```python
import torch

def _softmax(x, axis=-1):
    return torch.softmax(x, dim=axis)
def _gelu(x):
    return torch.nn.functional.gelu(x, approximate="tanh")
def _silu(x):
    return torch.nn.functional.silu(x)
def _sigmoid(x):
    return torch.sigmoid(x)
def _layernorm(x, axis=-1, eps=1e-5):
    m = x.mean(dim=axis, keepdim=True)
    v = x.var(dim=axis, keepdim=True, unbiased=False)
    return (x - m) / torch.sqrt(v + eps)
def _scatter_add(tgt, idx, src, axis=0):
    return tgt.clone().index_add_(axis, idx, src)
def _segment_sum(src, seg, n):
    out = torch.zeros((n,) + src.shape[1:], dtype=src.dtype)
    return out.index_add_(0, seg, src)
def _pad(x, pw):
    flat = tuple(v for pair in reversed(pw) for v in pair)
    return torch.nn.functional.pad(x, flat)

kernel_name = 'sequential_preLN__spectral_fnet__swiglu_ffn__prompt'

def setup_inputs():

    _w = (lambda a: (lambda t: t.to(torch.bfloat16) if t.is_floating_point() else t)(torch.as_tensor(a)))
    def _A_setup():
        B, S, D = 1, 2048, 576
        ns = torch.arange(S)[:, None] * torch.arange(S)[None, :]
        nd = torch.arange(D)[:, None] * torch.arange(D)[None, :]
        Ws_re = torch.cos(-2.0 * torch.pi * ns / S).to(float)
        Ws_im = torch.sin(-2.0 * torch.pi * ns / S).to(float)
        Wd_re = torch.cos(-2.0 * torch.pi * nd / D).to(float)
        Wd_im = torch.sin(-2.0 * torch.pi * nd / D).to(float)
        return {
            "x": _w((lambda *s: torch.randn(*s, dtype=torch.bfloat16) * 0.05)(B, S, D)),
            "dft_seq_re": _w(Ws_re),
            "dft_seq_im": _w(Ws_im),
            "dft_hid_re": _w(Wd_re),
            "dft_hid_im": _w(Wd_im),
        }
    _A_in = _A_setup()

    def _B_setup():
        B, S, D, F = 1, 2048, 576, 4608
        return {
            "x": _w((lambda *s: torch.randn(*s, dtype=torch.bfloat16) * 0.05)(B, S, D)),
            "w_gate": _w((lambda *s: torch.randn(*s, dtype=torch.bfloat16) * 0.2)(D, F)),
            "w_up": _w((lambda *s: torch.randn(*s, dtype=torch.bfloat16) * 0.2)(D, F)),
            "w_down": _w((lambda *s: torch.randn(*s, dtype=torch.bfloat16) * 0.2)(F, D)),
        }
    _B_in = _B_setup()

    return {
        "A_x": _A_in["x"],
        "A_dft_seq_re": _A_in["dft_seq_re"],
        "A_dft_seq_im": _A_in["dft_seq_im"],
        "A_dft_hid_re": _A_in["dft_hid_re"],
        "A_dft_hid_im": _A_in["dft_hid_im"],
        "B_x": _B_in["x"],
        "B_w_gate": _B_in["w_gate"],
        "B_w_up": _B_in["w_up"],
        "B_w_down": _B_in["w_down"],
    }

def reference(A_x, A_dft_seq_re, A_dft_seq_im, A_dft_hid_re, A_dft_hid_im, B_x, B_w_gate, B_w_up, B_w_down):
    def _A_ref(x, dft_seq_re, dft_seq_im, dft_hid_re, dft_hid_im):
        a = torch.einsum("bsd,ed->bse", x, dft_hid_re)
        b = torch.einsum("bsd,ed->bse", x, dft_hid_im)
        y = torch.einsum("ts,bse->bte", dft_seq_re, a) - torch.einsum("ts,bse->bte", dft_seq_im, b)
        return y

    def _B_ref(x, w_gate, w_up, w_down):
        g = _silu(x @ w_gate)
        u = x @ w_up
        return (g * u) @ w_down

    x = A_x
    h = x + _A_ref(_layernorm(x, axis=-1), A_dft_seq_re, A_dft_seq_im, A_dft_hid_re, A_dft_hid_im)
    h2 = h + _B_ref(_layernorm(h, axis=-1), B_w_gate, B_w_up, B_w_down)
    return h2
```

```asm
; @launch grid=(256,1,1) block=(256,1,1) lds=163840
.amdgcn_target "amdgcn-amd-amdhsa--gfx950"
.text
.globl sequential_preLN__spectral_fnet__swiglu_ffn__prompt_kernel
.p2align 8
.type sequential_preLN__spectral_fnet__swiglu_ffn__prompt_kernel,@function
sequential_preLN__spectral_fnet__swiglu_ffn__prompt_kernel:
  s_cmp_ge_u32 s2, 256
  s_cbranch_scc1 sequential_preLN__spectral_fnet__swiglu_ffn__prompt_kernel_end
  s_load_dwordx2 s[4:5], s[0:1], 0
  s_load_dwordx4 s[20:23], s[0:1], 80
  s_load_dwordx2 s[6:7], s[0:1], 88
  s_load_dwordx4 s[24:27], s[0:1], 48
  s_getpc_b64 s[16:17]
hid_pc:
  s_add_u32 s16, s16, hid_pc-hid_pc
  s_addc_u32 s17, s17, 0
  s_mov_b32 s18, sequential_preLN__spectral_fnet__swiglu_ffn__prompt_kernel_j1-hid_pc
  s_mov_b32 s19, 0x20000
  v_lshlrev_b32 v2, 7, v0
  buffer_load_dword v3, v2, s[16:19], 0 offen
  v_and_b32 v1, 63, v0
  v_lshrrev_b32 v4, 6, v0
  s_nop 0
  v_readfirstlane_b32 s28, v4
  s_cmp_ge_u32 s2, 192
  s_cbranch_scc1 hid_side
  s_and_b32 s29, s2, 7
  s_lshl_b32 s29, s29, 3
  s_bfe_u32 s31, s2, 0x30003
  s_or_b32 s29, s29, s31
  s_lshr_b32 s30, s2, 6
  v_and_b32 v12, 31, v1
  v_lshrrev_b32 v13, 5, v1
  s_cmp_lg_u32 s28, 3
  s_cbranch_scc1 hid_main
  v_lshrrev_b32 v5, 3, v1
  s_mov_b32 s37, 73728
  v_mul_lo_u32 v5, v5, s37
  v_lshrrev_b32 v6, 4, v1
  v_and_b32 v7, 7, v1
  v_xor_b32 v6, v6, v7
  v_lshlrev_b32 v6, 4, v6
  v_xor_b32 v7, 64, v6
  v_add_u32 v8, v5, v6
  v_add_u32 v9, 588800, v5
  v_add_u32 v9, v9, v7
  v_add_u32 v10, 1177600, v8
  v_add_u32 v11, 1177600, v9
  s_mul_i32 s33, s29, 1152
  s_waitcnt lgkmcnt(0)
  s_mov_b32 s8, s4
  s_mov_b32 s9, s5
  s_mov_b32 s10, 2359296
  s_mov_b32 s11, 0x20000
  s_mov_b32 m0, 73728
  s_nop 0
hid_ld:
  buffer_load_dwordx4 v8, s[8:11], s33 offen nt lds
  buffer_load_dwordx4 v9, s[8:11], s33 offen offset:1024 nt lds
  buffer_load_dwordx4 v10, s[8:11], s33 offen offset:2048 nt lds
  buffer_load_dwordx4 v11, s[8:11], s33 offen offset:3072 nt lds
  s_add_u32 m0, m0, 4096
  s_add_u32 s33, s33, 128
  s_cmp_lt_u32 m0, 110592
  s_cbranch_scc1 hid_ld
  v_and_b32 v24, 15, v1
  v_lshrrev_b32 v25, 4, v1
  v_lshrrev_b32 v26, 1, v24
  v_xor_b32 v25, v25, v26
  v_lshlrev_b32 v25, 4, v25
  v_lshl_add_u32 v20, v24, 7, v25
  v_add_u32 v20, 73728, v20
  v_xor_b32 v21, 64, v20
  v_mov_b32 v28, 0x3f803f80
  v_mov_b32 v29, 0x3f803f80
  v_mov_b32 v30, 0x3f803f80
  v_mov_b32 v31, 0x3f803f80
  v_lshlrev_b32 v27, 2, v24
  v_add_u32 v27, 110592, v27
  s_mov_b32 s16, s6
  s_mov_b32 s17, s7
  s_mov_b32 s18, 8388608
  s_mov_b32 s19, 0x20000
  v_lshrrev_b32 v5, 4, v12
  v_lshlrev_b32 v5, 5, v5
  v_bfe_u32 v6, v12, 2, 1
  v_lshl_add_u32 v5, v6, 4, v5
  v_bfe_u32 v6, v12, 3, 1
  v_lshl_add_u32 v5, v6, 3, v5
  v_and_b32 v6, 3, v12
  v_lshl_add_u32 v5, v6, 1, v5
  v_lshl_add_u32 v5, v13, 6, v5
  v_lshlrev_b32 v6, 2, v12
  v_add_u32 v7, 110592, v6
  v_bfe_u32 v14, v1, 1, 3
  v_lshlrev_b32 v14, 4, v14
  v_lshl_add_u32 v14, v12, 7, v14
  v_add_u32 v14, 73728, v14
  s_cmp_eq_u32 s30, 0
  s_cselect_b32 s38, 0, 0x1000000
  s_lshl_b32 s39, s29, 7
  s_add_u32 s39, s39, s38
  s_add_u32 s40, s39, 7143424
  s_add_u32 s39, s39, 2367488
  s_mov_b32 vcc_lo, 0xaaaaaaaa
  s_mov_b32 vcc_hi, 0xaaaaaaaa
  s_mov_b32 s46, 0xcccccccc
  s_mov_b32 s47, 0xcccccccc
  s_waitcnt vmcnt(24)
  s_barrier
  ds_read_b128 v[64:67], v20 offset:0
  ds_read_b128 v[68:71], v20 offset:2048
  ds_read_b128 v[72:75], v21 offset:0
  ds_read_b128 v[76:79], v21 offset:2048
  ds_read_b128 v[80:83], v20 offset:4096
  ds_read_b128 v[84:87], v20 offset:6144
  s_waitcnt lgkmcnt(5)
  v_mfma_f32_16x16x32_bf16 v[96:99], v[28:31], v[64:67], 0
  ds_read_b128 v[88:91], v21 offset:4096
  v_mfma_f32_16x16x32_bf16 v[100:103], v[64:67], v[64:67], 0
  s_waitcnt lgkmcnt(5)
  v_mfma_f32_16x16x32_bf16 v[104:107], v[28:31], v[68:71], 0
  ds_read_b128 v[92:95], v21 offset:6144
  v_mfma_f32_16x16x32_bf16 v[108:111], v[68:71], v[68:71], 0
  s_waitcnt lgkmcnt(4)
  v_mfma_f32_16x16x32_bf16 v[96:99], v[28:31], v[72:75], v[96:99]
  ds_read_b128 v[64:67], v20 offset:8192
  v_mfma_f32_16x16x32_bf16 v[100:103], v[72:75], v[72:75], v[100:103]
  v_mfma_f32_16x16x32_bf16 v[104:107], v[28:31], v[76:79], v[104:107]
  ds_read_b128 v[68:71], v20 offset:10240
  v_mfma_f32_16x16x32_bf16 v[108:111], v[76:79], v[76:79], v[108:111]
  s_waitcnt lgkmcnt(4)
  v_mfma_f32_16x16x32_bf16 v[96:99], v[28:31], v[80:83], v[96:99]
  ds_read_b128 v[72:75], v21 offset:8192
  v_mfma_f32_16x16x32_bf16 v[100:103], v[80:83], v[80:83], v[100:103]
  v_mfma_f32_16x16x32_bf16 v[104:107], v[28:31], v[84:87], v[104:107]
  ds_read_b128 v[76:79], v21 offset:10240
  v_mfma_f32_16x16x32_bf16 v[108:111], v[84:87], v[84:87], v[108:111]
  s_waitcnt lgkmcnt(4)
  v_mfma_f32_16x16x32_bf16 v[96:99], v[28:31], v[88:91], v[96:99]
  s_waitcnt vmcnt(0)
  s_barrier
  ds_read_b128 v[80:83], v20 offset:12288
  v_mfma_f32_16x16x32_bf16 v[100:103], v[88:91], v[88:91], v[100:103]
  v_mfma_f32_16x16x32_bf16 v[104:107], v[28:31], v[92:95], v[104:107]
  ds_read_b128 v[84:87], v20 offset:14336
  v_mfma_f32_16x16x32_bf16 v[108:111], v[92:95], v[92:95], v[108:111]
  s_waitcnt lgkmcnt(4)
  v_mfma_f32_16x16x32_bf16 v[96:99], v[28:31], v[64:67], v[96:99]
  ds_read_b128 v[88:91], v21 offset:12288
  v_mfma_f32_16x16x32_bf16 v[100:103], v[64:67], v[64:67], v[100:103]
  v_mfma_f32_16x16x32_bf16 v[104:107], v[28:31], v[68:71], v[104:107]
  ds_read_b128 v[92:95], v21 offset:14336
  v_mfma_f32_16x16x32_bf16 v[108:111], v[68:71], v[68:71], v[108:111]
  s_waitcnt lgkmcnt(4)
  v_mfma_f32_16x16x32_bf16 v[96:99], v[28:31], v[72:75], v[96:99]
  ds_read_b128 v[64:67], v20 offset:16384
  v_mfma_f32_16x16x32_bf16 v[100:103], v[72:75], v[72:75], v[100:103]
  v_mfma_f32_16x16x32_bf16 v[104:107], v[28:31], v[76:79], v[104:107]
  ds_read_b128 v[68:71], v20 offset:18432
  v_mfma_f32_16x16x32_bf16 v[108:111], v[76:79], v[76:79], v[108:111]
  s_waitcnt lgkmcnt(4)
  v_mfma_f32_16x16x32_bf16 v[96:99], v[28:31], v[80:83], v[96:99]
  ds_read_b128 v[72:75], v21 offset:16384
  v_mfma_f32_16x16x32_bf16 v[100:103], v[80:83], v[80:83], v[100:103]
  v_mfma_f32_16x16x32_bf16 v[104:107], v[28:31], v[84:87], v[104:107]
  ds_read_b128 v[76:79], v21 offset:18432
  v_mfma_f32_16x16x32_bf16 v[108:111], v[84:87], v[84:87], v[108:111]
  s_waitcnt lgkmcnt(4)
  v_mfma_f32_16x16x32_bf16 v[96:99], v[28:31], v[88:91], v[96:99]
  ds_read_b128 v[80:83], v20 offset:20480
  v_mfma_f32_16x16x32_bf16 v[100:103], v[88:91], v[88:91], v[100:103]
  v_mfma_f32_16x16x32_bf16 v[104:107], v[28:31], v[92:95], v[104:107]
  ds_read_b128 v[84:87], v20 offset:22528
  v_mfma_f32_16x16x32_bf16 v[108:111], v[92:95], v[92:95], v[108:111]
  s_waitcnt lgkmcnt(4)
  v_mfma_f32_16x16x32_bf16 v[96:99], v[28:31], v[64:67], v[96:99]
  ds_read_b128 v[88:91], v21 offset:20480
  v_mfma_f32_16x16x32_bf16 v[100:103], v[64:67], v[64:67], v[100:103]
  v_mfma_f32_16x16x32_bf16 v[104:107], v[28:31], v[68:71], v[104:107]
  ds_read_b128 v[92:95], v21 offset:22528
  v_mfma_f32_16x16x32_bf16 v[108:111], v[68:71], v[68:71], v[108:111]
  s_waitcnt lgkmcnt(4)
  v_mfma_f32_16x16x32_bf16 v[96:99], v[28:31], v[72:75], v[96:99]
  ds_read_b128 v[64:67], v20 offset:24576
  v_mfma_f32_16x16x32_bf16 v[100:103], v[72:75], v[72:75], v[100:103]
  v_mfma_f32_16x16x32_bf16 v[104:107], v[28:31], v[76:79], v[104:107]
  ds_read_b128 v[68:71], v20 offset:26624
  v_mfma_f32_16x16x32_bf16 v[108:111], v[76:79], v[76:79], v[108:111]
  s_waitcnt lgkmcnt(4)
  v_mfma_f32_16x16x32_bf16 v[96:99], v[28:31], v[80:83], v[96:99]
  ds_read_b128 v[72:75], v21 offset:24576
  v_mfma_f32_16x16x32_bf16 v[100:103], v[80:83], v[80:83], v[100:103]
  v_mfma_f32_16x16x32_bf16 v[104:107], v[28:31], v[84:87], v[104:107]
  ds_read_b128 v[76:79], v21 offset:26624
  v_mfma_f32_16x16x32_bf16 v[108:111], v[84:87], v[84:87], v[108:111]
  s_waitcnt lgkmcnt(4)
  v_mfma_f32_16x16x32_bf16 v[96:99], v[28:31], v[88:91], v[96:99]
  ds_read_b128 v[80:83], v20 offset:28672
  v_mfma_f32_16x16x32_bf16 v[100:103], v[88:91], v[88:91], v[100:103]
  v_mfma_f32_16x16x32_bf16 v[104:107], v[28:31], v[92:95], v[104:107]
  ds_read_b128 v[84:87], v20 offset:30720
  v_mfma_f32_16x16x32_bf16 v[108:111], v[92:95], v[92:95], v[108:111]
  s_waitcnt lgkmcnt(4)
  v_mfma_f32_16x16x32_bf16 v[96:99], v[28:31], v[64:67], v[96:99]
  ds_read_b128 v[88:91], v21 offset:28672
  v_mfma_f32_16x16x32_bf16 v[100:103], v[64:67], v[64:67], v[100:103]
  v_mfma_f32_16x16x32_bf16 v[104:107], v[28:31], v[68:71], v[104:107]
  ds_read_b128 v[92:95], v21 offset:30720
  v_mfma_f32_16x16x32_bf16 v[108:111], v[68:71], v[68:71], v[108:111]
  s_waitcnt lgkmcnt(4)
  v_mfma_f32_16x16x32_bf16 v[96:99], v[28:31], v[72:75], v[96:99]
  ds_read_b128 v[64:67], v20 offset:32768
  v_mfma_f32_16x16x32_bf16 v[100:103], v[72:75], v[72:75], v[100:103]
  v_mfma_f32_16x16x32_bf16 v[104:107], v[28:31], v[76:79], v[104:107]
  ds_read_b128 v[68:71], v20 offset:34816
  v_mfma_f32_16x16x32_bf16 v[108:111], v[76:79], v[76:79], v[108:111]
  s_waitcnt lgkmcnt(4)
  v_mfma_f32_16x16x32_bf16 v[96:99], v[28:31], v[80:83], v[96:99]
  ds_read_b128 v[72:75], v21 offset:32768
  v_mfma_f32_16x16x32_bf16 v[100:103], v[80:83], v[80:83], v[100:103]
  v_mfma_f32_16x16x32_bf16 v[104:107], v[28:31], v[84:87], v[104:107]
  ds_read_b128 v[76:79], v21 offset:34816
  v_mfma_f32_16x16x32_bf16 v[108:111], v[84:87], v[84:87], v[108:111]
  s_waitcnt lgkmcnt(4)
  v_mfma_f32_16x16x32_bf16 v[96:99], v[28:31], v[88:91], v[96:99]
  v_mfma_f32_16x16x32_bf16 v[100:103], v[88:91], v[88:91], v[100:103]
  v_mfma_f32_16x16x32_bf16 v[104:107], v[28:31], v[92:95], v[104:107]
  v_mfma_f32_16x16x32_bf16 v[108:111], v[92:95], v[92:95], v[108:111]
  s_waitcnt lgkmcnt(2)
  v_mfma_f32_16x16x32_bf16 v[96:99], v[28:31], v[64:67], v[96:99]
  v_mfma_f32_16x16x32_bf16 v[100:103], v[64:67], v[64:67], v[100:103]
  v_mfma_f32_16x16x32_bf16 v[104:107], v[28:31], v[68:71], v[104:107]
  v_mfma_f32_16x16x32_bf16 v[108:111], v[68:71], v[68:71], v[108:111]
  s_waitcnt lgkmcnt(0)
  v_mfma_f32_16x16x32_bf16 v[96:99], v[28:31], v[72:75], v[96:99]
  v_mfma_f32_16x16x32_bf16 v[100:103], v[72:75], v[72:75], v[100:103]
  v_mfma_f32_16x16x32_bf16 v[104:107], v[28:31], v[76:79], v[104:107]
  v_mfma_f32_16x16x32_bf16 v[108:111], v[76:79], v[76:79], v[108:111]
  s_nop 4
  v_mul_f32 v96, 0xbae38e39, v96
  s_nop 0
  v_mul_f32 v104, 0xbae38e39, v104
  v_cndmask_b32 v100, v100, v101, vcc
  v_cndmask_b32 v108, v108, v109, vcc
  v_cndmask_b32 v102, v102, v103, vcc
  v_cndmask_b32 v110, v110, v111, vcc
  v_cndmask_b32 v100, v100, v102, s[46:47]
  v_cndmask_b32 v108, v108, v110, s[46:47]
  v_mul_f32 v100, 0x3ae38e39, v100
  v_mul_f32 v108, 0x3ae38e39, v108
  v_fma_f32 v100, -v96, v96, v100
  v_fma_f32 v108, -v104, v104, v108
  v_max_f32 v100, 0, v100
  v_max_f32 v108, 0, v108
  v_add_f32 v100, 0x3727c5ac, v100
  v_add_f32 v108, 0x3727c5ac, v108
  v_rsq_f32 v100, v100
  v_rsq_f32 v108, v108
  s_mov_b32 exec_lo, 0x00f0000f
  s_mov_b32 exec_hi, 0xf0000f00
  ds_write2_b32 v27, v96, v100 offset0:0 offset1:32
  ds_write2_b32 v27, v104, v108 offset0:16 offset1:48
  s_mov_b64 exec, -1
  s_waitcnt lgkmcnt(0)
  s_barrier
  ds_read2_b32 v[32:33], v7 offset0:0 offset1:32
  ds_read_u16 v34, v14
  v_cmp_gt_u32 vcc, 32, v1
  s_waitcnt lgkmcnt(0)
  v_lshlrev_b32 v34, 16, v34
  v_add_f32 v34, v34, v32
  v_mul_f32 v34, v34, v33
  v_cvt_pk_bf16_f32 v34, v34, v34
  v_cndmask_b32 v34, 0, v34, vcc
  buffer_store_short v34, v5, s[16:19], s39 offen sc1
  buffer_store_dword v32, v6, s[16:19], s40 offen sc1
  s_branch sequential_preLN__spectral_fnet__swiglu_ffn__prompt_kernel_j1
hid_side:
  s_nop 4
  v_lshlrev_b32 v2, 7, v1
  s_sub_u32 s29, s2, 192
  s_and_b32 s30, s29, 7
  s_lshr_b32 s29, s29, 3
  s_lshl_b32 s31, s28, 3
  s_add_u32 s29, s29, s31
  s_getpc_b64 s[16:17]
hid_pc2:
  s_add_u32 s16, s16, sequential_preLN__spectral_fnet__swiglu_ffn__prompt_kernel_j1-hid_pc2
  s_addc_u32 s17, s17, 0
  s_mov_b32 s18, sequential_preLN__spectral_fnet__swiglu_ffn__prompt_kernel_end-sequential_preLN__spectral_fnet__swiglu_ffn__prompt_kernel_j1
  s_mov_b32 s19, 0x20000
  s_mul_i32 s31, s29, 1792
  s_mov_b64 exec, 0x3fff
  buffer_load_dword v5, v2, s[16:19], s31 offen
  s_mov_b64 exec, -1
  s_waitcnt lgkmcnt(0)
  s_add_u32 s12, s6, 7159808
  s_addc_u32 s13, s7, 0
  s_mov_b32 s14, 106496
  s_mov_b32 s15, 0x20000
  v_lshlrev_b32 v10, 4, v0
  v_mov_b32 v12, 0
  v_mov_b32 v13, 0
  v_mov_b32 v14, 0
  v_mov_b32 v15, 0
  s_sub_u32 s36, s2, 192
  s_lshl_b32 s36, s36, 12
  buffer_store_dwordx4 v[12:15], v10, s[12:15], s36 offen sc1
  s_mov_b32 s16, s20
  s_mov_b32 s17, s21
  s_mov_b32 s18, 104
  s_mov_b32 s19, 0x20000
  v_lshlrev_b32 v10, 8, v0
  v_mov_b32 v11, 1
  s_lshr_b32 s36, s36, 10
  s_waitcnt vmcnt(0)
  s_barrier
  buffer_store_dword v11, v10, s[16:19], s36 offen sc1
  s_load_dwordx2 s[36:37], s[0:1], 64
  s_sub_u32 s38, s2, 192
  s_lshr_b32 s38, s38, 3
  s_mul_i32 s38, s38, 72
  s_cmp_eq_u32 s28, 2
  s_cselect_b32 s39, 9, 72
  s_lshl_b32 s39, s39, 7
  s_mul_i32 s40, s30, 663552
  s_mul_i32 s41, s30, 1152
  s_cmp_eq_u32 s28, 2
  s_cselect_b32 s40, s40, s41
  s_mul_i32 s41, s38, s39
  s_add_u32 s40, s40, s41
  s_add_u32 s40, s40, 1024
  v_bfe_u32 v6, v1, 1, 3
  v_mul_lo_u32 v6, v6, s39
  v_lshrrev_b32 v7, 4, v1
  v_lshl_add_u32 v6, v7, 5, v6
  v_and_b32 v8, 1, v1
  v_lshl_add_u32 v6, v8, 4, v6
  v_mul_u32_u24 v7, 18432, v7
  v_and_b32 v8, 15, v1
  v_lshl_add_u32 v7, v8, 4, v7
  s_lshl_b32 s39, s39, 3
  s_mul_i32 s42, s30, 3
  s_add_u32 s42, s42, s28
  s_mul_i32 s42, s42, 73728
  s_lshl_b32 s41, s38, 5
  s_add_u32 s42, s42, s41
  s_waitcnt lgkmcnt(0)
  s_cmp_eq_u32 s28, 1
  s_cselect_b32 s8, s26, s24
  s_cselect_b32 s9, s27, s25
  s_cmp_eq_u32 s28, 2
  s_cselect_b32 s8, s36, s8
  s_cselect_b32 s9, s37, s9
  s_mov_b32 s10, 5308416
  s_mov_b32 s11, 0x20000
  s_add_u32 s12, s6, 46137344
  s_addc_u32 s13, s7, 0
  s_mov_b32 s14, 1769472
  s_mov_b32 s15, 0x20000
  s_cmp_eq_u32 s28, 3
  s_cbranch_scc1 hid_pk
  buffer_load_dwordx4 v[16:19], v6, s[8:11], s40 offen nt
  s_add_u32 s40, s40, s39
  buffer_load_dwordx4 v[20:23], v6, s[8:11], s40 offen nt
  s_add_u32 s40, s40, s39
  buffer_load_dwordx4 v[24:27], v6, s[8:11], s40 offen nt
  s_add_u32 s40, s40, s39
  buffer_load_dwordx4 v[28:31], v6, s[8:11], s40 offen nt
  s_add_u32 s40, s40, s39
  buffer_load_dwordx4 v[32:35], v6, s[8:11], s40 offen nt
  s_add_u32 s40, s40, s39
  buffer_load_dwordx4 v[36:39], v6, s[8:11], s40 offen nt
  s_add_u32 s40, s40, s39
  buffer_load_dwordx4 v[40:43], v6, s[8:11], s40 offen nt
  s_add_u32 s40, s40, s39
  buffer_load_dwordx4 v[44:47], v6, s[8:11], s40 offen nt
  s_add_u32 s40, s40, s39
  buffer_load_dwordx4 v[48:51], v6, s[8:11], s40 offen nt
  s_add_u32 s40, s40, s39
hid_pk:
  v_mul_u32_u24 v6, 9216, v1
  s_mul_i32 s30, s30, 1152
  s_mov_b32 s10, 5308416
  s_mov_b32 s11, 0x20000
  s_add_u32 s32, s29, 0
  s_and_b32 s33, s32, 7
  s_lshr_b32 s34, s32, 3
  s_bitcmp1_b32 s33, 0
  s_cselect_b32 s8, s26, s24
  s_cselect_b32 s9, s27, s25
  s_lshr_b32 s33, s33, 1
  s_lshl_b32 s33, s33, 2
  s_lshr_b32 s33, 0x75316420, s33
  s_and_b32 s33, s33, 15
  s_lshl_b32 s33, s33, 7
  s_mul_i32 s34, s34, 589824
  s_add_u32 s33, s33, s34
  s_add_u32 s33, s33, s30
  buffer_load_dword v223, v6, s[8:11], s33 offen
  s_add_u32 s32, s29, 32
  s_and_b32 s33, s32, 7
  s_lshr_b32 s34, s32, 3
  s_bitcmp1_b32 s33, 0
  s_cselect_b32 s8, s26, s24
  s_cselect_b32 s9, s27, s25
  s_lshr_b32 s33, s33, 1
  s_lshl_b32 s33, s33, 2
  s_lshr_b32 s33, 0x75316420, s33
  s_and_b32 s33, s33, 15
  s_lshl_b32 s33, s33, 7
  s_mul_i32 s34, s34, 589824
  s_add_u32 s33, s33, s34
  s_add_u32 s33, s33, s30
  buffer_load_dword v223, v6, s[8:11], s33 offen
  s_add_u32 s32, s29, 64
  s_cmp_ge_u32 s32, 72
  s_cbranch_scc1 hid_sx
  s_and_b32 s33, s32, 7
  s_lshr_b32 s34, s32, 3
  s_bitcmp1_b32 s33, 0
  s_cselect_b32 s8, s26, s24
  s_cselect_b32 s9, s27, s25
  s_lshr_b32 s33, s33, 1
  s_lshl_b32 s33, s33, 2
  s_lshr_b32 s33, 0x75316420, s33
  s_and_b32 s33, s33, 15
  s_lshl_b32 s33, s33, 7
  s_mul_i32 s34, s34, 589824
  s_add_u32 s33, s33, s34
  s_add_u32 s33, s33, s30
  buffer_load_dword v223, v6, s[8:11], s33 offen
hid_sx:
  s_cmp_eq_u32 s28, 3
  s_cbranch_scc1 sequential_preLN__spectral_fnet__swiglu_ffn__prompt_kernel_j1
  s_waitcnt vmcnt(2)
  buffer_store_dwordx4 v[16:19], v7, s[12:15], s42 offen sc1
  buffer_store_dwordx4 v[20:23], v7, s[12:15], s42 offen offset:256 sc1
  buffer_store_dwordx4 v[24:27], v7, s[12:15], s42 offen offset:512 sc1
  buffer_store_dwordx4 v[28:31], v7, s[12:15], s42 offen offset:768 sc1
  buffer_store_dwordx4 v[32:35], v7, s[12:15], s42 offen offset:1024 sc1
  buffer_store_dwordx4 v[36:39], v7, s[12:15], s42 offen offset:1280 sc1
  buffer_store_dwordx4 v[40:43], v7, s[12:15], s42 offen offset:1536 sc1
  buffer_store_dwordx4 v[44:47], v7, s[12:15], s42 offen offset:1792 sc1
  buffer_store_dwordx4 v[48:51], v7, s[12:15], s42 offen offset:2048 sc1
  s_branch sequential_preLN__spectral_fnet__swiglu_ffn__prompt_kernel_j1
hid_main:
  s_movk_i32 s44, 512
  s_mul_i32 s32, s30, 3
  s_add_u32 s32, s32, s28
  s_lshl_b32 s38, s32, 4
  v_and_b32 v8, 15, v1
  v_add_u32 v8, s38, v8
  v_bfe_u32 v9, v1, 4, 1
  v_lshl_add_u32 v10, v9, 9, v8
  v_cmp_eq_u32 s[40:41], v10, s44
  v_mov_b32 v5, 144
  s_nop 0
  v_cndmask_b32 v5, v8, v5, s[40:41]
  v_cvt_f32_u32 v5, v5
  v_cvt_f32_u32 v6, v9
  v_mul_f32 v6, 0x3e800000, v6
  v_cndmask_b32 v7, v6, 0, s[40:41]
  v_mul_f32 v11, 0x3d638e39, v5
  v_mul_f32 v5, 0x3ae38e39, v5
  v_cos_f32 v28, v11
  v_cvt_f32_u32 v11, v13
  v_mul_f32 v11, 0x41000000, v11
  v_fmac_f32 v6, v5, v11
  v_fmac_f32 v7, v5, v11
  v_add_f32 v28, v28, v28
  v_fmamk_f32 v32, v5, 0x0, v7
  v_fmamk_f32 v33, v5, 0x40000000, v7
  v_fmamk_f32 v34, v5, 0x40800000, v7
  v_fmamk_f32 v35, v5, 0x40c00000, v7
  v_fmamk_f32 v36, v5, 0x41800000, v7
  v_fmamk_f32 v37, v5, 0x41900000, v7
  v_fmamk_f32 v38, v5, 0x41a00000, v7
  v_fmamk_f32 v39, v5, 0x41b00000, v7
  v_fmamk_f32 v40, v5, 0x3f800000, v6
  v_fmamk_f32 v41, v5, 0x40400000, v6
  v_fmamk_f32 v42, v5, 0x40a00000, v6
  v_fmamk_f32 v43, v5, 0x40e00000, v6
  v_fmamk_f32 v44, v5, 0x41880000, v6
  v_fmamk_f32 v45, v5, 0x41980000, v6
  v_fmamk_f32 v46, v5, 0x41a80000, v6
  v_fmamk_f32 v47, v5, 0x41b80000, v6
  v_cos_f32 v32, v32
  v_cos_f32 v33, v33
  v_cos_f32 v34, v34
  v_cos_f32 v35, v35
  v_cos_f32 v36, v36
  v_cos_f32 v37, v37
  v_cos_f32 v38, v38
  v_cos_f32 v39, v39
  v_cos_f32 v40, v40
  v_cos_f32 v41, v41
  v_cos_f32 v42, v42
  v_cos_f32 v43, v43
  v_cos_f32 v44, v44
  v_cos_f32 v45, v45
  v_cos_f32 v46, v46
  v_cos_f32 v47, v47
  v_cvt_pk_bf16_f32 v112, v32, v33
  v_cvt_pk_bf16_f32 v113, v34, v35
  v_cvt_pk_bf16_f32 v114, v36, v37
  v_cvt_pk_bf16_f32 v115, v38, v39
  v_cvt_pk_bf16_f32 v116, v40, v41
  v_cvt_pk_bf16_f32 v117, v42, v43
  v_cvt_pk_bf16_f32 v118, v44, v45
  v_cvt_pk_bf16_f32 v119, v46, v47
  v_fmamk_f32 v48, v5, 0x42000000, v7
  v_fmamk_f32 v49, v5, 0x42080000, v7
  v_fmamk_f32 v50, v5, 0x42100000, v7
  v_fmamk_f32 v51, v5, 0x42180000, v7
  v_fmamk_f32 v52, v5, 0x42400000, v7
  v_fmamk_f32 v53, v5, 0x42480000, v7
  v_fmamk_f32 v54, v5, 0x42500000, v7
  v_fmamk_f32 v55, v5, 0x42580000, v7
  v_fmamk_f32 v56, v5, 0x42040000, v6
  v_fmamk_f32 v57, v5, 0x420c0000, v6
  v_fmamk_f32 v58, v5, 0x42140000, v6
  v_fmamk_f32 v59, v5, 0x421c0000, v6
  v_fmamk_f32 v60, v5, 0x42440000, v6
  v_fmamk_f32 v61, v5, 0x424c0000, v6
  v_fmamk_f32 v62, v5, 0x42540000, v6
  v_fmamk_f32 v63, v5, 0x425c0000, v6
  v_cos_f32 v48, v48
  v_cos_f32 v49, v49
  v_cos_f32 v50, v50
  v_cos_f32 v51, v51
  v_cos_f32 v52, v52
  v_cos_f32 v53, v53
  v_cos_f32 v54, v54
  v_cos_f32 v55, v55
  v_cos_f32 v56, v56
  v_cos_f32 v57, v57
  v_cos_f32 v58, v58
  v_cos_f32 v59, v59
  v_cos_f32 v60, v60
  v_cos_f32 v61, v61
  v_cos_f32 v62, v62
  v_cos_f32 v63, v63
  v_cvt_pk_bf16_f32 v120, v48, v49
  v_cvt_pk_bf16_f32 v121, v50, v51
  v_cvt_pk_bf16_f32 v122, v52, v53
  v_cvt_pk_bf16_f32 v123, v54, v55
  v_cvt_pk_bf16_f32 v124, v56, v57
  v_cvt_pk_bf16_f32 v125, v58, v59
  v_cvt_pk_bf16_f32 v126, v60, v61
  v_cvt_pk_bf16_f32 v127, v62, v63
  v_pk_fma_f32 v[32:33], v[48:49], v[28:29], v[32:33] op_sel_hi:[1,0,1] neg_lo:[0,0,1] neg_hi:[0,0,1]
  v_pk_fma_f32 v[34:35], v[50:51], v[28:29], v[34:35] op_sel_hi:[1,0,1] neg_lo:[0,0,1] neg_hi:[0,0,1]
  v_pk_fma_f32 v[36:37], v[52:53], v[28:29], v[36:37] op_sel_hi:[1,0,1] neg_lo:[0,0,1] neg_hi:[0,0,1]
  v_pk_fma_f32 v[38:39], v[54:55], v[28:29], v[38:39] op_sel_hi:[1,0,1] neg_lo:[0,0,1] neg_hi:[0,0,1]
  v_pk_fma_f32 v[40:41], v[56:57], v[28:29], v[40:41] op_sel_hi:[1,0,1] neg_lo:[0,0,1] neg_hi:[0,0,1]
  v_pk_fma_f32 v[42:43], v[58:59], v[28:29], v[42:43] op_sel_hi:[1,0,1] neg_lo:[0,0,1] neg_hi:[0,0,1]
  v_pk_fma_f32 v[44:45], v[60:61], v[28:29], v[44:45] op_sel_hi:[1,0,1] neg_lo:[0,0,1] neg_hi:[0,0,1]
  v_pk_fma_f32 v[46:47], v[62:63], v[28:29], v[46:47] op_sel_hi:[1,0,1] neg_lo:[0,0,1] neg_hi:[0,0,1]
  v_cvt_pk_bf16_f32 v128, v32, v33
  v_cvt_pk_bf16_f32 v129, v34, v35
  v_cvt_pk_bf16_f32 v130, v36, v37
  v_cvt_pk_bf16_f32 v131, v38, v39
  v_cvt_pk_bf16_f32 v132, v40, v41
  v_cvt_pk_bf16_f32 v133, v42, v43
  v_cvt_pk_bf16_f32 v134, v44, v45
  v_cvt_pk_bf16_f32 v135, v46, v47
  v_pk_fma_f32 v[48:49], v[32:33], v[28:29], v[48:49] op_sel_hi:[1,0,1] neg_lo:[0,0,1] neg_hi:[0,0,1]
  v_pk_fma_f32 v[50:51], v[34:35], v[28:29], v[50:51] op_sel_hi:[1,0,1] neg_lo:[0,0,1] neg_hi:[0,0,1]
  v_pk_fma_f32 v[52:53], v[36:37], v[28:29], v[52:53] op_sel_hi:[1,0,1] neg_lo:[0,0,1] neg_hi:[0,0,1]
  v_pk_fma_f32 v[54:55], v[38:39], v[28:29], v[54:55] op_sel_hi:[1,0,1] neg_lo:[0,0,1] neg_hi:[0,0,1]
  v_pk_fma_f32 v[56:57], v[40:41], v[28:29], v[56:57] op_sel_hi:[1,0,1] neg_lo:[0,0,1] neg_hi:[0,0,1]
  v_pk_fma_f32 v[58:59], v[42:43], v[28:29], v[58:59] op_sel_hi:[1,0,1] neg_lo:[0,0,1] neg_hi:[0,0,1]
  v_pk_fma_f32 v[60:61], v[44:45], v[28:29], v[60:61] op_sel_hi:[1,0,1] neg_lo:[0,0,1] neg_hi:[0,0,1]
  v_pk_fma_f32 v[62:63], v[46:47], v[28:29], v[62:63] op_sel_hi:[1,0,1] neg_lo:[0,0,1] neg_hi:[0,0,1]
  v_cvt_pk_bf16_f32 v136, v48, v49
  v_cvt_pk_bf16_f32 v137, v50, v51
  v_cvt_pk_bf16_f32 v138, v52, v53
  v_cvt_pk_bf16_f32 v139, v54, v55
  v_cvt_pk_bf16_f32 v140, v56, v57
  v_cvt_pk_bf16_f32 v141, v58, v59
  v_cvt_pk_bf16_f32 v142, v60, v61
  v_cvt_pk_bf16_f32 v143, v62, v63
  v_pk_fma_f32 v[32:33], v[48:49], v[28:29], v[32:33] op_sel_hi:[1,0,1] neg_lo:[0,0,1] neg_hi:[0,0,1]
  v_pk_fma_f32 v[34:35], v[50:51], v[28:29], v[34:35] op_sel_hi:[1,0,1] neg_lo:[0,0,1] neg_hi:[0,0,1]
  v_pk_fma_f32 v[36:37], v[52:53], v[28:29], v[36:37] op_sel_hi:[1,0,1] neg_lo:[0,0,1] neg_hi:[0,0,1]
  v_pk_fma_f32 v[38:39], v[54:55], v[28:29], v[38:39] op_sel_hi:[1,0,1] neg_lo:[0,0,1] neg_hi:[0,0,1]
  v_pk_fma_f32 v[40:41], v[56:57], v[28:29], v[40:41] op_sel_hi:[1,0,1] neg_lo:[0,0,1] neg_hi:[0,0,1]
  v_pk_fma_f32 v[42:43], v[58:59], v[28:29], v[42:43] op_sel_hi:[1,0,1] neg_lo:[0,0,1] neg_hi:[0,0,1]
  v_pk_fma_f32 v[44:45], v[60:61], v[28:29], v[44:45] op_sel_hi:[1,0,1] neg_lo:[0,0,1] neg_hi:[0,0,1]
  v_pk_fma_f32 v[46:47], v[62:63], v[28:29], v[46:47] op_sel_hi:[1,0,1] neg_lo:[0,0,1] neg_hi:[0,0,1]
  v_cvt_pk_bf16_f32 v144, v32, v33
  v_cvt_pk_bf16_f32 v145, v34, v35
  v_cvt_pk_bf16_f32 v146, v36, v37
  v_cvt_pk_bf16_f32 v147, v38, v39
  v_cvt_pk_bf16_f32 v148, v40, v41
  v_cvt_pk_bf16_f32 v149, v42, v43
  v_cvt_pk_bf16_f32 v150, v44, v45
  v_cvt_pk_bf16_f32 v151, v46, v47
  v_pk_fma_f32 v[48:49], v[32:33], v[28:29], v[48:49] op_sel_hi:[1,0,1] neg_lo:[0,0,1] neg_hi:[0,0,1]
  v_pk_fma_f32 v[50:51], v[34:35], v[28:29], v[50:51] op_sel_hi:[1,0,1] neg_lo:[0,0,1] neg_hi:[0,0,1]
  v_pk_fma_f32 v[52:53], v[36:37], v[28:29], v[52:53] op_sel_hi:[1,0,1] neg_lo:[0,0,1] neg_hi:[0,0,1]
  v_pk_fma_f32 v[54:55], v[38:39], v[28:29], v[54:55] op_sel_hi:[1,0,1] neg_lo:[0,0,1] neg_hi:[0,0,1]
  v_pk_fma_f32 v[56:57], v[40:41], v[28:29], v[56:57] op_sel_hi:[1,0,1] neg_lo:[0,0,1] neg_hi:[0,0,1]
  v_pk_fma_f32 v[58:59], v[42:43], v[28:29], v[58:59] op_sel_hi:[1,0,1] neg_lo:[0,0,1] neg_hi:[0,0,1]
  v_pk_fma_f32 v[60:61], v[44:45], v[28:29], v[60:61] op_sel_hi:[1,0,1] neg_lo:[0,0,1] neg_hi:[0,0,1]
  v_pk_fma_f32 v[62:63], v[46:47], v[28:29], v[62:63] op_sel_hi:[1,0,1] neg_lo:[0,0,1] neg_hi:[0,0,1]
  v_cvt_pk_bf16_f32 v152, v48, v49
  v_cvt_pk_bf16_f32 v153, v50, v51
  v_cvt_pk_bf16_f32 v154, v52, v53
  v_cvt_pk_bf16_f32 v155, v54, v55
  v_cvt_pk_bf16_f32 v156, v56, v57
  v_cvt_pk_bf16_f32 v157, v58, v59
  v_cvt_pk_bf16_f32 v158, v60, v61
  v_cvt_pk_bf16_f32 v159, v62, v63
  v_pk_fma_f32 v[32:33], v[48:49], v[28:29], v[32:33] op_sel_hi:[1,0,1] neg_lo:[0,0,1] neg_hi:[0,0,1]
  v_pk_fma_f32 v[34:35], v[50:51], v[28:29], v[34:35] op_sel_hi:[1,0,1] neg_lo:[0,0,1] neg_hi:[0,0,1]
  v_pk_fma_f32 v[36:37], v[52:53], v[28:29], v[36:37] op_sel_hi:[1,0,1] neg_lo:[0,0,1] neg_hi:[0,0,1]
  v_pk_fma_f32 v[38:39], v[54:55], v[28:29], v[38:39] op_sel_hi:[1,0,1] neg_lo:[0,0,1] neg_hi:[0,0,1]
  v_pk_fma_f32 v[40:41], v[56:57], v[28:29], v[40:41] op_sel_hi:[1,0,1] neg_lo:[0,0,1] neg_hi:[0,0,1]
  v_pk_fma_f32 v[42:43], v[58:59], v[28:29], v[42:43] op_sel_hi:[1,0,1] neg_lo:[0,0,1] neg_hi:[0,0,1]
  v_pk_fma_f32 v[44:45], v[60:61], v[28:29], v[44:45] op_sel_hi:[1,0,1] neg_lo:[0,0,1] neg_hi:[0,0,1]
  v_pk_fma_f32 v[46:47], v[62:63], v[28:29], v[46:47] op_sel_hi:[1,0,1] neg_lo:[0,0,1] neg_hi:[0,0,1]
  v_cvt_pk_bf16_f32 v160, v32, v33
  v_cvt_pk_bf16_f32 v161, v34, v35
  v_cvt_pk_bf16_f32 v162, v36, v37
  v_cvt_pk_bf16_f32 v163, v38, v39
  v_cvt_pk_bf16_f32 v164, v40, v41
  v_cvt_pk_bf16_f32 v165, v42, v43
  v_cvt_pk_bf16_f32 v166, v44, v45
  v_cvt_pk_bf16_f32 v167, v46, v47
  v_pk_fma_f32 v[48:49], v[32:33], v[28:29], v[48:49] op_sel_hi:[1,0,1] neg_lo:[0,0,1] neg_hi:[0,0,1]
  v_pk_fma_f32 v[50:51], v[34:35], v[28:29], v[50:51] op_sel_hi:[1,0,1] neg_lo:[0,0,1] neg_hi:[0,0,1]
  v_pk_fma_f32 v[52:53], v[36:37], v[28:29], v[52:53] op_sel_hi:[1,0,1] neg_lo:[0,0,1] neg_hi:[0,0,1]
  v_pk_fma_f32 v[54:55], v[38:39], v[28:29], v[54:55] op_sel_hi:[1,0,1] neg_lo:[0,0,1] neg_hi:[0,0,1]
  v_pk_fma_f32 v[56:57], v[40:41], v[28:29], v[56:57] op_sel_hi:[1,0,1] neg_lo:[0,0,1] neg_hi:[0,0,1]
  v_pk_fma_f32 v[58:59], v[42:43], v[28:29], v[58:59] op_sel_hi:[1,0,1] neg_lo:[0,0,1] neg_hi:[0,0,1]
  v_pk_fma_f32 v[60:61], v[44:45], v[28:29], v[60:61] op_sel_hi:[1,0,1] neg_lo:[0,0,1] neg_hi:[0,0,1]
  v_pk_fma_f32 v[62:63], v[46:47], v[28:29], v[62:63] op_sel_hi:[1,0,1] neg_lo:[0,0,1] neg_hi:[0,0,1]
  v_cvt_pk_bf16_f32 v168, v48, v49
  v_cvt_pk_bf16_f32 v169, v50, v51
  v_cvt_pk_bf16_f32 v170, v52, v53
  v_cvt_pk_bf16_f32 v171, v54, v55
  v_cvt_pk_bf16_f32 v172, v56, v57
  v_cvt_pk_bf16_f32 v173, v58, v59
  v_cvt_pk_bf16_f32 v174, v60, v61
  v_cvt_pk_bf16_f32 v175, v62, v63
  v_pk_fma_f32 v[32:33], v[48:49], v[28:29], v[32:33] op_sel_hi:[1,0,1] neg_lo:[0,0,1] neg_hi:[0,0,1]
  v_pk_fma_f32 v[34:35], v[50:51], v[28:29], v[34:35] op_sel_hi:[1,0,1] neg_lo:[0,0,1] neg_hi:[0,0,1]
  v_pk_fma_f32 v[36:37], v[52:53], v[28:29], v[36:37] op_sel_hi:[1,0,1] neg_lo:[0,0,1] neg_hi:[0,0,1]
  v_pk_fma_f32 v[38:39], v[54:55], v[28:29], v[38:39] op_sel_hi:[1,0,1] neg_lo:[0,0,1] neg_hi:[0,0,1]
  v_pk_fma_f32 v[40:41], v[56:57], v[28:29], v[40:41] op_sel_hi:[1,0,1] neg_lo:[0,0,1] neg_hi:[0,0,1]
  v_pk_fma_f32 v[42:43], v[58:59], v[28:29], v[42:43] op_sel_hi:[1,0,1] neg_lo:[0,0,1] neg_hi:[0,0,1]
  v_pk_fma_f32 v[44:45], v[60:61], v[28:29], v[44:45] op_sel_hi:[1,0,1] neg_lo:[0,0,1] neg_hi:[0,0,1]
  v_pk_fma_f32 v[46:47], v[62:63], v[28:29], v[46:47] op_sel_hi:[1,0,1] neg_lo:[0,0,1] neg_hi:[0,0,1]
  v_cvt_pk_bf16_f32 v176, v32, v33
  v_cvt_pk_bf16_f32 v177, v34, v35
  v_cvt_pk_bf16_f32 v178, v36, v37
  v_cvt_pk_bf16_f32 v179, v38, v39
  v_cvt_pk_bf16_f32 v180, v40, v41
  v_cvt_pk_bf16_f32 v181, v42, v43
  v_cvt_pk_bf16_f32 v182, v44, v45
  v_cvt_pk_bf16_f32 v183, v46, v47
  v_cmp_gt_u32 vcc, 32, v1
  v_mov_b32 v11, 0xffff0000
  s_nop 0
  v_cndmask_b32 v11, -1, v11, vcc
  v_and_b32 v184, v11, v112
  v_mov_b32 v185, v113
  v_mov_b32 v186, v114
  v_mov_b32 v187, v115
  v_bfe_u32 v14, v1, 1, 3
  v_xor_b32 v14, v14, v13
  v_lshlrev_b32 v14, 4, v14
  v_lshl_add_u32 v16, v12, 7, v14
  v_add_u32 v16, 73728, v16
  v_xor_b32 v17, 32, v16
  v_xor_b32 v18, 64, v16
  v_xor_b32 v19, 96, v16
  s_mov_b32 s52, 0x05040100
  s_mov_b32 s53, 0x07060302
  v_lshlrev_b32 v31, 31, v8
  v_xor_b32 v31, 1.0, v31
  v_cmp_eq_u32 vcc, 1, v9
  v_mov_b32 v20, 1.0
  s_nop 0
  v_cndmask_b32 v22, -1.0, v20, vcc
  v_sub_f32 v21, 0, v22
  v_mov_b32 v30, 0
  v_cndmask_b32 v30, -1.0, v30, vcc
  v_cndmask_b32 v23, v30, -1.0, s[40:41]
  v_cndmask_b32 v20, v20, 0, s[40:41]
  v_cndmask_b32 v21, v21, 0, s[40:41]
  v_mov_b32 v11, 0xbfa00000
  v_cmp_eq_u32 vcc, 64, v10
  s_nop 1
  v_cndmask_b32 v23, v23, v11, vcc
  v_cmp_eq_u32 vcc, 128, v10
  s_nop 1
  v_cndmask_b32 v23, v23, v11, vcc
  v_cmp_eq_u32 vcc, 32, v10
  s_nop 1
  v_cndmask_b32 v30, v30, v11, vcc
  v_mov_b32 v11, 0x440fc000
  v_cmp_eq_u32 vcc, 0, v10
  s_nop 1
  v_cndmask_b32 v23, v23, v11, vcc
  v_lshlrev_b32 v11, 4, v13
  v_add_u32 v11, 110592, v11
  s_mul_i32 s39, s28, 4864
  s_add_u32 s39, s39, 111616
  v_and_b32 v24, 15, v1
  v_mul_u32_u24 v24, 144, v24
  v_lshl_add_u32 v24, v9, 6, v24
  v_add_u32 v29, 2304, v24
  v_mov_b32 v5, 4608
  v_cndmask_b32 v24, v24, v5, s[40:41]
  v_mov_b32 v5, 4672
  v_cndmask_b32 v29, v29, v5, s[40:41]
  v_lshl_add_u32 v5, v13, 4, s39
  v_add_u32 v24, v24, v5
  v_add_u32 v29, v29, v5
  v_lshrrev_b32 v26, 3, v1
  v_and_b32 v27, 7, v1
  v_lshlrev_b32 v27, 4, v27
  v_mul_u32_u24 v25, 144, v26
  s_waitcnt lgkmcnt(0)
  s_barrier
  ds_read_b128 v[64:67], v16 offset:0
  ds_read_b128 v[68:71], v17 offset:0
  ds_read_b128 v[72:75], v18 offset:0
  ds_read_b128 v[76:79], v19 offset:0
  ds_read_b128 v[80:83], v16 offset:4096
  ds_read_b128 v[84:87], v17 offset:4096
  s_waitcnt lgkmcnt(5)
  v_perm_b32 v96, v65, v64, s52
  v_perm_b32 v97, v67, v66, s52
  s_waitcnt lgkmcnt(4)
  v_perm_b32 v98, v69, v68, s52
  v_perm_b32 v99, v71, v70, s52
  v_perm_b32 v100, v65, v64, s53
  v_perm_b32 v101, v67, v66, s53
  v_perm_b32 v102, v69, v68, s53
  v_perm_b32 v103, v71, v70, s53
  v_mfma_f32_32x32x16_bf16 v[32:47], v[96:99], v[184:187], 0
  s_waitcnt lgkmcnt(2)
  ds_read_b128 v[88:91], v18 offset:4096
  v_perm_b32 v104, v73, v72, s52
  v_perm_b32 v105, v75, v74, s52
  v_perm_b32 v106, v77, v76, s52
  v_perm_b32 v107, v79, v78, s52
  v_add3_u32 v25, v25, v27, s39
  v_mov_b32 v252, 0
  v_mov_b32 v253, 0
  v_mov_b32 v254, 0
  v_mfma_f32_32x32x16_bf16 v[48:63], v[100:103], v[116:119], 0
  ds_read_b128 v[92:95], v19 offset:4096
  v_perm_b32 v108, v73, v72, s53
  v_perm_b32 v109, v75, v74, s53
  v_perm_b32 v110, v77, v76, s53
  v_perm_b32 v111, v79, v78, s53
  v_mov_b32 v255, 0
  ds_write_b128 v25, v[252:255]
  ds_write_b128 v25, v[252:255] offset:2304
  v_lshl_add_u32 v10, v26, 13, v27
  v_mfma_f32_32x32x16_bf16 v[32:47], v[104:107], v[120:123], v[32:47]
  s_waitcnt lgkmcnt(4)
  ds_read_b128 v[64:67], v16 offset:8192
  v_perm_b32 v96, v81, v80, s52
  v_perm_b32 v97, v83, v82, s52
  v_perm_b32 v98, v85, v84, s52
  v_perm_b32 v99, v87, v86, s52
  v_sub_u32 v26, 7, v26
  v_lshl_add_u32 v26, v26, 13, v27
  v_lshlrev_b32 v5, 23, v1
  v_and_b32 v5, 0x1c000000, v5
  v_mfma_f32_32x32x16_bf16 v[48:63], v[108:111], v[124:127], v[48:63]
  ds_read_b128 v[68:71], v17 offset:8192
  v_perm_b32 v100, v81, v80, s53
  v_perm_b32 v101, v83, v82, s53
  v_perm_b32 v102, v85, v84, s53
  v_perm_b32 v103, v87, v86, s53
  v_add_u32 v27, v27, v5
  s_lshl_b32 s47, s29, 7
  s_lshl_b32 s46, s32, 17
  s_sub_u32 s45, 2301952, s46
  v_mfma_f32_32x32x16_bf16 v[32:47], v[96:99], v[128:131], v[32:47]
  s_waitcnt lgkmcnt(4)
  ds_read_b128 v[72:75], v18 offset:8192
  v_perm_b32 v104, v89, v88, s52
  v_perm_b32 v105, v91, v90, s52
  v_perm_b32 v106, v93, v92, s52
  v_perm_b32 v107, v95, v94, s52
  s_add_u32 s45, s45, s47
  s_add_u32 s46, s46, s47
  s_add_u32 s47, s47, 1179648
  s_cmp_eq_u32 s32, 0
  v_mfma_f32_32x32x16_bf16 v[48:63], v[100:103], v[132:135], v[48:63]
  ds_read_b128 v[76:79], v19 offset:8192
  v_perm_b32 v108, v89, v88, s53
  v_perm_b32 v109, v91, v90, s53
  v_perm_b32 v110, v93, v92, s53
  v_perm_b32 v111, v95, v94, s53
  s_cselect_b32 s47, s47, 0x1000000
  s_lshl_b32 s43, s32, 12
  s_mul_i32 s35, s29, 36864
  s_add_u32 s35, s35, s43
  v_mfma_f32_32x32x16_bf16 v[32:47], v[104:107], v[136:139], v[32:47]
  s_waitcnt lgkmcnt(2)
  s_barrier
  ds_read_b128 v[80:83], v16 offset:12288
  v_perm_b32 v96, v65, v64, s52
  v_perm_b32 v97, v67, v66, s52
  v_perm_b32 v98, v69, v68, s52
  v_perm_b32 v99, v71, v70, s52
  v_lshlrev_b32 v15, 4, v1
  s_mov_b32 s12, s6
  s_mov_b32 s13, s7
  s_mov_b32 s14, 2375680
  v_mfma_f32_32x32x16_bf16 v[48:63], v[108:111], v[140:143], v[48:63]
  ds_read_b128 v[84:87], v17 offset:12288
  v_perm_b32 v100, v65, v64, s53
  v_perm_b32 v101, v67, v66, s53
  v_perm_b32 v102, v69, v68, s53
  v_perm_b32 v103, v71, v70, s53
  s_mov_b32 s15, 0x20000
  s_add_u32 s16, s6, 4784128
  s_addc_u32 s17, s7, 0
  s_mov_b32 s18, 2359296
  v_mfma_f32_32x32x16_bf16 v[32:47], v[96:99], v[144:147], v[32:47]
  s_waitcnt lgkmcnt(2)
  ds_read_b128 v[88:91], v18 offset:12288
  v_perm_b32 v104, v73, v72, s52
  v_perm_b32 v105, v75, v74, s52
  v_perm_b32 v106, v77, v76, s52
  v_perm_b32 v107, v79, v78, s52
  s_mov_b32 s19, 0x20000
  v_mfma_f32_32x32x16_bf16 v[48:63], v[100:103], v[148:151], v[48:63]
  ds_read_b128 v[92:95], v19 offset:12288
  v_perm_b32 v108, v73, v72, s53
  v_perm_b32 v109, v75, v74, s53
  v_perm_b32 v110, v77, v76, s53
  v_perm_b32 v111, v79, v78, s53
  v_mfma_f32_32x32x16_bf16 v[32:47], v[104:107], v[152:155], v[32:47]
  s_waitcnt lgkmcnt(2)
  ds_read_b128 v[64:67], v16 offset:16384
  v_perm_b32 v96, v81, v80, s52
  v_perm_b32 v97, v83, v82, s52
  v_perm_b32 v98, v85, v84, s52
  v_perm_b32 v99, v87, v86, s52
  v_mfma_f32_32x32x16_bf16 v[48:63], v[108:111], v[156:159], v[48:63]
  ds_read_b128 v[68:71], v17 offset:16384
  v_perm_b32 v100, v81, v80, s53
  v_perm_b32 v101, v83, v82, s53
  v_perm_b32 v102, v85, v84, s53
  v_perm_b32 v103, v87, v86, s53
  v_mfma_f32_32x32x16_bf16 v[32:47], v[96:99], v[160:163], v[32:47]
  s_waitcnt lgkmcnt(2)
  ds_read_b128 v[72:75], v18 offset:16384
  v_perm_b32 v104, v89, v88, s52
  v_perm_b32 v105, v91, v90, s52
  v_perm_b32 v106, v93, v92, s52
  v_perm_b32 v107, v95, v94, s52
  v_mfma_f32_32x32x16_bf16 v[48:63], v[100:103], v[164:167], v[48:63]
  ds_read_b128 v[76:79], v19 offset:16384
  v_perm_b32 v108, v89, v88, s53
  v_perm_b32 v109, v91, v90, s53
  v_perm_b32 v110, v93, v92, s53
  v_perm_b32 v111, v95, v94, s53
  v_mfma_f32_32x32x16_bf16 v[32:47], v[104:107], v[168:171], v[32:47]
  s_waitcnt lgkmcnt(2)
  ds_read_b128 v[80:83], v16 offset:20480
  v_perm_b32 v96, v65, v64, s52
  v_perm_b32 v97, v67, v66, s52
  v_perm_b32 v98, v69, v68, s52
  v_perm_b32 v99, v71, v70, s52
  v_mfma_f32_32x32x16_bf16 v[48:63], v[108:111], v[172:175], v[48:63]
  ds_read_b128 v[84:87], v17 offset:20480
  v_perm_b32 v100, v65, v64, s53
  v_perm_b32 v101, v67, v66, s53
  v_perm_b32 v102, v69, v68, s53
  v_perm_b32 v103, v71, v70, s53
  v_mfma_f32_32x32x16_bf16 v[32:47], v[96:99], v[176:179], v[32:47]
  s_waitcnt lgkmcnt(2)
  ds_read_b128 v[88:91], v18 offset:20480
  v_perm_b32 v104, v73, v72, s52
  v_perm_b32 v105, v75, v74, s52
  v_perm_b32 v106, v77, v76, s52
  v_perm_b32 v107, v79, v78, s52
  v_mfma_f32_32x32x16_bf16 v[48:63], v[100:103], v[180:183], v[48:63]
  ds_read_b128 v[92:95], v19 offset:20480
  v_perm_b32 v108, v73, v72, s53
  v_perm_b32 v109, v75, v74, s53
  v_perm_b32 v110, v77, v76, s53
  v_perm_b32 v111, v79, v78, s53
  v_mfma_f32_32x32x16_bf16 v[188:203], v[104:107], v[112:115], 0
  s_waitcnt lgkmcnt(2)
  ds_read_b128 v[64:67], v16 offset:24576
  v_add_u32 v14, s43, v16
  ds_read_b128 v[220:223], v14
  v_perm_b32 v96, v81, v80, s52
  v_perm_b32 v97, v83, v82, s52
  v_perm_b32 v98, v85, v84, s52
  v_perm_b32 v99, v87, v86, s52
  v_mfma_f32_32x32x16_bf16 v[204:219], v[108:111], v[116:119], 0
  ds_read_b128 v[68:71], v17 offset:24576
  v_add_u32 v14, s43, v17
  ds_read_b128 v[224:227], v14
  v_perm_b32 v100, v81, v80, s53
  v_perm_b32 v101, v83, v82, s53
  v_perm_b32 v102, v85, v84, s53
  v_perm_b32 v103, v87, v86, s53
  v_mfma_f32_32x32x16_bf16 v[188:203], v[96:99], v[120:123], v[188:203]
  s_waitcnt lgkmcnt(4)
  ds_read_b128 v[72:75], v18 offset:24576
  v_add_u32 v14, s43, v18
  ds_read_b128 v[228:231], v14
  v_perm_b32 v104, v89, v88, s52
  v_perm_b32 v105, v91, v90, s52
  v_perm_b32 v106, v93, v92, s52
  v_perm_b32 v107, v95, v94, s52
  v_mfma_f32_32x32x16_bf16 v[204:219], v[100:103], v[124:127], v[204:219]
  ds_read_b128 v[76:79], v19 offset:24576
  v_add_u32 v14, s43, v19
  ds_read_b128 v[232:235], v14
  v_perm_b32 v108, v89, v88, s53
  v_perm_b32 v109, v91, v90, s53
  v_perm_b32 v110, v93, v92, s53
  v_perm_b32 v111, v95, v94, s53
  v_mfma_f32_32x32x16_bf16 v[188:203], v[104:107], v[128:131], v[188:203]
  s_waitcnt lgkmcnt(5)
  ds_read_b128 v[80:83], v16 offset:28672
  v_perm_b32 v96, v65, v64, s52
  v_perm_b32 v97, v67, v66, s52
  v_perm_b32 v98, v69, v68, s52
  v_perm_b32 v99, v71, v70, s52
  v_mfma_f32_32x32x16_bf16 v[204:219], v[108:111], v[132:135], v[204:219]
  ds_read_b128 v[84:87], v17 offset:28672
  v_perm_b32 v100, v65, v64, s53
  v_perm_b32 v101, v67, v66, s53
  v_perm_b32 v102, v69, v68, s53
  v_perm_b32 v103, v71, v70, s53
  v_mfma_f32_32x32x16_bf16 v[188:203], v[96:99], v[136:139], v[188:203]
  s_waitcnt lgkmcnt(3)
  ds_read_b128 v[88:91], v18 offset:28672
  v_perm_b32 v104, v73, v72, s52
  v_perm_b32 v105, v75, v74, s52
  v_perm_b32 v106, v77, v76, s52
  v_perm_b32 v107, v79, v78, s52
  v_mfma_f32_32x32x16_bf16 v[204:219], v[100:103], v[140:143], v[204:219]
  ds_read_b128 v[92:95], v19 offset:28672
  buffer_store_dwordx4 v[220:223], v15, s[16:19], s35 offen sc1
  v_perm_b32 v108, v73, v72, s53
  v_perm_b32 v109, v75, v74, s53
  v_perm_b32 v110, v77, v76, s53
  v_perm_b32 v111, v79, v78, s53
  v_mfma_f32_32x32x16_bf16 v[188:203], v[104:107], v[144:147], v[188:203]
  s_waitcnt lgkmcnt(2)
  ds_read_b128 v[64:67], v16 offset:32768
  v_perm_b32 v96, v81, v80, s52
  v_perm_b32 v97, v83, v82, s52
  v_perm_b32 v98, v85, v84, s52
  v_perm_b32 v99, v87, v86, s52
  v_mfma_f32_32x32x16_bf16 v[204:219], v[108:111], v[148:151], v[204:219]
  ds_read_b128 v[68:71], v17 offset:32768
  buffer_store_dwordx4 v[224:227], v15, s[16:19], s35 offen offset:1024 sc1
  v_perm_b32 v100, v81, v80, s53
  v_perm_b32 v101, v83, v82, s53
  v_perm_b32 v102, v85, v84, s53
  v_perm_b32 v103, v87, v86, s53
  v_mfma_f32_32x32x16_bf16 v[188:203], v[96:99], v[152:155], v[188:203]
  s_waitcnt lgkmcnt(2)
  ds_read_b128 v[72:75], v18 offset:32768
  v_perm_b32 v104, v89, v88, s52
  v_perm_b32 v105, v91, v90, s52
  v_perm_b32 v106, v93, v92, s52
  v_perm_b32 v107, v95, v94, s52
  v_mfma_f32_32x32x16_bf16 v[204:219], v[100:103], v[156:159], v[204:219]
  ds_read_b128 v[76:79], v19 offset:32768
  buffer_store_dwordx4 v[228:231], v15, s[16:19], s35 offen offset:2048 sc1
  v_perm_b32 v108, v89, v88, s53
  v_perm_b32 v109, v91, v90, s53
  v_perm_b32 v110, v93, v92, s53
  v_perm_b32 v111, v95, v94, s53
  v_mfma_f32_32x32x16_bf16 v[188:203], v[104:107], v[160:163], v[188:203]
  s_waitcnt lgkmcnt(2)
  v_perm_b32 v96, v65, v64, s52
  v_perm_b32 v97, v67, v66, s52
  v_perm_b32 v98, v69, v68, s52
  v_perm_b32 v99, v71, v70, s52
  v_mfma_f32_32x32x16_bf16 v[204:219], v[108:111], v[164:167], v[204:219]
  buffer_store_dwordx4 v[232:235], v15, s[16:19], s35 offen offset:3072 sc1
  v_perm_b32 v100, v65, v64, s53
  v_perm_b32 v101, v67, v66, s53
  v_perm_b32 v102, v69, v68, s53
  v_perm_b32 v103, v71, v70, s53
  v_mfma_f32_32x32x16_bf16 v[188:203], v[96:99], v[168:171], v[188:203]
  s_waitcnt lgkmcnt(0)
  v_perm_b32 v104, v73, v72, s52
  v_perm_b32 v105, v75, v74, s52
  v_perm_b32 v106, v77, v76, s52
  v_perm_b32 v107, v79, v78, s52
  v_mfma_f32_32x32x16_bf16 v[204:219], v[100:103], v[172:175], v[204:219]
  v_perm_b32 v108, v73, v72, s53
  v_perm_b32 v109, v75, v74, s53
  v_perm_b32 v110, v77, v76, s53
  v_perm_b32 v111, v79, v78, s53
  v_mfma_f32_32x32x16_bf16 v[188:203], v[104:107], v[176:179], v[188:203]
  s_nop 0
  v_mfma_f32_32x32x16_bf16 v[204:219], v[108:111], v[180:183], v[204:219]
  s_nop 9
  v_fmac_f32 v32, v188, v31
  v_fmac_f32 v33, v189, v31
  v_fmac_f32 v34, v190, v31
  v_fmac_f32 v35, v191, v31
  v_fmac_f32 v36, v192, v31
  v_fmac_f32 v37, v193, v31
  v_fmac_f32 v38, v194, v31
  v_fmac_f32 v39, v195, v31
  v_fmac_f32 v40, v196, v31
  v_fmac_f32 v41, v197, v31
  v_fmac_f32 v42, v198, v31
  v_fmac_f32 v43, v199, v31
  v_fmac_f32 v44, v200, v31
  v_fmac_f32 v45, v201, v31
  v_fmac_f32 v46, v202, v31
  v_fmac_f32 v47, v203, v31
  v_fmac_f32 v48, v204, v31
  v_fmac_f32 v49, v205, v31
  v_fmac_f32 v50, v206, v31
  v_fmac_f32 v51, v207, v31
  v_fmac_f32 v52, v208, v31
  v_fmac_f32 v53, v209, v31
  v_fmac_f32 v54, v210, v31
  v_fmac_f32 v55, v211, v31
  v_fmac_f32 v56, v212, v31
  v_fmac_f32 v57, v213, v31
  v_fmac_f32 v58, v214, v31
  v_fmac_f32 v59, v215, v31
  v_fmac_f32 v60, v216, v31
  v_fmac_f32 v61, v217, v31
  v_fmac_f32 v62, v218, v31
  v_fmac_f32 v63, v219, v31
  v_mul_f32 v144, v32, v21
  v_mul_f32 v145, v33, v21
  v_mul_f32 v146, v34, v21
  v_mul_f32 v147, v35, v21
  v_mul_f32 v148, v36, v21
  v_mul_f32 v149, v37, v21
  v_mul_f32 v150, v38, v21
  v_mul_f32 v151, v39, v21
  v_mul_f32 v152, v40, v21
  v_mul_f32 v153, v41, v21
  v_mul_f32 v154, v42, v21
  v_mul_f32 v155, v43, v21
  v_mul_f32 v156, v44, v21
  v_mul_f32 v157, v45, v21
  v_mul_f32 v158, v46, v21
  v_mul_f32 v159, v47, v21
  s_barrier
  ds_read_b128 v[112:115], v11 offset:0
  ds_read_b128 v[116:119], v11 offset:32
  ds_read_b128 v[120:123], v11 offset:64
  ds_read_b128 v[124:127], v11 offset:96
  ds_read_b128 v[128:131], v11 offset:128
  ds_read_b128 v[132:135], v11 offset:160
  ds_read_b128 v[136:139], v11 offset:192
  ds_read_b128 v[140:143], v11 offset:224
  v_fmac_f32 v32, v48, v20
  v_fmac_f32 v33, v49, v20
  v_fmac_f32 v34, v50, v20
  v_fmac_f32 v35, v51, v20
  v_fmac_f32 v36, v52, v20
  v_fmac_f32 v37, v53, v20
  v_fmac_f32 v38, v54, v20
  v_fmac_f32 v39, v55, v20
  v_fmac_f32 v40, v56, v20
  v_fmac_f32 v41, v57, v20
  v_fmac_f32 v42, v58, v20
  v_fmac_f32 v43, v59, v20
  v_fmac_f32 v44, v60, v20
  v_fmac_f32 v45, v61, v20
  v_fmac_f32 v46, v62, v20
  v_fmac_f32 v47, v63, v20
  v_fmac_f32 v144, v48, v22
  v_fmac_f32 v145, v49, v22
  v_fmac_f32 v146, v50, v22
  v_fmac_f32 v147, v51, v22
  v_fmac_f32 v148, v52, v22
  v_fmac_f32 v149, v53, v22
  v_fmac_f32 v150, v54, v22
  v_fmac_f32 v151, v55, v22
  v_fmac_f32 v152, v56, v22
  v_fmac_f32 v153, v57, v22
  v_fmac_f32 v154, v58, v22
  v_fmac_f32 v155, v59, v22
  v_fmac_f32 v156, v60, v22
  v_fmac_f32 v157, v61, v22
  v_fmac_f32 v158, v62, v22
  v_fmac_f32 v159, v63, v22
  s_waitcnt lgkmcnt(7)
  v_fmac_f32 v32, v112, v23
  v_fmac_f32 v33, v113, v23
  v_fmac_f32 v34, v114, v23
  v_fmac_f32 v35, v115, v23
  s_waitcnt lgkmcnt(6)
  v_fmac_f32 v36, v116, v23
  v_fmac_f32 v37, v117, v23
  v_fmac_f32 v38, v118, v23
  v_fmac_f32 v39, v119, v23
  s_waitcnt lgkmcnt(5)
  v_fmac_f32 v40, v120, v23
  v_fmac_f32 v41, v121, v23
  v_fmac_f32 v42, v122, v23
  v_fmac_f32 v43, v123, v23
  s_waitcnt lgkmcnt(4)
  v_fmac_f32 v44, v124, v23
  v_fmac_f32 v45, v125, v23
  v_fmac_f32 v46, v126, v23
  v_fmac_f32 v47, v127, v23
  s_waitcnt lgkmcnt(3)
  v_mul_f32 v32, v32, v128
  v_mul_f32 v33, v33, v129
  v_mul_f32 v34, v34, v130
  v_mul_f32 v35, v35, v131
  s_waitcnt lgkmcnt(2)
  v_mul_f32 v36, v36, v132
  v_mul_f32 v37, v37, v133
  v_mul_f32 v38, v38, v134
  v_mul_f32 v39, v39, v135
  v_cvt_pk_bf16_f32 v64, v32, v33
  v_cvt_pk_bf16_f32 v65, v34, v35
  v_cvt_pk_bf16_f32 v66, v36, v37
  v_cvt_pk_bf16_f32 v67, v38, v39
  ds_write_b128 v24, v[64:67] offset:0
  s_waitcnt lgkmcnt(2)
  v_mul_f32 v40, v40, v136
  v_mul_f32 v41, v41, v137
  v_mul_f32 v42, v42, v138
  v_mul_f32 v43, v43, v139
  s_waitcnt lgkmcnt(1)
  v_mul_f32 v44, v44, v140
  v_mul_f32 v45, v45, v141
  v_mul_f32 v46, v46, v142
  v_mul_f32 v47, v47, v143
  v_cvt_pk_bf16_f32 v68, v40, v41
  v_cvt_pk_bf16_f32 v69, v42, v43
  v_cvt_pk_bf16_f32 v70, v44, v45
  v_cvt_pk_bf16_f32 v71, v46, v47
  ds_write_b128 v24, v[68:71] offset:32
  ds_read_b128 v[96:99], v25 offset:0
  ds_read_b128 v[100:103], v25 offset:1152
  v_fmac_f32 v144, v112, v30
  v_fmac_f32 v145, v113, v30
  v_fmac_f32 v146, v114, v30
  v_fmac_f32 v147, v115, v30
  v_fmac_f32 v148, v116, v30
  v_fmac_f32 v149, v117, v30
  v_fmac_f32 v150, v118, v30
  v_fmac_f32 v151, v119, v30
  v_fmac_f32 v152, v120, v30
  v_fmac_f32 v153, v121, v30
  v_fmac_f32 v154, v122, v30
  v_fmac_f32 v155, v123, v30
  v_fmac_f32 v156, v124, v30
  v_fmac_f32 v157, v125, v30
  v_fmac_f32 v158, v126, v30
  v_fmac_f32 v159, v127, v30
  v_mul_f32 v144, v144, v128
  v_mul_f32 v145, v145, v129
  v_mul_f32 v146, v146, v130
  v_mul_f32 v147, v147, v131
  v_mul_f32 v148, v148, v132
  v_mul_f32 v149, v149, v133
  v_mul_f32 v150, v150, v134
  v_mul_f32 v151, v151, v135
  v_cvt_pk_bf16_f32 v72, v144, v145
  v_cvt_pk_bf16_f32 v73, v146, v147
  v_cvt_pk_bf16_f32 v74, v148, v149
  v_cvt_pk_bf16_f32 v75, v150, v151
  ds_write_b128 v29, v[72:75] offset:0
  v_mul_f32 v152, v152, v136
  v_mul_f32 v153, v153, v137
  v_mul_f32 v154, v154, v138
  v_mul_f32 v155, v155, v139
  v_mul_f32 v156, v156, v140
  v_mul_f32 v157, v157, v141
  v_mul_f32 v158, v158, v142
  v_mul_f32 v159, v159, v143
  v_cvt_pk_bf16_f32 v76, v152, v153
  v_cvt_pk_bf16_f32 v77, v154, v155
  v_cvt_pk_bf16_f32 v78, v156, v157
  v_cvt_pk_bf16_f32 v79, v158, v159
  ds_write_b128 v29, v[76:79] offset:32
  s_waitcnt lgkmcnt(3)
  buffer_store_dwordx4 v[96:99], v10, s[12:15], s46 offen sc1
  ds_read_b128 v[80:83], v25 offset:2304
  ds_read_b128 v[84:87], v25 offset:3456
  ds_read_b128 v[88:91], v25 offset:4608
  s_add_u32 s46, s46, 65536
  s_waitcnt lgkmcnt(5)
  buffer_store_dwordx4 v[100:103], v10, s[12:15], s46 offen sc1
  s_waitcnt lgkmcnt(2)
  buffer_store_dwordx4 v[80:83], v26, s[12:15], s45 offen sc1
  s_sub_u32 s45, s45, 65536
  s_waitcnt lgkmcnt(1)
  buffer_store_dwordx4 v[84:87], v26, s[12:15], s45 offen sc1
  s_waitcnt lgkmcnt(0)
  buffer_store_dwordx4 v[88:91], v27, s[12:15], s47 offen sc1
sequential_preLN__spectral_fnet__swiglu_ffn__prompt_kernel_j1:
  s_nop 4
  s_mov_b32 s8, s20
  s_mov_b32 s9, s21
  s_mov_b32 s10, 104
  s_mov_b32 s11, 0x20000
  s_mov_b32 s12, s22
  s_mov_b32 s13, s23
  s_mov_b32 s14, 8388608
  s_mov_b32 s15, 0x20000
  v_min_u32 v4, 25, v1
  v_lshlrev_b32 v4, 2, v4
  s_mov_b32 s42, 0x80000
sequential_preLN__spectral_fnet__swiglu_ffn__prompt_kernel_zw:
  buffer_load_dword v5, v4, s[8:11], 0 offen sc1
  s_lshr_b32 s40, s2, 3
  s_lshl_b32 s40, s40, 7
  s_and_b32 s41, s2, 7
  s_lshl_b32 s41, s41, 2
  s_add_u32 s40, s40, s41
  s_add_u32 s40, s40, 7217152
  s_lshl_b32 s41, s41, 5
  s_lshr_b32 s43, s2, 3
  s_lshl_b32 s43, s43, 2
  s_add_u32 s41, s41, s43
  s_add_u32 s41, s41, 7220128
  s_cmp_ge_u32 s2, 192
  s_cselect_b32 s40, s41, s40
  v_lshlrev_b32 v6, 12, v0
  v_lshrrev_b32 v7, 3, v0
  v_lshl_add_u32 v6, v7, 23, v6
  v_mov_b32 v7, 1
  s_waitcnt vmcnt(0)
  v_cmp_eq_u32 vcc, 0, v5
  s_sub_u32 s42, s42, 1
  s_cbranch_scc1 sequential_preLN__spectral_fnet__swiglu_ffn__prompt_kernel_zg
  s_cmp_eq_u64 vcc, 0
  s_cbranch_scc0 sequential_preLN__spectral_fnet__swiglu_ffn__prompt_kernel_zw
sequential_preLN__spectral_fnet__swiglu_ffn__prompt_kernel_zg:
  s_barrier
  buffer_store_dword v7, v6, s[12:15], s40 offen sc1
  s_load_dwordx4 s[4:7], s[0:1], 48
  s_load_dwordx2 s[36:37], s[0:1], 64
  s_load_dwordx2 s[38:39], s[0:1], 88
  s_and_b32 s30, s2, 7
  s_cmp_ge_u32 s2, 144
  s_cselect_b32 s52, 1, 0
  s_lshr_b32 s53, s2, 3
  s_cmp_ge_u32 s53, 9
  s_cselect_b32 s54, 1, 0
  s_cselect_b32 s55, 9, 0
  s_sub_u32 s53, s53, s55
  s_mul_i32 s55, s30, 9
  s_add_u32 s53, s53, s55
  s_and_b32 s55, s2, 1
  s_cmp_eq_u32 s52, 1
  s_cselect_b32 s54, s55, s54
  s_cselect_b32 s53, 72, s53
  s_cmp_ge_u32 s53, 36
  s_cselect_b32 s56, 0x80008000, 0
  s_lshl_b32 s57, s54, 2
  s_add_u32 s57, s57, s28
  s_xor_b32 s55, s57, 0
  s_lshl_b32 s62, s53, 3
  s_add_u32 s55, s55, s62
  s_sub_u32 s62, 576, s55
  s_min_u32 s55, s55, s62
  s_cmp_eq_u32 s52, 1
  s_cselect_b32 s55, 289, s55
  s_lshl_b32 s58, s55, 13
  s_add_u32 s59, s58, 4096
  s_xor_b32 s55, s57, 4
  s_lshl_b32 s62, s53, 3
  s_add_u32 s55, s55, s62
  s_sub_u32 s62, 576, s55
  s_min_u32 s55, s55, s62
  s_cmp_eq_u32 s52, 1
  s_cselect_b32 s55, 289, s55
  s_lshl_b32 s60, s55, 13
  s_add_u32 s61, s60, 4096
  s_mov_b32 s66, 2375680
  s_lshl_b32 s63, s28, 14
  s_add_u32 s63, s63, 73728
  v_and_b32 v3, 31, v1
  v_lshrrev_b32 v4, 5, v1
  v_lshrrev_b32 v5, 4, v1
  v_xor_b32 v5, v5, v1
  v_lshlrev_b32 v5, 4, v5
  v_xor_b32 v244, 64, v5
  v_cvt_f32_u32 v10, v3
  v_cvt_f32_u32 v11, v4
  v_mul_f32 v11, 4.0, v11
  v_mul_f32 v12, 0x3d000000, v10
  v_mul_f32 v13, v12, v11
  v_mov_b32 v152, v13
  v_fmamk_f32 v153, v12, 0x3f800000, v13
  v_fmamk_f32 v154, v12, 0x40000000, v13
  v_fmamk_f32 v155, v12, 0x40400000, v13
  v_fmamk_f32 v156, v12, 0x41000000, v13
  v_fmamk_f32 v157, v12, 0x41100000, v13
  v_fmamk_f32 v158, v12, 0x41200000, v13
  v_fmamk_f32 v159, v12, 0x41300000, v13
  v_fmamk_f32 v160, v12, 0x41800000, v13
  v_fmamk_f32 v161, v12, 0x41880000, v13
  v_fmamk_f32 v162, v12, 0x41900000, v13
  v_fmamk_f32 v163, v12, 0x41980000, v13
  v_fmamk_f32 v164, v12, 0x41c00000, v13
  v_fmamk_f32 v165, v12, 0x41c80000, v13
  v_fmamk_f32 v166, v12, 0x41d00000, v13
  v_fmamk_f32 v167, v12, 0x41d80000, v13
  v_cos_f32 v168, v152
  v_sin_f32 v152, v152
  v_cos_f32 v169, v153
  v_sin_f32 v153, v153
  v_cos_f32 v170, v154
  v_sin_f32 v154, v154
  v_cos_f32 v171, v155
  v_sin_f32 v155, v155
  v_cos_f32 v172, v156
  v_sin_f32 v156, v156
  v_cos_f32 v173, v157
  v_sin_f32 v157, v157
  v_cos_f32 v174, v158
  v_sin_f32 v158, v158
  v_cos_f32 v175, v159
  v_sin_f32 v159, v159
  v_cos_f32 v176, v160
  v_sin_f32 v160, v160
  v_cos_f32 v177, v161
  v_sin_f32 v161, v161
  v_cos_f32 v178, v162
  v_sin_f32 v162, v162
  v_cos_f32 v179, v163
  v_sin_f32 v163, v163
  v_cos_f32 v180, v164
  v_sin_f32 v164, v164
  v_cos_f32 v181, v165
  v_sin_f32 v165, v165
  v_cos_f32 v182, v166
  v_sin_f32 v166, v166
  v_cos_f32 v183, v167
  v_sin_f32 v167, v167
  s_waitcnt lgkmcnt(0)
  s_bfe_u32 s45, s2, 0x10003
  s_bfe_u32 s44, s2, 0x20003
  s_mul_i32 s31, s30, 1152
  s_and_b32 s40, s28, 1
  s_lshl_b32 s40, s40, 2
  s_lshr_b32 s41, s28, 1
  s_add_u32 s40, s40, s41
  s_mul_i32 s40, s40, 36864
  s_lshl_b32 s46, s44, 8
  s_add_u32 s46, s46, s40
  s_add_u32 s46, s46, s31
  s_mul_i32 s32, s28, 9216
  v_and_b32 v225, 3, v1
  v_bfe_u32 v227, v1, 4, 1
  v_lshlrev_b32 v224, 1, v227
  v_xor_b32 v225, v225, v224
  v_lshlrev_b32 v225, 4, v225
  v_lshrrev_b32 v226, 5, v1
  v_lshl_add_u32 v226, v226, 6, v225
  v_bfe_u32 v224, v1, 2, 2
  v_lshl_add_u32 v224, v227, 3, v224
  v_mul_u32_u24 v200, 9216, v224
  v_add_u32 v200, v200, v226
  v_lshrrev_b32 v224, 4, v1
  v_add_u32 v201, 293888, v200
  v_add_u32 v202, 587776, v200
  v_add_u32 v203, 881664, v200
  v_and_b32 v222, 15, v1
  v_lshlrev_b32 v222, 4, v222
  v_lshl_add_u32 v222, v224, 9, v222
  s_mov_b32 s8, s4
  s_mov_b32 s9, s5
  s_mov_b32 s10, 5308416
  s_mov_b32 s11, 0x20000
  s_mov_b32 s12, s6
  s_mov_b32 s13, s7
  s_mov_b32 s14, 5308416
  s_mov_b32 s15, 0x20000
  s_mov_b32 s20, s38
  s_mov_b32 s21, s39
  s_mov_b32 s22, 8388608
  s_mov_b32 s23, 0x20000
  s_cmp_ge_u32 s2, 146
  s_cbranch_scc1 sequential_preLN__spectral_fnet__swiglu_ffn__prompt_kernel_nofft
  s_mov_b32 s64, s38
  s_mov_b32 s65, s39
  s_mov_b32 s67, 0x20000
  v_cvt_pk_bf16_f32 v16, v168, v169
  v_cvt_pk_bf16_f32 v48, v152, v153
  v_cvt_pk_bf16_f32 v17, v170, v171
  v_cvt_pk_bf16_f32 v49, v154, v155
  v_cvt_pk_bf16_f32 v18, v172, v173
  v_cvt_pk_bf16_f32 v50, v156, v157
  v_cvt_pk_bf16_f32 v19, v174, v175
  v_cvt_pk_bf16_f32 v51, v158, v159
  v_cvt_pk_bf16_f32 v20, v176, v177
  v_cvt_pk_bf16_f32 v52, v160, v161
  v_cvt_pk_bf16_f32 v21, v178, v179
  v_cvt_pk_bf16_f32 v53, v162, v163
  v_cvt_pk_bf16_f32 v22, v180, v181
  v_cvt_pk_bf16_f32 v54, v164, v165
  v_cvt_pk_bf16_f32 v23, v182, v183
  v_cvt_pk_bf16_f32 v55, v166, v167
  v_xor_b32 v24, 0x80008000, v48
  v_xor_b32 v40, s56, v16
  v_xor_b32 v32, s56, v48
  v_xor_b32 v25, 0x80008000, v49
  v_xor_b32 v41, s56, v17
  v_xor_b32 v33, s56, v49
  v_xor_b32 v26, 0x80008000, v50
  v_xor_b32 v42, s56, v18
  v_xor_b32 v34, s56, v50
  v_xor_b32 v27, 0x80008000, v51
  v_xor_b32 v43, s56, v19
  v_xor_b32 v35, s56, v51
  v_xor_b32 v28, 0x80008000, v52
  v_xor_b32 v44, s56, v20
  v_xor_b32 v36, s56, v52
  v_xor_b32 v29, 0x80008000, v53
  v_xor_b32 v45, s56, v21
  v_xor_b32 v37, s56, v53
  v_xor_b32 v30, 0x80008000, v54
  v_xor_b32 v46, s56, v22
  v_xor_b32 v38, s56, v54
  v_xor_b32 v31, 0x80008000, v55
  v_xor_b32 v47, s56, v23
  v_xor_b32 v39, s56, v55
  s_lshl_b32 s55, s54, 5
  v_add_u32 v10, s55, v3
  v_cvt_f32_u32 v10, v10
  v_fmac_f32 v13, 0x3c800000, v10
  v_mov_b32 v220, v12
  v_mov_b32 v221, v13
  v_mul_f32 v8, 0x3a000000, v10
  v_mul_f32 v9, v8, v11
  v_bfe_u32 v12, v1, 1, 3
  v_xor_b32 v10, v12, v4
  v_lshlrev_b32 v10, 4, v10
  v_lshl_add_u32 v10, v3, 7, v10
  v_add_u32 v240, s63, v10
  v_xor_b32 v241, 32, v240
  v_xor_b32 v242, 64, v240
  v_xor_b32 v243, 96, v240
  v_bfe_u32 v12, v1, 2, 2
  v_mul_u32_u24 v14, 72, v3
  v_lshl_add_u32 v14, v4, 3, v14
  s_mul_i32 s55, s57, 2368
  s_add_u32 s55, s55, 139264
  v_add_u32 v2, s55, v14
  s_xor_b32 s55, s57, 4
  s_mul_i32 s55, s55, 2368
  s_add_u32 s55, s55, 139264
  v_add_u32 v14, s55, v14
  v_mul_u32_u24 v15, 2368, v12
  v_and_b32 v12, 3, v1
  v_lshl_add_u32 v15, v12, 3, v15
  v_bfe_u32 v12, v1, 4, 1
  v_lshl_add_u32 v15, v12, 5, v15
  v_mul_u32_u24 v12, 72, v4
  s_mul_i32 s55, s28, 576
  s_add_u32 s55, s55, 139264
  v_add3_u32 v15, v15, v12, s55
  v_mul_u32_u24 v7, 36864, v4
  v_lshl_add_u32 v7, v3, 4, v7
  v_lshlrev_b32 v6, 2, v1
  s_lshl_b32 s68, s54, 2
  s_add_u32 s68, s68, s28
  s_lshl_b32 s69, s68, 10
  s_add_u32 s69, s69, 7143424
  s_mul_i32 s68, s68, 294912
  s_lshl_b32 s55, s53, 9
  s_add_u32 s68, s68, s55
  s_mov_b32 s70, 0x00003f80
  s_mov_b32 s71, 0x3f800000
  s_cmp_lg_u32 s28, 0
  s_cbranch_scc1 sequential_preLN__spectral_fnet__swiglu_ffn__prompt_kernel_tg
  v_lshrrev_b32 v12, 3, v1
  v_and_b32 v13, 7, v1
  v_lshlrev_b32 v13, 2, v13
  v_lshl_add_u32 v12, v12, 7, v13
  s_lshl_b32 s55, s30, 12
  s_add_u32 s55, s55, 7217152
  s_mov_b32 s62, 0x80000
sequential_preLN__spectral_fnet__swiglu_ffn__prompt_kernel_tw:
  buffer_load_dword v248, v12, s[20:23], s55 offen sc1
  buffer_load_dword v249, v12, s[20:23], s55 offen offset:1024 sc1
  buffer_load_dword v250, v12, s[20:23], s55 offen offset:2048 sc1
  s_waitcnt vmcnt(0)
  v_min3_u32 v248, v248, v249, v250
  v_cmp_eq_u32 vcc, 0, v248
  s_sub_u32 s62, s62, 1
  s_cbranch_scc1 sequential_preLN__spectral_fnet__swiglu_ffn__prompt_kernel_tg
  s_cmp_eq_u64 vcc, 0
  s_cbranch_scc0 sequential_preLN__spectral_fnet__swiglu_ffn__prompt_kernel_tw
sequential_preLN__spectral_fnet__swiglu_ffn__prompt_kernel_tg:
  s_waitcnt vmcnt(0)
  s_barrier
  s_add_u32 m0, s63, 0
  s_nop 0
  buffer_load_dwordx4 v5, s[64:67], s58 offen sc1 lds
  buffer_load_dwordx4 v244, s[64:67], s58 offen offset:1024 sc1 lds
  buffer_load_dwordx4 v5, s[64:67], s58 offen offset:2048 sc1 lds
  buffer_load_dwordx4 v244, s[64:67], s58 offen offset:3072 sc1 lds
  s_add_u32 m0, s63, 4096
  s_nop 0
  buffer_load_dwordx4 v5, s[64:67], s59 offen sc1 lds
  buffer_load_dwordx4 v244, s[64:67], s59 offen offset:1024 sc1 lds
  buffer_load_dwordx4 v5, s[64:67], s59 offen offset:2048 sc1 lds
  buffer_load_dwordx4 v244, s[64:67], s59 offen offset:3072 sc1 lds
  s_add_u32 m0, s63, 8192
  s_nop 0
  buffer_load_dwordx4 v5, s[64:67], s60 offen sc1 lds
  buffer_load_dwordx4 v244, s[64:67], s60 offen offset:1024 sc1 lds
  buffer_load_dwordx4 v5, s[64:67], s60 offen offset:2048 sc1 lds
  buffer_load_dwordx4 v244, s[64:67], s60 offen offset:3072 sc1 lds
  v_mov_b32 v12, v220
  v_mov_b32 v13, v221
  v_mov_b32 v152, v13
  v_fmamk_f32 v153, v12, 0x3f800000, v13
  v_fmamk_f32 v154, v12, 0x40000000, v13
  v_fmamk_f32 v155, v12, 0x40400000, v13
  v_fmamk_f32 v156, v12, 0x41000000, v13
  v_fmamk_f32 v157, v12, 0x41100000, v13
  v_fmamk_f32 v158, v12, 0x41200000, v13
  v_fmamk_f32 v159, v12, 0x41300000, v13
  v_fmamk_f32 v160, v12, 0x41800000, v13
  v_fmamk_f32 v161, v12, 0x41880000, v13
  v_fmamk_f32 v162, v12, 0x41900000, v13
  v_fmamk_f32 v163, v12, 0x41980000, v13
  v_fmamk_f32 v164, v12, 0x41c00000, v13
  v_fmamk_f32 v165, v12, 0x41c80000, v13
  v_fmamk_f32 v166, v12, 0x41d00000, v13
  v_fmamk_f32 v167, v12, 0x41d80000, v13
  v_cos_f32 v168, v152
  v_sin_f32 v152, v152
  v_cos_f32 v169, v153
  v_sin_f32 v153, v153
  v_cos_f32 v170, v154
  v_sin_f32 v154, v154
  v_cos_f32 v171, v155
  v_sin_f32 v155, v155
  v_cos_f32 v172, v156
  v_sin_f32 v156, v156
  v_cos_f32 v173, v157
  v_sin_f32 v157, v157
  v_cos_f32 v174, v158
  v_sin_f32 v158, v158
  v_cos_f32 v175, v159
  v_sin_f32 v159, v159
  v_cos_f32 v176, v160
  v_sin_f32 v160, v160
  v_cos_f32 v177, v161
  v_sin_f32 v161, v161
  v_cos_f32 v178, v162
  v_sin_f32 v162, v162
  v_cos_f32 v179, v163
  v_sin_f32 v163, v163
  v_cos_f32 v180, v164
  v_sin_f32 v164, v164
  v_cos_f32 v181, v165
  v_sin_f32 v165, v165
  v_cos_f32 v182, v166
  v_sin_f32 v166, v166
  v_cos_f32 v183, v167
  v_sin_f32 v167, v167
  v_cvt_pk_bf16_f32 v56, v168, v169
  v_cvt_pk_bf16_f32 v72, v152, v153
  v_cvt_pk_bf16_f32 v57, v170, v171
  v_cvt_pk_bf16_f32 v73, v154, v155
  v_cvt_pk_bf16_f32 v58, v172, v173
  v_cvt_pk_bf16_f32 v74, v156, v157
  v_cvt_pk_bf16_f32 v59, v174, v175
  v_cvt_pk_bf16_f32 v75, v158, v159
  v_cvt_pk_bf16_f32 v60, v176, v177
  v_cvt_pk_bf16_f32 v76, v160, v161
  v_cvt_pk_bf16_f32 v61, v178, v179
  v_cvt_pk_bf16_f32 v77, v162, v163
  v_cvt_pk_bf16_f32 v62, v180, v181
  v_cvt_pk_bf16_f32 v78, v164, v165
  v_cvt_pk_bf16_f32 v63, v182, v183
  v_cvt_pk_bf16_f32 v79, v166, v167
  v_xor_b32 v64, 0x80008000, v72
  v_xor_b32 v80, s56, v56
  v_xor_b32 v72, s56, v72
  v_xor_b32 v65, 0x80008000, v73
  v_xor_b32 v81, s56, v57
  v_xor_b32 v73, s56, v73
  v_xor_b32 v66, 0x80008000, v74
  v_xor_b32 v82, s56, v58
  v_xor_b32 v74, s56, v74
  v_xor_b32 v67, 0x80008000, v75
  v_xor_b32 v83, s56, v59
  v_xor_b32 v75, s56, v75
  v_xor_b32 v68, 0x80008000, v76
  v_xor_b32 v84, s56, v60
  v_xor_b32 v76, s56, v76
  v_xor_b32 v69, 0x80008000, v77
  v_xor_b32 v85, s56, v61
  v_xor_b32 v77, s56, v77
  v_xor_b32 v70, 0x80008000, v78
  v_xor_b32 v86, s56, v62
  v_xor_b32 v78, s56, v78
  v_xor_b32 v71, 0x80008000, v79
  v_xor_b32 v87, s56, v63
  v_xor_b32 v79, s56, v79
  v_mov_b32 v104, v9
  v_fmamk_f32 v105, v8, 0x3f800000, v9
  v_fmamk_f32 v106, v8, 0x40000000, v9
  v_fmamk_f32 v107, v8, 0x40400000, v9
  v_fmamk_f32 v108, v8, 0x41000000, v9
  v_fmamk_f32 v109, v8, 0x41100000, v9
  v_fmamk_f32 v110, v8, 0x41200000, v9
  v_fmamk_f32 v111, v8, 0x41300000, v9
  v_fmamk_f32 v112, v8, 0x41800000, v9
  v_fmamk_f32 v113, v8, 0x41880000, v9
  v_fmamk_f32 v114, v8, 0x41900000, v9
  v_fmamk_f32 v115, v8, 0x41980000, v9
  v_fmamk_f32 v116, v8, 0x41c00000, v9
  v_fmamk_f32 v117, v8, 0x41c80000, v9
  v_fmamk_f32 v118, v8, 0x41d00000, v9
  v_fmamk_f32 v119, v8, 0x41d80000, v9
  v_cos_f32 v88, v104
  v_sin_f32 v104, v104
  v_cos_f32 v89, v105
  v_sin_f32 v105, v105
  v_cos_f32 v90, v106
  v_sin_f32 v106, v106
  v_cos_f32 v91, v107
  v_sin_f32 v107, v107
  s_add_u32 m0, s63, 12288
  s_nop 0
  buffer_load_dwordx4 v5, s[64:67], s61 offen sc1 lds
  buffer_load_dwordx4 v244, s[64:67], s61 offen offset:1024 sc1 lds
  buffer_load_dwordx4 v5, s[64:67], s61 offen offset:2048 sc1 lds
  buffer_load_dwordx4 v244, s[64:67], s61 offen offset:3072 sc1 lds
  s_waitcnt vmcnt(12)
  ds_read_b128 a[0:3], v240 offset:0
  ds_read_b128 a[4:7], v241 offset:0
  ds_read_b128 a[16:19], v242 offset:0
  ds_read_b128 a[20:23], v243 offset:0
  s_waitcnt lgkmcnt(3)
  v_mfma_f32_32x32x16_bf16 v[120:135], a[0:3], v[16:19], 0
  v_cos_f32 v92, v108
  v_sin_f32 v108, v108
  v_cos_f32 v93, v109
  v_sin_f32 v109, v109
  v_cos_f32 v94, v110
  v_mfma_f32_32x32x16_bf16 v[136:151], a[0:3], v[24:27], 0
  v_sin_f32 v110, v110
  v_cos_f32 v95, v111
  v_sin_f32 v111, v111
  v_cos_f32 v96, v112
  v_sin_f32 v112, v112
  s_waitcnt lgkmcnt(2)
  v_mfma_f32_32x32x16_bf16 v[120:135], a[4:7], v[20:23], v[120:135]
  v_cos_f32 v97, v113
  v_sin_f32 v113, v113
  v_cos_f32 v98, v114
  v_sin_f32 v114, v114
  v_cos_f32 v99, v115
  v_mfma_f32_32x32x16_bf16 v[136:151], a[4:7], v[28:31], v[136:151]
  s_waitcnt vmcnt(8)
  ds_read_b128 a[8:11], v240 offset:4096
  ds_read_b128 a[12:15], v241 offset:4096
  ds_read_b128 a[24:27], v242 offset:4096
  ds_read_b128 a[28:31], v243 offset:4096
  v_sin_f32 v115, v115
  v_cos_f32 v100, v116
  v_sin_f32 v116, v116
  s_waitcnt lgkmcnt(5)
  v_mfma_f32_32x32x16_bf16 v[120:135], a[16:19], v[32:35], v[120:135]
  s_add_u32 s55, s68, 4784128
  buffer_load_dwordx4 v[204:207], v7, s[20:23], s55 offen sc1
  buffer_load_dword v228, v6, s[20:23], s69 offen sc1
  v_cos_f32 v101, v117
  v_sin_f32 v117, v117
  v_cos_f32 v102, v118
  v_mfma_f32_32x32x16_bf16 v[136:151], a[16:19], v[40:43], v[136:151]
  s_add_u32 s55, s68, 4857856
  buffer_load_dwordx4 v[208:211], v7, s[20:23], s55 offen sc1
  buffer_load_dword v229, v6, s[20:23], s69 offen offset:256 sc1
  v_sin_f32 v118, v118
  v_cos_f32 v103, v119
  v_sin_f32 v119, v119
  s_waitcnt lgkmcnt(4)
  v_mfma_f32_32x32x16_bf16 v[120:135], a[20:23], v[36:39], v[120:135]
  s_add_u32 s55, s68, 4931584
  buffer_load_dwordx4 v[212:215], v7, s[20:23], s55 offen sc1
  buffer_load_dword v230, v6, s[20:23], s69 offen offset:512 sc1
  v_mfma_f32_32x32x16_bf16 v[136:151], a[20:23], v[44:47], v[136:151]
  s_add_u32 s55, s68, 5005312
  buffer_load_dwordx4 v[216:219], v7, s[20:23], s55 offen sc1
  buffer_load_dword v231, v6, s[20:23], s69 offen offset:768 sc1
  s_waitcnt lgkmcnt(3)
  v_mfma_f32_32x32x16_bf16 v[120:135], a[8:11], v[56:59], v[120:135]
  v_mfma_f32_32x32x16_bf16 v[136:151], a[8:11], v[64:67], v[136:151]
  s_waitcnt lgkmcnt(2)
  v_mfma_f32_32x32x16_bf16 v[120:135], a[12:15], v[60:63], v[120:135]
  v_mfma_f32_32x32x16_bf16 v[136:151], a[12:15], v[68:71], v[136:151]
  s_waitcnt lgkmcnt(1)
  v_mfma_f32_32x32x16_bf16 v[120:135], a[24:27], v[72:75], v[120:135]
  v_mfma_f32_32x32x16_bf16 v[136:151], a[24:27], v[80:83], v[136:151]
  s_waitcnt lgkmcnt(0)
  v_mfma_f32_32x32x16_bf16 v[120:135], a[28:31], v[76:79], v[120:135]
  v_mfma_f32_32x32x16_bf16 v[136:151], a[28:31], v[84:87], v[136:151]
  s_waitcnt vmcnt(12)
  ds_read_b128 a[32:35], v240 offset:8192
  ds_read_b128 a[36:39], v241 offset:8192
  ds_read_b128 a[48:51], v242 offset:8192
  ds_read_b128 a[52:55], v243 offset:8192
  s_waitcnt vmcnt(8)
  ds_read_b128 a[40:43], v240 offset:12288
  ds_read_b128 a[44:47], v241 offset:12288
  ds_read_b128 a[56:59], v242 offset:12288
  ds_read_b128 a[60:63], v243 offset:12288
  s_waitcnt lgkmcnt(7)
  v_mfma_f32_32x32x16_bf16 v[152:167], a[32:35], v[16:19], 0
  v_mfma_f32_32x32x16_bf16 v[168:183], a[32:35], v[24:27], 0
  v_mul_f32 v248, v120, v88
  v_mul_f32 v252, v136, v88
  v_mul_f32 v249, v121, v89
  v_mul_f32 v253, v137, v89
  v_mul_f32 v250, v122, v90
  s_waitcnt lgkmcnt(6)
  v_mfma_f32_32x32x16_bf16 v[152:167], a[36:39], v[20:23], v[152:167]
  v_mul_f32 v254, v138, v90
  v_mul_f32 v251, v123, v91
  v_mul_f32 v255, v139, v91
  s_add_u32 m0, s32, 0
  s_add_u32 s41, s46, 0
  buffer_load_dwordx4 v200, s[8:11], s41 offen lds
  v_fmac_f32 v248, v136, v104
  v_fma_f32 v252, -v120, v104, v252
  v_mfma_f32_32x32x16_bf16 v[168:183], a[36:39], v[28:31], v[168:183]
  v_fmac_f32 v249, v137, v105
  v_fma_f32 v253, -v121, v105, v253
  v_fmac_f32 v250, v138, v106
  v_fma_f32 v254, -v122, v106, v254
  v_fmac_f32 v251, v139, v107
  s_waitcnt lgkmcnt(5)
  v_mfma_f32_32x32x16_bf16 v[152:167], a[48:51], v[32:35], v[152:167]
  v_fma_f32 v255, -v123, v107, v255
  v_cvt_pk_bf16_f32 v184, v248, v249
  v_cvt_pk_bf16_f32 v192, v252, v253
  v_cvt_pk_bf16_f32 v185, v250, v251
  buffer_load_dwordx4 v201, s[8:11], s41 offen offset:1024 lds
  v_cvt_pk_bf16_f32 v193, v254, v255
  v_mfma_f32_32x32x16_bf16 v[168:183], a[48:51], v[40:43], v[168:183]
  v_mul_f32 v248, v124, v92
  v_mul_f32 v252, v140, v92
  v_mul_f32 v249, v125, v93
  v_mul_f32 v253, v141, v93
  v_mul_f32 v250, v126, v94
  s_waitcnt lgkmcnt(4)
  v_mfma_f32_32x32x16_bf16 v[152:167], a[52:55], v[36:39], v[152:167]
  v_mul_f32 v254, v142, v94
  v_mul_f32 v251, v127, v95
  v_mul_f32 v255, v143, v95
  v_fmac_f32 v248, v140, v108
  v_fma_f32 v252, -v124, v108, v252
  buffer_load_dwordx4 v202, s[8:11], s41 offen offset:2048 lds
  v_mfma_f32_32x32x16_bf16 v[168:183], a[52:55], v[44:47], v[168:183]
  v_fmac_f32 v249, v141, v109
  v_fma_f32 v253, -v125, v109, v253
  v_fmac_f32 v250, v142, v110
  v_fma_f32 v254, -v126, v110, v254
  v_fmac_f32 v251, v143, v111
  s_waitcnt lgkmcnt(3)
  v_mfma_f32_32x32x16_bf16 v[152:167], a[40:43], v[56:59], v[152:167]
  v_fma_f32 v255, -v127, v111, v255
  v_cvt_pk_bf16_f32 v186, v248, v249
  v_cvt_pk_bf16_f32 v194, v252, v253
  v_cvt_pk_bf16_f32 v187, v250, v251
  v_cvt_pk_bf16_f32 v195, v254, v255
  v_mfma_f32_32x32x16_bf16 v[168:183], a[40:43], v[64:67], v[168:183]
  v_mfma_f32_32x32x16_bf16 v[232:247], v[16:19], v[184:187], 0
  v_mfma_f32_32x32x16_bf16 v[232:247], v[48:51], v[192:195], v[232:247]
  v_mul_f32 v248, v128, v96
  v_mul_f32 v252, v144, v96
  v_mul_f32 v249, v129, v97
  s_waitcnt lgkmcnt(2)
  v_mfma_f32_32x32x16_bf16 v[152:167], a[44:47], v[60:63], v[152:167]
  v_mul_f32 v253, v145, v97
  v_mul_f32 v250, v130, v98
  v_mul_f32 v254, v146, v98
  v_mul_f32 v251, v131, v99
  v_mul_f32 v255, v147, v99
  v_mfma_f32_32x32x16_bf16 v[168:183], a[44:47], v[68:71], v[168:183]
  v_fmac_f32 v248, v144, v112
  buffer_load_dwordx4 v203, s[8:11], s41 offen offset:3072 lds
  v_fma_f32 v252, -v128, v112, v252
  v_fmac_f32 v249, v145, v113
  v_fma_f32 v253, -v129, v113, v253
  v_fmac_f32 v250, v146, v114
  s_waitcnt lgkmcnt(1)
  v_mfma_f32_32x32x16_bf16 v[152:167], a[56:59], v[72:75], v[152:167]
  v_fma_f32 v254, -v130, v114, v254
  v_fmac_f32 v251, v147, v115
  v_fma_f32 v255, -v131, v115, v255
  v_cvt_pk_bf16_f32 v188, v248, v249
  v_cvt_pk_bf16_f32 v196, v252, v253
  v_mfma_f32_32x32x16_bf16 v[168:183], a[56:59], v[80:83], v[168:183]
  v_cvt_pk_bf16_f32 v189, v250, v251
  v_cvt_pk_bf16_f32 v197, v254, v255
  s_add_u32 m0, s32, 4096
  s_add_u32 s41, s46, 1179648
  buffer_load_dwordx4 v200, s[8:11], s41 offen lds
  v_mul_f32 v248, v132, v100
  v_mul_f32 v252, v148, v100
  v_mul_f32 v249, v133, v101
  s_waitcnt lgkmcnt(0)
  v_mfma_f32_32x32x16_bf16 v[152:167], a[60:63], v[76:79], v[152:167]
  v_mul_f32 v253, v149, v101
  v_mul_f32 v250, v134, v102
  v_mul_f32 v254, v150, v102
  v_mul_f32 v251, v135, v103
  v_mul_f32 v255, v151, v103
  v_mfma_f32_32x32x16_bf16 v[168:183], a[60:63], v[84:87], v[168:183]
  v_fmac_f32 v248, v148, v116
  v_fma_f32 v252, -v132, v116, v252
  v_fmac_f32 v249, v149, v117
  buffer_load_dwordx4 v201, s[8:11], s41 offen offset:1024 lds
  v_fma_f32 v253, -v133, v117, v253
  v_fmac_f32 v250, v150, v118
  v_fma_f32 v254, -v134, v118, v254
  v_fmac_f32 v251, v151, v119
  v_fma_f32 v255, -v135, v119, v255
  v_cvt_pk_bf16_f32 v190, v248, v249
  v_cvt_pk_bf16_f32 v198, v252, v253
  v_cvt_pk_bf16_f32 v191, v250, v251
  v_cvt_pk_bf16_f32 v199, v254, v255
  s_nop 0
  v_mfma_f32_32x32x16_bf16 v[232:247], v[20:23], v[188:191], v[232:247]
  v_mfma_f32_32x32x16_bf16 v[232:247], v[52:55], v[196:199], v[232:247]
  s_cmp_eq_u32 s52, 1
  s_cbranch_scc1 sequential_preLN__spectral_fnet__swiglu_ffn__prompt_kernel_mu
  s_waitcnt vmcnt(13)
  v_lshlrev_b32 v56, 16, v204
  v_and_b32 v57, 0xffff0000, v204
  v_lshlrev_b32 v58, 16, v205
  v_and_b32 v59, 0xffff0000, v205
  v_lshlrev_b32 v60, 16, v206
  v_and_b32 v61, 0xffff0000, v206
  v_lshlrev_b32 v62, 16, v207
  v_and_b32 v63, 0xffff0000, v207
  s_waitcnt vmcnt(11)
  v_lshlrev_b32 v64, 16, v208
  v_and_b32 v65, 0xffff0000, v208
  v_lshlrev_b32 v66, 16, v209
  v_and_b32 v67, 0xffff0000, v209
  v_lshlrev_b32 v68, 16, v210
  buffer_load_dwordx4 v202, s[8:11], s41 offen offset:2048 lds
  v_and_b32 v69, 0xffff0000, v210
  v_lshlrev_b32 v70, 16, v211
  v_and_b32 v71, 0xffff0000, v211
  s_waitcnt vmcnt(10)
  v_lshlrev_b32 v72, 16, v212
  v_and_b32 v73, 0xffff0000, v212
  v_lshlrev_b32 v74, 16, v213
  v_and_b32 v75, 0xffff0000, v213
  v_lshlrev_b32 v76, 16, v214
  v_and_b32 v77, 0xffff0000, v214
  v_lshlrev_b32 v78, 16, v215
  v_and_b32 v79, 0xffff0000, v215
  s_waitcnt vmcnt(8)
  v_lshlrev_b32 v80, 16, v216
  v_and_b32 v81, 0xffff0000, v216
  buffer_load_dwordx4 v203, s[8:11], s41 offen offset:3072 lds
  v_lshlrev_b32 v82, 16, v217
  v_and_b32 v83, 0xffff0000, v217
  v_lshlrev_b32 v84, 16, v218
  v_and_b32 v85, 0xffff0000, v218
  v_lshlrev_b32 v86, 16, v219
  v_and_b32 v87, 0xffff0000, v219
  v_cvt_pk_bf16_f32 v136, v232, v233
  v_cvt_pk_bf16_f32 v137, v234, v235
  ds_write_b64 v2, v[136:137] offset:0
  v_cvt_pk_bf16_f32 v138, v236, v237
  v_cvt_pk_bf16_f32 v139, v238, v239
  ds_write_b64 v2, v[138:139] offset:16
  v_cvt_pk_bf16_f32 v140, v240, v241
  s_add_u32 m0, s32, 8192
  s_add_u32 s41, s46, 2359296
  buffer_load_dwordx4 v200, s[8:11], s41 offen lds
  v_cvt_pk_bf16_f32 v141, v242, v243
  ds_write_b64 v2, v[140:141] offset:32
  v_cvt_pk_bf16_f32 v142, v244, v245
  v_cvt_pk_bf16_f32 v143, v246, v247
  ds_write_b64 v2, v[142:143] offset:48
  v_mul_f32 v248, v152, v88
  v_mul_f32 v252, v168, v88
  v_mul_f32 v249, v153, v89
  v_mul_f32 v253, v169, v89
  v_mul_f32 v250, v154, v90
  v_mul_f32 v254, v170, v90
  v_mul_f32 v251, v155, v91
  v_mul_f32 v255, v171, v91
  s_add_u32 m0, s32, 36864
  s_add_u32 s41, s46, 0
  buffer_load_dwordx4 v200, s[12:15], s41 offen lds
  v_fmac_f32 v248, v168, v104
  v_fma_f32 v252, -v152, v104, v252
  v_fmac_f32 v249, v169, v105
  v_fma_f32 v253, -v153, v105, v253
  v_fmac_f32 v250, v170, v106
  v_fma_f32 v254, -v154, v106, v254
  v_fmac_f32 v251, v171, v107
  v_fma_f32 v255, -v155, v107, v255
  v_cvt_pk_bf16_f32 v204, v248, v249
  v_cvt_pk_bf16_f32 v212, v252, v253
  v_cvt_pk_bf16_f32 v205, v250, v251
  v_cvt_pk_bf16_f32 v213, v254, v255
  v_mul_f32 v248, v156, v92
  buffer_load_dwordx4 v201, s[12:15], s41 offen offset:1024 lds
  v_mul_f32 v252, v172, v92
  v_mul_f32 v249, v157, v93
  v_mul_f32 v253, v173, v93
  v_mul_f32 v250, v158, v94
  v_mul_f32 v254, v174, v94
  v_mul_f32 v251, v159, v95
  v_mul_f32 v255, v175, v95
  v_fmac_f32 v248, v172, v108
  v_fma_f32 v252, -v156, v108, v252
  v_fmac_f32 v249, v173, v109
  v_fma_f32 v253, -v157, v109, v253
  v_fmac_f32 v250, v174, v110
  v_fma_f32 v254, -v158, v110, v254
  buffer_load_dwordx4 v202, s[12:15], s41 offen offset:2048 lds
  v_fmac_f32 v251, v175, v111
  v_fma_f32 v255, -v159, v111, v255
  v_cvt_pk_bf16_f32 v206, v248, v249
  v_cvt_pk_bf16_f32 v214, v252, v253
  v_cvt_pk_bf16_f32 v207, v250, v251
  v_cvt_pk_bf16_f32 v215, v254, v255
  s_nop 0
  v_mfma_f32_32x32x16_bf16 v[120:135], v[16:19], v[204:207], 0
  v_mfma_f32_32x32x16_bf16 v[120:135], v[48:51], v[212:215], v[120:135]
  v_mul_f32 v248, v160, v96
  v_mul_f32 v252, v176, v96
  v_mul_f32 v249, v161, v97
  v_mul_f32 v253, v177, v97
  v_mul_f32 v250, v162, v98
  buffer_load_dwordx4 v203, s[12:15], s41 offen offset:3072 lds
  v_mul_f32 v254, v178, v98
  v_mul_f32 v251, v163, v99
  v_mul_f32 v255, v179, v99
  v_fmac_f32 v248, v176, v112
  v_fma_f32 v252, -v160, v112, v252
  v_fmac_f32 v249, v177, v113
  v_fma_f32 v253, -v161, v113, v253
  v_fmac_f32 v250, v178, v114
  v_fma_f32 v254, -v162, v114, v254
  v_fmac_f32 v251, v179, v115
  v_fma_f32 v255, -v163, v115, v255
  v_cvt_pk_bf16_f32 v208, v248, v249
  v_cvt_pk_bf16_f32 v216, v252, v253
  s_add_u32 m0, s32, 40960
  s_add_u32 s41, s46, 1179648
  buffer_load_dwordx4 v200, s[12:15], s41 offen lds
  v_cvt_pk_bf16_f32 v209, v250, v251
  v_cvt_pk_bf16_f32 v217, v254, v255
  v_mul_f32 v248, v164, v100
  v_mul_f32 v252, v180, v100
  v_mul_f32 v249, v165, v101
  v_mul_f32 v253, v181, v101
  v_mul_f32 v250, v166, v102
  v_mul_f32 v254, v182, v102
  v_mul_f32 v251, v167, v103
  v_mul_f32 v255, v183, v103
  v_fmac_f32 v248, v180, v116
  v_fma_f32 v252, -v164, v116, v252
  v_fmac_f32 v249, v181, v117
  buffer_load_dwordx4 v201, s[12:15], s41 offen offset:1024 lds
  v_fma_f32 v253, -v165, v117, v253
  v_fmac_f32 v250, v182, v118
  v_fma_f32 v254, -v166, v118, v254
  v_fmac_f32 v251, v183, v119
  v_fma_f32 v255, -v167, v119, v255
  v_cvt_pk_bf16_f32 v210, v248, v249
  v_cvt_pk_bf16_f32 v218, v252, v253
  v_cvt_pk_bf16_f32 v211, v250, v251
  v_cvt_pk_bf16_f32 v219, v254, v255
  s_nop 0
  v_mfma_f32_32x32x16_bf16 v[120:135], v[20:23], v[208:211], v[120:135]
  v_mfma_f32_32x32x16_bf16 v[120:135], v[52:55], v[216:219], v[120:135]
  v_add_f32 v56, v56, v228
  v_add_f32 v57, v57, v228
  buffer_load_dwordx4 v202, s[12:15], s41 offen offset:2048 lds
  v_add_f32 v58, v58, v228
  v_add_f32 v59, v59, v228
  v_add_f32 v60, v60, v228
  v_add_f32 v61, v61, v228
  v_add_f32 v62, v62, v228
  v_add_f32 v63, v63, v228
  v_add_f32 v64, v64, v229
  v_add_f32 v65, v65, v229
  v_add_f32 v66, v66, v229
  v_add_f32 v67, v67, v229
  v_add_f32 v68, v68, v229
  v_add_f32 v69, v69, v229
  v_add_f32 v70, v70, v229
  buffer_load_dwordx4 v203, s[12:15], s41 offen offset:3072 lds
  v_add_f32 v71, v71, v229
  v_cvt_pk_bf16_f32 v144, v120, v121
  v_cvt_pk_bf16_f32 v145, v122, v123
  ds_write_b64 v14, v[144:145] offset:0
  v_cvt_pk_bf16_f32 v146, v124, v125
  v_cvt_pk_bf16_f32 v147, v126, v127
  ds_write_b64 v14, v[146:147] offset:16
  v_cvt_pk_bf16_f32 v148, v128, v129
  v_cvt_pk_bf16_f32 v149, v130, v131
  ds_write_b64 v14, v[148:149] offset:32
  v_cvt_pk_bf16_f32 v150, v132, v133
  v_cvt_pk_bf16_f32 v151, v134, v135
  ds_write_b64 v14, v[150:151] offset:48
  s_waitcnt lgkmcnt(0)
  s_barrier
  ds_read_b64_tr_b16 v[88:89], v15 offset:0
  ds_read_b64_tr_b16 v[90:91], v15 offset:9472
  ds_read_b64_tr_b16 v[92:93], v15 offset:144
  ds_read_b64_tr_b16 v[94:95], v15 offset:9616
  ds_read_b64_tr_b16 v[96:97], v15 offset:288
  ds_read_b64_tr_b16 v[98:99], v15 offset:9760
  ds_read_b64_tr_b16 v[100:101], v15 offset:432
  ds_read_b64_tr_b16 v[102:103], v15 offset:9904
  v_add_f32 v72, v72, v230
  v_add_f32 v73, v73, v230
  v_add_f32 v74, v74, v230
  v_add_f32 v75, v75, v230
  s_add_u32 m0, s32, 45056
  s_add_u32 s41, s46, 2359296
  buffer_load_dwordx4 v200, s[12:15], s41 offen lds
  v_add_f32 v76, v76, v230
  v_add_f32 v77, v77, v230
  v_add_f32 v78, v78, v230
  v_add_f32 v79, v79, v230
  s_waitcnt vmcnt(18)
  v_add_f32 v80, v80, v231
  v_add_f32 v81, v81, v231
  v_add_f32 v82, v82, v231
  v_add_f32 v83, v83, v231
  v_add_f32 v84, v84, v231
  v_add_f32 v85, v85, v231
  v_add_f32 v86, v86, v231
  v_add_f32 v87, v87, v231
  s_add_u32 s55, s68, 2424832
  s_waitcnt lgkmcnt(7)
  v_dot2c_f32_bf16 v56, s70, v88
  v_dot2c_f32_bf16 v57, s71, v88
  v_dot2c_f32_bf16 v58, s70, v89
  v_dot2c_f32_bf16 v59, s71, v89
  s_waitcnt lgkmcnt(6)
  v_dot2c_f32_bf16 v60, s70, v90
  v_dot2c_f32_bf16 v61, s71, v90
  v_dot2c_f32_bf16 v62, s70, v91
  v_dot2c_f32_bf16 v63, s71, v91
  v_cvt_pk_bf16_f32 v24, v56, v57
  v_cvt_pk_bf16_f32 v25, v58, v59
  v_cvt_pk_bf16_f32 v26, v60, v61
  v_cvt_pk_bf16_f32 v27, v62, v63
  buffer_store_dwordx4 v[24:27], v7, s[20:23], s55 offen sc1
  s_add_u32 s55, s55, 73728
  s_waitcnt lgkmcnt(5)
  v_dot2c_f32_bf16 v64, s70, v92
  v_dot2c_f32_bf16 v65, s71, v92
  v_dot2c_f32_bf16 v66, s70, v93
  v_dot2c_f32_bf16 v67, s71, v93
  s_waitcnt lgkmcnt(4)
  v_dot2c_f32_bf16 v68, s70, v94
  v_dot2c_f32_bf16 v69, s71, v94
  v_dot2c_f32_bf16 v70, s70, v95
  v_dot2c_f32_bf16 v71, s71, v95
  v_cvt_pk_bf16_f32 v28, v64, v65
  v_cvt_pk_bf16_f32 v29, v66, v67
  v_cvt_pk_bf16_f32 v30, v68, v69
  v_cvt_pk_bf16_f32 v31, v70, v71
  buffer_store_dwordx4 v[28:31], v7, s[20:23], s55 offen sc1
  s_add_u32 s55, s55, 73728
  s_waitcnt lgkmcnt(3)
  v_dot2c_f32_bf16 v72, s70, v96
  v_dot2c_f32_bf16 v73, s71, v96
  v_dot2c_f32_bf16 v74, s70, v97
  v_dot2c_f32_bf16 v75, s71, v97
  s_waitcnt lgkmcnt(2)
  v_dot2c_f32_bf16 v76, s70, v98
  v_dot2c_f32_bf16 v77, s71, v98
  v_dot2c_f32_bf16 v78, s70, v99
  v_dot2c_f32_bf16 v79, s71, v99
  v_cvt_pk_bf16_f32 v32, v72, v73
  v_cvt_pk_bf16_f32 v33, v74, v75
  v_cvt_pk_bf16_f32 v34, v76, v77
  v_cvt_pk_bf16_f32 v35, v78, v79
  buffer_store_dwordx4 v[32:35], v7, s[20:23], s55 offen sc1
  s_add_u32 s55, s55, 73728
  s_waitcnt lgkmcnt(1)
  v_dot2c_f32_bf16 v80, s70, v100
  v_dot2c_f32_bf16 v81, s71, v100
  v_dot2c_f32_bf16 v82, s70, v101
  v_dot2c_f32_bf16 v83, s71, v101
  s_waitcnt lgkmcnt(0)
  v_dot2c_f32_bf16 v84, s70, v102
  v_dot2c_f32_bf16 v85, s71, v102
  v_dot2c_f32_bf16 v86, s70, v103
  v_dot2c_f32_bf16 v87, s71, v103
  v_cvt_pk_bf16_f32 v36, v80, v81
  v_cvt_pk_bf16_f32 v37, v82, v83
  v_cvt_pk_bf16_f32 v38, v84, v85
  v_cvt_pk_bf16_f32 v39, v86, v87
  buffer_store_dwordx4 v[36:39], v7, s[20:23], s55 offen sc1
  s_and_b32 s55, s53, 1
  s_lshl_b32 s55, s55, 13
  s_add_u32 s55, s55, s69
  s_add_u32 s55, s55, 106496
  v_mul_f32 v228, v56, v56
  v_mul_f32 v229, v64, v64
  v_mul_f32 v230, v72, v72
  v_mul_f32 v231, v80, v80
  v_fmac_f32 v228, v57, v57
  v_fmac_f32 v229, v65, v65
  v_fmac_f32 v230, v73, v73
  v_fmac_f32 v231, v81, v81
  v_fmac_f32 v228, v58, v58
  v_fmac_f32 v229, v66, v66
  v_fmac_f32 v230, v74, v74
  v_fmac_f32 v231, v82, v82
  v_fmac_f32 v228, v59, v59
  v_fmac_f32 v229, v67, v67
  v_fmac_f32 v230, v75, v75
  v_fmac_f32 v231, v83, v83
  v_fmac_f32 v228, v60, v60
  v_fmac_f32 v229, v68, v68
  v_fmac_f32 v230, v76, v76
  v_fmac_f32 v231, v84, v84
  v_fmac_f32 v228, v61, v61
  v_fmac_f32 v229, v69, v69
  v_fmac_f32 v230, v77, v77
  v_fmac_f32 v231, v85, v85
  v_fmac_f32 v228, v62, v62
  v_fmac_f32 v229, v70, v70
  v_fmac_f32 v230, v78, v78
  v_fmac_f32 v231, v86, v86
  v_fmac_f32 v228, v63, v63
  v_fmac_f32 v229, v71, v71
  v_fmac_f32 v230, v79, v79
  v_fmac_f32 v231, v87, v87
  buffer_atomic_add_f32 v228, v6, s[20:23], s55 offen
  buffer_atomic_add_f32 v229, v6, s[20:23], s55 offen offset:256
  buffer_atomic_add_f32 v230, v6, s[20:23], s55 offen offset:512
  buffer_atomic_add_f32 v231, v6, s[20:23], s55 offen offset:768
sequential_preLN__spectral_fnet__swiglu_ffn__prompt_kernel_join:
  s_nop 1
  v_mul_u32_u24 v193, 1280, v0
  v_lshrrev_b32 v192, 3, v0
  v_lshl_add_u32 v193, v192, 23, v193
  v_mov_b32 v192, 1
  s_cmp_ge_u32 s2, 146
  s_cbranch_scc1 sequential_preLN__spectral_fnet__swiglu_ffn__prompt_kernel_np
  s_lshr_b32 s55, s53, 3
  s_lshl_b32 s55, s55, 7
  s_and_b32 s62, s53, 7
  s_lshl_b32 s62, s62, 2
  s_add_u32 s55, s55, s62
  s_mul_i32 s62, s54, 10240
  s_add_u32 s55, s55, s62
  s_add_u32 s55, s55, 7196672
  s_waitcnt vmcnt(4)
  s_barrier
  buffer_store_dword v192, v193, s[20:23], s55 offen sc1
sequential_preLN__spectral_fnet__swiglu_ffn__prompt_kernel_np:
  s_add_u32 m0, s32, 73728
  s_add_u32 s41, s46, 2654208
  buffer_load_dwordx4 v200, s[8:11], s41 offen lds
  buffer_load_dwordx4 v201, s[8:11], s41 offen offset:1024 lds
  buffer_load_dwordx4 v202, s[8:11], s41 offen offset:2048 lds
  buffer_load_dwordx4 v203, s[8:11], s41 offen offset:3072 lds
  s_add_u32 m0, s32, 77824
  s_add_u32 s41, s46, 3833856
  buffer_load_dwordx4 v200, s[8:11], s41 offen lds
  buffer_load_dwordx4 v201, s[8:11], s41 offen offset:1024 lds
  buffer_load_dwordx4 v202, s[8:11], s41 offen offset:2048 lds
  buffer_load_dwordx4 v203, s[8:11], s41 offen offset:3072 lds
  s_add_u32 m0, s32, 81920
  s_add_u32 s41, s46, 5013504
  buffer_load_dwordx4 v200, s[8:11], s41 offen lds
  s_add_u32 m0, s32, 110592
  s_add_u32 s41, s46, 2654208
  buffer_load_dwordx4 v200, s[12:15], s41 offen lds
  buffer_load_dwordx4 v201, s[12:15], s41 offen offset:1024 lds
  buffer_load_dwordx4 v202, s[12:15], s41 offen offset:2048 lds
  buffer_load_dwordx4 v203, s[12:15], s41 offen offset:3072 lds
  s_add_u32 m0, s32, 114688
  s_add_u32 s41, s46, 3833856
  buffer_load_dwordx4 v200, s[12:15], s41 offen lds
  buffer_load_dwordx4 v201, s[12:15], s41 offen offset:1024 lds
  buffer_load_dwordx4 v202, s[12:15], s41 offen offset:2048 lds
  buffer_load_dwordx4 v203, s[12:15], s41 offen offset:3072 lds
  s_add_u32 m0, s32, 118784
  s_add_u32 s41, s46, 5013504
  buffer_load_dwordx4 v200, s[12:15], s41 offen lds
  s_mov_b32 s16, s36
  s_mov_b32 s17, s37
  s_mov_b32 s18, 5308416
  s_mov_b32 s19, 0x20000
  s_add_u32 s24, s38, 8388608
  s_addc_u32 s25, s39, 0
  s_mov_b32 s26, 39518208
  s_mov_b32 s27, 0x20000
  v_lshlrev_b32 v14, 4, v1
  v_lshlrev_b32 v255, 3, v1
  v_and_b32 v10, 3, v1
  v_lshlrev_b32 v10, 3, v10
  v_bfe_u32 v224, v1, 2, 3
  v_lshl_add_u32 v10, v224, 6, v10
  v_lshl_add_u32 v10, v227, 5, v10
  v_mul_u32_u24 v248, 1152, v224
  v_add_u32 v248, v248, v226
  v_lshrrev_b32 v224, 5, v1
  v_mul_u32_u24 v226, 9216, v224
  v_add_u32 v10, v10, v226
  v_xor_b32 v11, 32, v10
  v_add_u32 v12, 73728, v10
  v_add_u32 v13, 73728, v11
  v_add_u32 v7, 110592, v255
  v_and_b32 v3, 7, v1
  v_lshlrev_b32 v3, 4, v3
  v_lshl_add_u32 v3, v224, 7, v3
  v_bfe_u32 v224, v1, 3, 2
  v_lshl_add_u32 v3, v224, 8, v3
  s_lshl_b32 s40, s45, 9
  v_xor_b32 v249, s40, v14
  v_and_b32 v9, 7, v1
  v_lshlrev_b32 v9, 2, v9
  s_mul_i32 s99, s30, 4224
  s_add_u32 s99, s99, 7220224
  s_mul_i32 s33, s30, 663552
  s_mov_b32 s95, s44
  s_lshr_b32 s36, s44, 1
  s_lshr_b32 s3, s2, 5
  s_lshl_b32 s3, s3, 3
  s_lshl_b32 s40, s28, 1
  s_add_u32 s40, s40, s3
  s_lshl_b32 s96, s40, 7
  s_add_u32 s96, s96, 7249920
  s_xor_b32 s97, s96, 128
  s_mul_i32 s34, s40, 36864
  s_add_u32 s34, s34, 2424832
  s_add_u32 s37, s34, 36864
  s_mul_i32 s40, s28, 18432
  s_mul_i32 s38, s2, 73728
  s_add_u32 s38, s38, s40
  s_xor_b32 s41, s2, 8
  s_mul_i32 s41, s41, 73728
  s_add_u32 s79, s41, s40
  s_xor_b32 s41, s2, 16
  s_mul_i32 s41, s41, 73728
  s_add_u32 s80, s41, s40
  s_xor_b32 s41, s2, 24
  s_mul_i32 s41, s41, 73728
  s_add_u32 s81, s41, s40
  s_add_u32 s35, s38, 18874368
  s_lshl_b32 s40, s36, 2
  s_add_u32 s3, s3, s40
  s_add_u32 s3, s3, s28
  v_lshlrev_b32 v15, 7, v1
  s_lshr_b32 s40, s2, 5
  s_lshl_b32 s40, s40, 2
  s_add_u32 s40, s40, s28
  s_mul_i32 s40, s40, 82944
  v_mul_u32_u24 v250, 9216, v1
  v_add_u32 v250, s40, v250
  s_lshl_b32 s40, s3, 1
  s_add_u32 s40, s40, s45
  s_mul_i32 s40, s40, 5184
  v_add_u32 v251, s40, v15
  v_cmp_lt_u32 vcc, 8, v1
  v_mov_b32 v224, 0x40000000
  v_mov_b32 v221, 0
  v_cndmask_b32 v250, v250, v224, vcc
  v_cndmask_b32 v251, v251, v224, vcc
  s_mul_i32 s40, s3, 768
  v_add_u32 v15, s40, v15
  v_cmp_lt_u32 vcc, 5, v1
  s_lshl_b32 s44, s44, 8
  s_nop 0
  v_cndmask_b32 v15, v15, v224, vcc
  v_cmp_ne_u32 vcc, 192, v0
  s_add_u32 s44, s44, s31
  s_mul_i32 s40, s45, 2654208
  s_add_u32 s31, s31, s40
  v_mov_b32 v253, 1
  s_lshl_b32 s29, s2, 7
  v_cndmask_b32 v252, v221, v224, vcc
  s_andn2_b32 s30, s29, 0xc00
  s_add_u32 s29, s29, 7159808
  s_add_u32 s30, s30, 7159808
  v_and_b32 v254, 3, v1
  v_lshlrev_b32 v254, 10, v254
  s_getpc_b64 s[4:5]
sequential_preLN__spectral_fnet__swiglu_ffn__prompt_kernel_pc:
  s_add_u32 s4, s4, sequential_preLN__spectral_fnet__swiglu_ffn__prompt_kernel_body-sequential_preLN__spectral_fnet__swiglu_ffn__prompt_kernel_pc
  s_addc_u32 s5, s5, 0
  s_mov_b32 s6, sequential_preLN__spectral_fnet__swiglu_ffn__prompt_kernel_end-sequential_preLN__spectral_fnet__swiglu_ffn__prompt_kernel_body
  s_mov_b32 s7, 0x20000
  s_lshr_b32 s43, s2, 7
  s_lshl_b32 s43, s43, 3
  s_and_b32 s42, s2, 7
  s_add_u32 s43, s43, s42
  s_mul_i32 s43, s43, 1280
  s_add_u32 s43, s43, 7196672
  v_lshrrev_b32 v224, 3, v1
  v_and_b32 v225, 7, v1
  v_lshlrev_b32 v225, 2, v225
  v_lshl_add_u32 v224, v224, 7, v225
  v_mov_b32 v192, 2
  s_cmp_ge_u32 s2, 144
  s_cselect_b32 s55, 0x1000000, s55
  s_cmp_lg_u32 s28, 0
  s_cbranch_scc1 sequential_preLN__spectral_fnet__swiglu_ffn__prompt_kernel_body
  s_mov_b32 s42, 0x80000
  s_cmp_lt_u32 s2, 146
  s_cbranch_scc1 sequential_preLN__spectral_fnet__swiglu_ffn__prompt_kernel_hw
sequential_preLN__spectral_fnet__swiglu_ffn__prompt_kernel_h1:
  buffer_load_dword v227, v225, s[20:23], s43 offen offset:1024 sc1
  s_waitcnt vmcnt(0)
  v_cmp_eq_u32 vcc, 0, v227
  s_sub_u32 s42, s42, 1
  s_cbranch_scc1 sequential_preLN__spectral_fnet__swiglu_ffn__prompt_kernel_body
  s_cmp_eq_u64 vcc, 0
  s_cbranch_scc1 sequential_preLN__spectral_fnet__swiglu_ffn__prompt_kernel_hw
  s_sleep 16
  s_branch sequential_preLN__spectral_fnet__swiglu_ffn__prompt_kernel_h1
sequential_preLN__spectral_fnet__swiglu_ffn__prompt_kernel_hw:
  buffer_load_dword v226, v224, s[20:23], s43 offen sc1
  buffer_load_dword v227, v225, s[20:23], s43 offen offset:1024 sc1
  s_waitcnt vmcnt(0)
  v_min_u32 v226, v226, v227
  v_cmp_eq_u32 vcc, 0, v226
  s_sub_u32 s42, s42, 1
  s_cbranch_scc1 sequential_preLN__spectral_fnet__swiglu_ffn__prompt_kernel_body
  s_cmp_eq_u64 vcc, 0
  s_cbranch_scc1 sequential_preLN__spectral_fnet__swiglu_ffn__prompt_kernel_body
  s_sleep 4
  s_cmp_eq_u64 vcc, -1
  s_cbranch_scc0 sequential_preLN__spectral_fnet__swiglu_ffn__prompt_kernel_hw
  s_sleep 12
  s_branch sequential_preLN__spectral_fnet__swiglu_ffn__prompt_kernel_hw
sequential_preLN__spectral_fnet__swiglu_ffn__prompt_kernel_body:
  s_mov_b32 s42, s37
  s_waitcnt vmcnt(0)
  s_barrier
  ds_read_b64_tr_b16 a[208:209], v10 offset:0
  ds_read_b64_tr_b16 a[210:211], v10 offset:18432
  ds_read_b64_tr_b16 a[212:213], v11 offset:0
  ds_read_b64_tr_b16 a[214:215], v11 offset:18432
  ds_read_b64_tr_b16 a[216:217], v10 offset:36864
  ds_read_b64_tr_b16 a[220:221], v11 offset:36864
  buffer_load_dwordx4 v[144:147], v222, s[20:23], s34 offen sc1
  buffer_load_dwordx4 v[148:151], v222, s[20:23], s34 offen offset:256 sc1
  buffer_load_dwordx4 v[152:155], v222, s[20:23], s42 offen sc1
  buffer_load_dwordx4 v[156:159], v222, s[20:23], s42 offen offset:256 sc1
  buffer_load_dwordx4 v[160:163], v222, s[20:23], s34 offen offset:2048 sc1
  buffer_load_dwordx4 v[164:167], v222, s[20:23], s34 offen offset:2304 sc1
  buffer_load_dwordx4 v[168:171], v222, s[20:23], s42 offen offset:2048 sc1
  buffer_load_dwordx4 v[172:175], v222, s[20:23], s42 offen offset:2304 sc1
  s_add_u32 s34, s34, 4096
  buffer_load_dwordx4 v[176:179], v222, s[20:23], s34 offen sc1
  buffer_load_dwordx4 v[180:183], v222, s[20:23], s34 offen offset:256 sc1
  s_add_u32 s42, s42, 4096
  buffer_load_dwordx4 v[184:187], v222, s[20:23], s42 offen sc1
  buffer_load_dwordx4 v[188:191], v222, s[20:23], s42 offen offset:256 sc1
  s_waitcnt vmcnt(11) lgkmcnt(4)
  v_mfma_f32_16x16x32_bf16 v[80:83], a[208:211], v[144:147], 0
  ds_read_b64_tr_b16 a[218:219], v10 offset:55296
  s_waitcnt vmcnt(10)
  v_mfma_f32_16x16x32_bf16 v[88:91], a[208:211], v[148:151], 0
  ds_read_b64_tr_b16 a[222:223], v11 offset:55296
  s_waitcnt vmcnt(9)
  v_mfma_f32_16x16x32_bf16 v[96:99], a[208:211], v[152:155], 0
  ds_read_b64_tr_b16 a[224:225], v10 offset:1024
  s_waitcnt vmcnt(8)
  v_mfma_f32_16x16x32_bf16 v[104:107], a[208:211], v[156:159], 0
  s_waitcnt lgkmcnt(5)
  buffer_load_dwordx4 v[204:207], v222, s[20:23], s34 offen offset:2048 sc1
  v_mfma_f32_16x16x32_bf16 v[84:87], a[212:215], v[144:147], 0
  ds_read_b64_tr_b16 a[226:227], v10 offset:19456
  v_mfma_f32_16x16x32_bf16 v[92:95], a[212:215], v[148:151], 0
  v_mfma_f32_16x16x32_bf16 v[100:103], a[212:215], v[152:155], 0
  ds_read_b64_tr_b16 a[228:229], v11 offset:1024
  v_mfma_f32_16x16x32_bf16 v[108:111], a[212:215], v[156:159], 0
  s_waitcnt lgkmcnt(4)
  buffer_load_dwordx4 v[208:211], v222, s[20:23], s34 offen offset:2304 sc1
  v_mfma_f32_16x16x32_bf16 v[112:115], a[216:219], v[144:147], 0
  ds_read_b64_tr_b16 a[230:231], v11 offset:19456
  v_mfma_f32_16x16x32_bf16 v[120:123], a[216:219], v[148:151], 0
  buffer_store_dword v192, v193, s[20:23], s55 offen sc1
  v_mfma_f32_16x16x32_bf16 v[128:131], a[216:219], v[152:155], 0
  ds_read_b64_tr_b16 a[232:233], v10 offset:37888
  v_mfma_f32_16x16x32_bf16 v[136:139], a[216:219], v[156:159], 0
  s_waitcnt lgkmcnt(5)
  buffer_load_dwordx4 v[212:215], v222, s[20:23], s42 offen offset:2048 sc1
  v_mfma_f32_16x16x32_bf16 v[116:119], a[220:223], v[144:147], 0
  ds_read_b64_tr_b16 a[234:235], v10 offset:56320
  v_mfma_f32_16x16x32_bf16 v[124:127], a[220:223], v[148:151], 0
  v_mfma_f32_16x16x32_bf16 v[132:135], a[220:223], v[152:155], 0
  ds_read_b64_tr_b16 a[236:237], v11 offset:37888
  v_mfma_f32_16x16x32_bf16 v[140:143], a[220:223], v[156:159], 0
  s_waitcnt lgkmcnt(5)
  buffer_load_dwordx4 v[216:219], v222, s[20:23], s42 offen offset:2304 sc1
  s_waitcnt vmcnt(12)
  v_mfma_f32_16x16x32_bf16 v[80:83], a[224:227], v[160:163], v[80:83]
  ds_read_b64_tr_b16 a[238:239], v11 offset:56320
  s_waitcnt vmcnt(11)
  v_mfma_f32_16x16x32_bf16 v[88:91], a[224:227], v[164:167], v[88:91]
  s_waitcnt vmcnt(10)
  v_mfma_f32_16x16x32_bf16 v[96:99], a[224:227], v[168:171], v[96:99]
  s_add_u32 s34, s34, 4096
  buffer_load_dwordx4 v[232:235], v222, s[20:23], s34 offen sc1
  s_waitcnt vmcnt(10)
  v_mfma_f32_16x16x32_bf16 v[104:107], a[224:227], v[172:175], v[104:107]
  s_waitcnt lgkmcnt(4)
  ds_read_b64_tr_b16 a[208:209], v10 offset:2048
  v_mfma_f32_16x16x32_bf16 v[84:87], a[228:231], v[160:163], v[84:87]
  ds_read_b64_tr_b16 a[210:211], v10 offset:20480
  v_mfma_f32_16x16x32_bf16 v[92:95], a[228:231], v[164:167], v[92:95]
  v_mfma_f32_16x16x32_bf16 v[100:103], a[228:231], v[168:171], v[100:103]
  ds_read_b64_tr_b16 a[212:213], v11 offset:2048
  v_mfma_f32_16x16x32_bf16 v[108:111], a[228:231], v[172:175], v[108:111]
  s_waitcnt lgkmcnt(5)
  buffer_load_dwordx4 v[236:239], v222, s[20:23], s34 offen offset:256 sc1
  v_mfma_f32_16x16x32_bf16 v[112:115], a[232:235], v[160:163], v[112:115]
  ds_read_b64_tr_b16 a[214:215], v11 offset:20480
  v_mfma_f32_16x16x32_bf16 v[120:123], a[232:235], v[164:167], v[120:123]
  v_mfma_f32_16x16x32_bf16 v[128:131], a[232:235], v[168:171], v[128:131]
  s_add_u32 s42, s42, 4096
  buffer_load_dwordx4 v[240:243], v222, s[20:23], s42 offen sc1
  v_mfma_f32_16x16x32_bf16 v[136:139], a[232:235], v[172:175], v[136:139]
  s_waitcnt lgkmcnt(4)
  ds_read_b64_tr_b16 a[216:217], v10 offset:38912
  v_mfma_f32_16x16x32_bf16 v[116:119], a[236:239], v[160:163], v[116:119]
  ds_read_b64_tr_b16 a[218:219], v10 offset:57344
  v_mfma_f32_16x16x32_bf16 v[124:127], a[236:239], v[164:167], v[124:127]
  v_mfma_f32_16x16x32_bf16 v[132:135], a[236:239], v[168:171], v[132:135]
  ds_read_b64_tr_b16 a[220:221], v11 offset:38912
  v_mfma_f32_16x16x32_bf16 v[140:143], a[236:239], v[172:175], v[140:143]
  s_waitcnt lgkmcnt(5)
  buffer_load_dwordx4 v[244:247], v222, s[20:23], s42 offen offset:256 sc1
  s_waitcnt vmcnt(12)
  v_mfma_f32_16x16x32_bf16 v[80:83], a[208:211], v[176:179], v[80:83]
  ds_read_b64_tr_b16 a[222:223], v11 offset:57344
  s_waitcnt vmcnt(11)
  v_mfma_f32_16x16x32_bf16 v[88:91], a[208:211], v[180:183], v[88:91]
  s_waitcnt vmcnt(10)
  v_mfma_f32_16x16x32_bf16 v[96:99], a[208:211], v[184:187], v[96:99]
  ds_read_b64_tr_b16 a[224:225], v10 offset:3072
  s_waitcnt vmcnt(9)
  v_mfma_f32_16x16x32_bf16 v[104:107], a[208:211], v[188:191], v[104:107]
  s_waitcnt lgkmcnt(5)
  buffer_load_dwordx4 a[0:3], v222, s[20:23], s34 offen offset:2048 sc1
  v_mfma_f32_16x16x32_bf16 v[84:87], a[212:215], v[176:179], v[84:87]
  ds_read_b64_tr_b16 a[226:227], v10 offset:21504
  v_mfma_f32_16x16x32_bf16 v[92:95], a[212:215], v[180:183], v[92:95]
  v_mfma_f32_16x16x32_bf16 v[100:103], a[212:215], v[184:187], v[100:103]
  ds_read_b64_tr_b16 a[228:229], v11 offset:3072
  v_mfma_f32_16x16x32_bf16 v[108:111], a[212:215], v[188:191], v[108:111]
  s_waitcnt lgkmcnt(5)
  buffer_load_dwordx4 a[4:7], v222, s[20:23], s34 offen offset:2304 sc1
  v_mfma_f32_16x16x32_bf16 v[112:115], a[216:219], v[176:179], v[112:115]
  s_lshl_b32 s92, s95, 8
  ds_read_b64_tr_b16 a[230:231], v11 offset:21504
  v_mfma_f32_16x16x32_bf16 v[120:123], a[216:219], v[180:183], v[120:123]
  s_add_u32 s92, s92, s33
  v_mfma_f32_16x16x32_bf16 v[128:131], a[216:219], v[184:187], v[128:131]
  s_mul_i32 s94, s28, 9216
  ds_read_b64_tr_b16 a[232:233], v10 offset:39936
  v_mfma_f32_16x16x32_bf16 v[136:139], a[216:219], v[188:191], v[136:139]
  s_waitcnt lgkmcnt(5)
  buffer_load_dwordx4 a[8:11], v222, s[20:23], s42 offen offset:2048 sc1
  v_mfma_f32_16x16x32_bf16 v[116:119], a[220:223], v[176:179], v[116:119]
  ds_read_b64_tr_b16 a[234:235], v10 offset:58368
  v_mfma_f32_16x16x32_bf16 v[124:127], a[220:223], v[180:183], v[124:127]
  v_mfma_f32_16x16x32_bf16 v[132:135], a[220:223], v[184:187], v[132:135]
  s_xor_b32 s40, s95, 0
  ds_read_b64_tr_b16 a[236:237], v11 offset:39936
  v_mfma_f32_16x16x32_bf16 v[140:143], a[220:223], v[188:191], v[140:143]
  s_mul_i32 s40, s40, 147456
  buffer_load_dwordx4 a[12:15], v222, s[20:23], s42 offen offset:2304 sc1
  s_waitcnt vmcnt(12) lgkmcnt(5)
  v_mfma_f32_16x16x32_bf16 v[80:83], a[224:227], v[204:207], v[80:83]
  ds_read_b64_tr_b16 a[238:239], v11 offset:58368
  s_waitcnt vmcnt(11)
  v_mfma_f32_16x16x32_bf16 v[88:91], a[224:227], v[208:211], v[88:91]
  s_waitcnt vmcnt(9)
  v_mfma_f32_16x16x32_bf16 v[96:99], a[224:227], v[212:215], v[96:99]
  s_add_u32 s34, s34, 4096
  buffer_load_dwordx4 a[16:19], v222, s[20:23], s34 offen sc1
  s_add_u32 s68, s40, s92
  s_waitcnt vmcnt(9)
  v_mfma_f32_16x16x32_bf16 v[104:107], a[224:227], v[216:219], v[104:107]
  s_waitcnt lgkmcnt(4)
  ds_read_b64_tr_b16 a[208:209], v10 offset:4096
  v_mfma_f32_16x16x32_bf16 v[84:87], a[228:231], v[204:207], v[84:87]
  ds_read_b64_tr_b16 a[210:211], v10 offset:22528
  v_mfma_f32_16x16x32_bf16 v[92:95], a[228:231], v[208:211], v[92:95]
  v_mfma_f32_16x16x32_bf16 v[100:103], a[228:231], v[212:215], v[100:103]
  s_add_u32 s68, s68, s94
  ds_read_b64_tr_b16 a[212:213], v11 offset:4096
  v_mfma_f32_16x16x32_bf16 v[108:111], a[228:231], v[216:219], v[108:111]
  s_waitcnt lgkmcnt(5)
  buffer_load_dwordx4 a[20:23], v222, s[20:23], s34 offen offset:256 sc1
  v_mfma_f32_16x16x32_bf16 v[112:115], a[232:235], v[204:207], v[112:115]
  ds_read_b64_tr_b16 a[214:215], v11 offset:22528
  v_mfma_f32_16x16x32_bf16 v[120:123], a[232:235], v[208:211], v[120:123]
  v_mfma_f32_16x16x32_bf16 v[128:131], a[232:235], v[212:215], v[128:131]
  s_add_u32 s42, s42, 4096
  buffer_load_dwordx4 a[24:27], v222, s[20:23], s42 offen sc1
  s_xor_b32 s40, s95, 1
  v_mfma_f32_16x16x32_bf16 v[136:139], a[232:235], v[216:219], v[136:139]
  s_waitcnt lgkmcnt(4)
  ds_read_b64_tr_b16 a[216:217], v10 offset:40960
  v_mfma_f32_16x16x32_bf16 v[116:119], a[236:239], v[204:207], v[116:119]
  ds_read_b64_tr_b16 a[218:219], v10 offset:59392
  v_mfma_f32_16x16x32_bf16 v[124:127], a[236:239], v[208:211], v[124:127]
  v_mfma_f32_16x16x32_bf16 v[132:135], a[236:239], v[212:215], v[132:135]
  s_mul_i32 s40, s40, 147456
  ds_read_b64_tr_b16 a[220:221], v11 offset:40960
  v_mfma_f32_16x16x32_bf16 v[140:143], a[236:239], v[216:219], v[140:143]
  s_waitcnt lgkmcnt(5)
  buffer_load_dwordx4 a[28:31], v222, s[20:23], s42 offen offset:256 sc1
  s_waitcnt vmcnt(11)
  v_mfma_f32_16x16x32_bf16 v[80:83], a[208:211], v[232:235], v[80:83]
  ds_read_b64_tr_b16 a[222:223], v11 offset:59392
  s_waitcnt vmcnt(10)
  v_mfma_f32_16x16x32_bf16 v[88:91], a[208:211], v[236:239], v[88:91]
  s_waitcnt vmcnt(9)
  v_mfma_f32_16x16x32_bf16 v[96:99], a[208:211], v[240:243], v[96:99]
  s_add_u32 s69, s40, s92
  ds_read_b64_tr_b16 a[224:225], v10 offset:5120
  s_waitcnt vmcnt(8)
  v_mfma_f32_16x16x32_bf16 v[104:107], a[208:211], v[244:247], v[104:107]
  s_waitcnt lgkmcnt(5)
  buffer_load_dwordx4 a[32:35], v222, s[20:23], s34 offen offset:2048 sc1
  v_mfma_f32_16x16x32_bf16 v[84:87], a[212:215], v[232:235], v[84:87]
  ds_read_b64_tr_b16 a[226:227], v10 offset:23552
  v_mfma_f32_16x16x32_bf16 v[92:95], a[212:215], v[236:239], v[92:95]
  v_mfma_f32_16x16x32_bf16 v[100:103], a[212:215], v[240:243], v[100:103]
  s_add_u32 s69, s69, s94
  ds_read_b64_tr_b16 a[228:229], v11 offset:5120
  s_xor_b32 s40, s95, 2
  v_mfma_f32_16x16x32_bf16 v[108:111], a[212:215], v[244:247], v[108:111]
  s_waitcnt lgkmcnt(5)
  buffer_load_dwordx4 a[36:39], v222, s[20:23], s34 offen offset:2304 sc1
  v_mfma_f32_16x16x32_bf16 v[112:115], a[216:219], v[232:235], v[112:115]
  ds_read_b64_tr_b16 a[230:231], v11 offset:23552
  v_mfma_f32_16x16x32_bf16 v[120:123], a[216:219], v[236:239], v[120:123]
  v_mfma_f32_16x16x32_bf16 v[128:131], a[216:219], v[240:243], v[128:131]
  s_mul_i32 s40, s40, 147456
  ds_read_b64_tr_b16 a[232:233], v10 offset:41984
  v_mfma_f32_16x16x32_bf16 v[136:139], a[216:219], v[244:247], v[136:139]
  s_waitcnt lgkmcnt(5)
  buffer_load_dwordx4 a[40:43], v222, s[20:23], s42 offen offset:2048 sc1
  v_mfma_f32_16x16x32_bf16 v[116:119], a[220:223], v[232:235], v[116:119]
  ds_read_b64_tr_b16 a[234:235], v10 offset:60416
  v_mfma_f32_16x16x32_bf16 v[124:127], a[220:223], v[236:239], v[124:127]
  v_mfma_f32_16x16x32_bf16 v[132:135], a[220:223], v[240:243], v[132:135]
  s_add_u32 s70, s40, s92
  ds_read_b64_tr_b16 a[236:237], v11 offset:41984
  v_mfma_f32_16x16x32_bf16 v[140:143], a[220:223], v[244:247], v[140:143]
  s_waitcnt lgkmcnt(5)
  buffer_load_dwordx4 a[44:47], v222, s[20:23], s42 offen offset:2304 sc1
  s_waitcnt vmcnt(11)
  v_mfma_f32_16x16x32_bf16 v[80:83], a[224:227], a[0:3], v[80:83]
  ds_read_b64_tr_b16 a[238:239], v11 offset:60416
  s_waitcnt vmcnt(10)
  v_mfma_f32_16x16x32_bf16 v[88:91], a[224:227], a[4:7], v[88:91]
  s_waitcnt vmcnt(9)
  v_mfma_f32_16x16x32_bf16 v[96:99], a[224:227], a[8:11], v[96:99]
  s_add_u32 s34, s34, 4096
  buffer_load_dwordx4 a[48:51], v222, s[20:23], s34 offen sc1
  s_add_u32 s70, s70, s94
  s_waitcnt vmcnt(9)
  v_mfma_f32_16x16x32_bf16 v[104:107], a[224:227], a[12:15], v[104:107]
  s_waitcnt lgkmcnt(4)
  ds_read_b64_tr_b16 a[208:209], v10 offset:6144
  v_mfma_f32_16x16x32_bf16 v[84:87], a[228:231], a[0:3], v[84:87]
  ds_read_b64_tr_b16 a[210:211], v10 offset:24576
  v_mfma_f32_16x16x32_bf16 v[92:95], a[228:231], a[4:7], v[92:95]
  v_mfma_f32_16x16x32_bf16 v[100:103], a[228:231], a[8:11], v[100:103]
  s_xor_b32 s40, s95, 3
  ds_read_b64_tr_b16 a[212:213], v11 offset:6144
  v_mfma_f32_16x16x32_bf16 v[108:111], a[228:231], a[12:15], v[108:111]
  s_waitcnt lgkmcnt(5)
  buffer_load_dwordx4 a[52:55], v222, s[20:23], s34 offen offset:256 sc1
  v_mfma_f32_16x16x32_bf16 v[112:115], a[232:235], a[0:3], v[112:115]
  ds_read_b64_tr_b16 a[214:215], v11 offset:24576
  v_mfma_f32_16x16x32_bf16 v[120:123], a[232:235], a[4:7], v[120:123]
  v_mfma_f32_16x16x32_bf16 v[128:131], a[232:235], a[8:11], v[128:131]
  s_add_u32 s42, s42, 4096
  buffer_load_dwordx4 a[56:59], v222, s[20:23], s42 offen sc1
  s_mul_i32 s40, s40, 147456
  v_mfma_f32_16x16x32_bf16 v[136:139], a[232:235], a[12:15], v[136:139]
  s_waitcnt lgkmcnt(4)
  ds_read_b64_tr_b16 a[216:217], v10 offset:43008
  v_mfma_f32_16x16x32_bf16 v[116:119], a[236:239], a[0:3], v[116:119]
  ds_read_b64_tr_b16 a[218:219], v10 offset:61440
  v_mfma_f32_16x16x32_bf16 v[124:127], a[236:239], a[4:7], v[124:127]
  v_mfma_f32_16x16x32_bf16 v[132:135], a[236:239], a[8:11], v[132:135]
  s_add_u32 s71, s40, s92
  ds_read_b64_tr_b16 a[220:221], v11 offset:43008
  v_mfma_f32_16x16x32_bf16 v[140:143], a[236:239], a[12:15], v[140:143]
  s_waitcnt lgkmcnt(5)
  buffer_load_dwordx4 a[60:63], v222, s[20:23], s42 offen offset:256 sc1
  s_waitcnt vmcnt(11)
  v_mfma_f32_16x16x32_bf16 v[80:83], a[208:211], a[16:19], v[80:83]
  s_add_u32 s71, s71, s94
  ds_read_b64_tr_b16 a[222:223], v11 offset:61440
  s_waitcnt vmcnt(10)
  v_mfma_f32_16x16x32_bf16 v[88:91], a[208:211], a[20:23], v[88:91]
  s_waitcnt vmcnt(9)
  v_mfma_f32_16x16x32_bf16 v[96:99], a[208:211], a[24:27], v[96:99]
  s_and_b32 s94, s28, 1
  ds_read_b64_tr_b16 a[224:225], v10 offset:7168
  s_waitcnt vmcnt(8)
  v_mfma_f32_16x16x32_bf16 v[104:107], a[208:211], a[28:31], v[104:107]
  s_waitcnt lgkmcnt(5)
  buffer_load_dwordx4 a[64:67], v222, s[20:23], s34 offen offset:2048 sc1
  v_mfma_f32_16x16x32_bf16 v[84:87], a[212:215], a[16:19], v[84:87]
  ds_read_b64_tr_b16 a[226:227], v10 offset:25600
  v_mfma_f32_16x16x32_bf16 v[92:95], a[212:215], a[20:23], v[92:95]
  v_mfma_f32_16x16x32_bf16 v[100:103], a[212:215], a[24:27], v[100:103]
  s_mul_i32 s94, s94, 9216
  ds_read_b64_tr_b16 a[228:229], v11 offset:7168
  v_mfma_f32_16x16x32_bf16 v[108:111], a[212:215], a[28:31], v[108:111]
  s_waitcnt lgkmcnt(5)
  buffer_load_dwordx4 a[68:71], v222, s[20:23], s34 offen offset:2304 sc1
  v_mfma_f32_16x16x32_bf16 v[112:115], a[216:219], a[16:19], v[112:115]
  ds_read_b64_tr_b16 a[230:231], v11 offset:25600
  v_mfma_f32_16x16x32_bf16 v[120:123], a[216:219], a[20:23], v[120:123]
  v_mfma_f32_16x16x32_bf16 v[128:131], a[216:219], a[24:27], v[128:131]
  s_add_u32 s92, s92, s94
  ds_read_b64_tr_b16 a[232:233], v10 offset:44032
  v_mfma_f32_16x16x32_bf16 v[136:139], a[216:219], a[28:31], v[136:139]
  s_waitcnt lgkmcnt(5)
  buffer_load_dwordx4 a[72:75], v222, s[20:23], s42 offen offset:2048 sc1
  v_mfma_f32_16x16x32_bf16 v[116:119], a[220:223], a[16:19], v[116:119]
  ds_read_b64_tr_b16 a[234:235], v10 offset:62464
  v_mfma_f32_16x16x32_bf16 v[124:127], a[220:223], a[20:23], v[124:127]
  v_mfma_f32_16x16x32_bf16 v[132:135], a[220:223], a[24:27], v[132:135]
  s_lshr_b32 s40, s28, 1
  ds_read_b64_tr_b16 a[236:237], v11 offset:44032
  v_mfma_f32_16x16x32_bf16 v[140:143], a[220:223], a[28:31], v[140:143]
  s_waitcnt lgkmcnt(5)
  buffer_load_dwordx4 a[76:79], v222, s[20:23], s42 offen offset:2304 sc1
  s_waitcnt vmcnt(11)
  v_mfma_f32_16x16x32_bf16 v[80:83], a[224:227], a[32:35], v[80:83]
  ds_read_b64_tr_b16 a[238:239], v11 offset:62464
  s_waitcnt vmcnt(10)
  v_mfma_f32_16x16x32_bf16 v[88:91], a[224:227], a[36:39], v[88:91]
  s_waitcnt vmcnt(9)
  v_mfma_f32_16x16x32_bf16 v[96:99], a[224:227], a[40:43], v[96:99]
  s_add_u32 s34, s34, 4096
  buffer_load_dwordx4 a[80:83], v222, s[20:23], s34 offen sc1
  s_add_u32 s40, s40, 0
  s_waitcnt vmcnt(9)
  v_mfma_f32_16x16x32_bf16 v[104:107], a[224:227], a[44:47], v[104:107]
  s_waitcnt lgkmcnt(4)
  ds_read_b64_tr_b16 a[208:209], v10 offset:8192
  v_mfma_f32_16x16x32_bf16 v[84:87], a[228:231], a[32:35], v[84:87]
  ds_read_b64_tr_b16 a[210:211], v10 offset:26624
  v_mfma_f32_16x16x32_bf16 v[92:95], a[228:231], a[36:39], v[92:95]
  v_mfma_f32_16x16x32_bf16 v[100:103], a[228:231], a[40:43], v[100:103]
  s_xor_b32 s40, s40, s95
  ds_read_b64_tr_b16 a[212:213], v11 offset:8192
  v_mfma_f32_16x16x32_bf16 v[108:111], a[228:231], a[44:47], v[108:111]
  s_waitcnt lgkmcnt(5)
  buffer_load_dwordx4 a[84:87], v222, s[20:23], s34 offen offset:256 sc1
  v_mfma_f32_16x16x32_bf16 v[112:115], a[232:235], a[32:35], v[112:115]
  ds_read_b64_tr_b16 a[214:215], v11 offset:26624
  v_mfma_f32_16x16x32_bf16 v[120:123], a[232:235], a[36:39], v[120:123]
  v_mfma_f32_16x16x32_bf16 v[128:131], a[232:235], a[40:43], v[128:131]
  s_add_u32 s42, s42, 4096
  buffer_load_dwordx4 a[88:91], v222, s[20:23], s42 offen sc1
  s_mul_i32 s40, s40, 18432
  v_mfma_f32_16x16x32_bf16 v[136:139], a[232:235], a[44:47], v[136:139]
  s_add_u32 s40, s40, s92
  ds_read_b64_tr_b16 a[216:217], v10 offset:45056
  s_waitcnt lgkmcnt(5)
  v_mfma_f32_16x16x32_bf16 v[116:119], a[236:239], a[32:35], v[116:119]
  s_add_u32 s72, s40, 589824
  ds_read_b64_tr_b16 a[218:219], v10 offset:63488
  v_mfma_f32_16x16x32_bf16 v[124:127], a[236:239], a[36:39], v[124:127]
  v_mfma_f32_16x16x32_bf16 v[132:135], a[236:239], a[40:43], v[132:135]
  s_lshr_b32 s40, s28, 1
  ds_read_b64_tr_b16 a[220:221], v11 offset:45056
  v_mfma_f32_16x16x32_bf16 v[140:143], a[236:239], a[44:47], v[140:143]
  s_add_u32 s40, s40, 2
  buffer_load_dwordx4 a[92:95], v222, s[20:23], s42 offen offset:256 sc1
  s_waitcnt vmcnt(11) lgkmcnt(5)
  v_mfma_f32_16x16x32_bf16 v[80:83], a[208:211], a[48:51], v[80:83]
  s_xor_b32 s40, s40, s95
  ds_read_b64_tr_b16 a[222:223], v11 offset:63488
  s_waitcnt vmcnt(10)
  v_mfma_f32_16x16x32_bf16 v[88:91], a[208:211], a[52:55], v[88:91]
  s_waitcnt vmcnt(9)
  v_mfma_f32_16x16x32_bf16 v[96:99], a[208:211], a[56:59], v[96:99]
  buffer_load_dwordx4 a[96:99], v222, s[20:23], s34 offen offset:2048 sc1
  s_waitcnt vmcnt(9)
  v_mfma_f32_16x16x32_bf16 v[104:107], a[208:211], a[60:63], v[104:107]
  s_waitcnt lgkmcnt(4)
  v_mfma_f32_16x16x32_bf16 v[84:87], a[212:215], a[48:51], v[84:87]
  v_mfma_f32_16x16x32_bf16 v[92:95], a[212:215], a[52:55], v[92:95]
  v_mfma_f32_16x16x32_bf16 v[100:103], a[212:215], a[56:59], v[100:103]
  buffer_load_dwordx4 a[100:103], v222, s[20:23], s34 offen offset:2304 sc1
  v_mfma_f32_16x16x32_bf16 v[108:111], a[212:215], a[60:63], v[108:111]
  s_waitcnt lgkmcnt(2)
  v_mfma_f32_16x16x32_bf16 v[112:115], a[216:219], a[48:51], v[112:115]
  s_barrier
  ds_read_b64_tr_b16 a[224:225], v12 offset:0
  v_mfma_f32_16x16x32_bf16 v[120:123], a[216:219], a[52:55], v[120:123]
  ds_read_b64_tr_b16 a[226:227], v12 offset:18432
  v_mfma_f32_16x16x32_bf16 v[128:131], a[216:219], a[56:59], v[128:131]
  ds_read_b64_tr_b16 a[228:229], v13 offset:0
  ds_read_b64_tr_b16 a[232:233], v12 offset:36864
  v_mfma_f32_16x16x32_bf16 v[136:139], a[216:219], a[60:63], v[136:139]
  s_waitcnt lgkmcnt(4)
  buffer_load_dwordx4 a[104:107], v222, s[20:23], s42 offen offset:2048 sc1
  v_mfma_f32_16x16x32_bf16 v[116:119], a[220:223], a[48:51], v[116:119]
  ds_read_b64_tr_b16 a[230:231], v13 offset:18432
  v_mfma_f32_16x16x32_bf16 v[124:127], a[220:223], a[52:55], v[124:127]
  ds_read_b64_tr_b16 a[234:235], v12 offset:55296
  v_mfma_f32_16x16x32_bf16 v[132:135], a[220:223], a[56:59], v[132:135]
  ds_read_b64_tr_b16 a[236:237], v13 offset:36864
  v_mfma_f32_16x16x32_bf16 v[140:143], a[220:223], a[60:63], v[140:143]
  s_waitcnt lgkmcnt(5)
  buffer_load_dwordx4 a[108:111], v222, s[20:23], s42 offen offset:2304 sc1
  s_waitcnt vmcnt(11)
  v_mfma_f32_16x16x32_bf16 v[80:83], a[224:227], a[64:67], v[80:83]
  ds_read_b64_tr_b16 a[238:239], v13 offset:55296
  s_waitcnt vmcnt(10)
  v_mfma_f32_16x16x32_bf16 v[88:91], a[224:227], a[68:71], v[88:91]
  s_waitcnt vmcnt(9)
  v_mfma_f32_16x16x32_bf16 v[96:99], a[224:227], a[72:75], v[96:99]
  s_add_u32 s34, s34, 4096
  buffer_load_dwordx4 a[112:115], v222, s[20:23], s34 offen sc1
  s_mul_i32 s40, s40, 18432
  s_waitcnt vmcnt(9)
  v_mfma_f32_16x16x32_bf16 v[104:107], a[224:227], a[76:79], v[104:107]
  s_waitcnt lgkmcnt(3)
  ds_read_b64_tr_b16 a[208:209], v12 offset:1024
  v_mfma_f32_16x16x32_bf16 v[84:87], a[228:231], a[64:67], v[84:87]
  ds_read_b64_tr_b16 a[210:211], v12 offset:19456
  v_mfma_f32_16x16x32_bf16 v[92:95], a[228:231], a[68:71], v[92:95]
  v_mfma_f32_16x16x32_bf16 v[100:103], a[228:231], a[72:75], v[100:103]
  s_add_u32 s40, s40, s92
  ds_read_b64_tr_b16 a[212:213], v13 offset:1024
  v_mfma_f32_16x16x32_bf16 v[108:111], a[228:231], a[76:79], v[108:111]
  s_waitcnt lgkmcnt(5)
  buffer_load_dwordx4 a[116:119], v222, s[20:23], s34 offen offset:256 sc1
  v_mfma_f32_16x16x32_bf16 v[112:115], a[232:235], a[64:67], v[112:115]
  ds_read_b64_tr_b16 a[214:215], v13 offset:19456
  v_mfma_f32_16x16x32_bf16 v[120:123], a[232:235], a[68:71], v[120:123]
  buffer_load_dword v226, v224, s[20:23], s43 offen sc1
  v_mfma_f32_16x16x32_bf16 v[128:131], a[232:235], a[72:75], v[128:131]
  s_add_u32 s42, s42, 4096
  buffer_load_dwordx4 a[120:123], v222, s[20:23], s42 offen sc1
  s_add_u32 s73, s40, 589824
  v_mfma_f32_16x16x32_bf16 v[136:139], a[232:235], a[76:79], v[136:139]
  s_waitcnt lgkmcnt(4)
  ds_read_b64_tr_b16 a[216:217], v12 offset:37888
  v_mfma_f32_16x16x32_bf16 v[116:119], a[236:239], a[64:67], v[116:119]
  ds_read_b64_tr_b16 a[218:219], v12 offset:56320
  v_mfma_f32_16x16x32_bf16 v[124:127], a[236:239], a[68:71], v[124:127]
  buffer_load_dword v227, v225, s[20:23], s43 offen offset:1024 sc1
  v_mfma_f32_16x16x32_bf16 v[132:135], a[236:239], a[72:75], v[132:135]
  s_and_b32 s93, s2, 7
  ds_read_b64_tr_b16 a[220:221], v13 offset:37888
  v_mfma_f32_16x16x32_bf16 v[140:143], a[236:239], a[76:79], v[140:143]
  s_waitcnt lgkmcnt(5)
  buffer_load_dwordx4 a[124:127], v222, s[20:23], s42 offen offset:256 sc1
  s_waitcnt vmcnt(13)
  v_mfma_f32_16x16x32_bf16 v[80:83], a[208:211], a[80:83], v[80:83]
  ds_read_b64_tr_b16 a[222:223], v13 offset:56320
  s_waitcnt vmcnt(12)
  v_mfma_f32_16x16x32_bf16 v[88:91], a[208:211], a[84:87], v[88:91]
  s_waitcnt vmcnt(11)
  v_mfma_f32_16x16x32_bf16 v[96:99], a[208:211], a[88:91], v[96:99]
  s_mul_i32 s93, s93, 221184
  ds_read_b64_tr_b16 a[224:225], v12 offset:2048
  s_waitcnt vmcnt(10)
  v_mfma_f32_16x16x32_bf16 v[104:107], a[208:211], a[92:95], v[104:107]
  s_waitcnt lgkmcnt(5)
  buffer_load_dwordx4 a[128:131], v222, s[20:23], s34 offen offset:2048 sc1
  v_mfma_f32_16x16x32_bf16 v[84:87], a[212:215], a[80:83], v[84:87]
  ds_read_b64_tr_b16 a[226:227], v12 offset:20480
  v_mfma_f32_16x16x32_bf16 v[92:95], a[212:215], a[84:87], v[92:95]
  v_mfma_f32_16x16x32_bf16 v[100:103], a[212:215], a[88:91], v[100:103]
  s_mul_i32 s40, s95, 18432
  ds_read_b64_tr_b16 a[228:229], v13 offset:2048
  v_mfma_f32_16x16x32_bf16 v[108:111], a[212:215], a[92:95], v[108:111]
  s_waitcnt lgkmcnt(5)
  buffer_load_dwordx4 a[132:135], v222, s[20:23], s34 offen offset:2304 sc1
  v_mfma_f32_16x16x32_bf16 v[112:115], a[216:219], a[80:83], v[112:115]
  ds_read_b64_tr_b16 a[230:231], v13 offset:20480
  v_mfma_f32_16x16x32_bf16 v[120:123], a[216:219], a[84:87], v[120:123]
  v_mfma_f32_16x16x32_bf16 v[128:131], a[216:219], a[88:91], v[128:131]
  s_add_u32 s93, s93, s40
  ds_read_b64_tr_b16 a[232:233], v12 offset:38912
  v_mfma_f32_16x16x32_bf16 v[136:139], a[216:219], a[92:95], v[136:139]
  s_waitcnt lgkmcnt(5)
  buffer_load_dwordx4 a[136:139], v222, s[20:23], s42 offen offset:2048 sc1
  v_mfma_f32_16x16x32_bf16 v[116:119], a[220:223], a[80:83], v[116:119]
  s_add_u32 s93, s93, 37748736
  ds_read_b64_tr_b16 a[234:235], v12 offset:57344
  v_mfma_f32_16x16x32_bf16 v[124:127], a[220:223], a[84:87], v[124:127]
  v_mfma_f32_16x16x32_bf16 v[132:135], a[220:223], a[88:91], v[132:135]
  s_lshr_b32 s40, s28, 1
  ds_read_b64_tr_b16 a[236:237], v13 offset:38912
  v_mfma_f32_16x16x32_bf16 v[140:143], a[220:223], a[92:95], v[140:143]
  s_waitcnt lgkmcnt(5)
  buffer_load_dwordx4 a[140:143], v222, s[20:23], s42 offen offset:2304 sc1
  s_waitcnt vmcnt(13)
  v_mfma_f32_16x16x32_bf16 v[80:83], a[224:227], a[96:99], v[80:83]
  ds_read_b64_tr_b16 a[238:239], v13 offset:57344
  s_waitcnt vmcnt(12)
  v_mfma_f32_16x16x32_bf16 v[88:91], a[224:227], a[100:103], v[88:91]
  s_waitcnt vmcnt(11)
  v_mfma_f32_16x16x32_bf16 v[96:99], a[224:227], a[104:107], v[96:99]
  s_add_u32 s34, s34, 4096
  buffer_load_dwordx4 a[144:147], v222, s[20:23], s34 offen sc1
  s_mul_i32 s40, s40, 73728
  s_waitcnt vmcnt(11)
  v_mfma_f32_16x16x32_bf16 v[104:107], a[224:227], a[108:111], v[104:107]
  s_waitcnt lgkmcnt(4)
  ds_read_b64_tr_b16 a[208:209], v12 offset:3072
  v_mfma_f32_16x16x32_bf16 v[84:87], a[228:231], a[96:99], v[84:87]
  ds_read_b64_tr_b16 a[210:211], v12 offset:21504
  v_mfma_f32_16x16x32_bf16 v[92:95], a[228:231], a[100:103], v[92:95]
  v_mfma_f32_16x16x32_bf16 v[100:103], a[228:231], a[104:107], v[100:103]
  s_and_b32 s37, s28, 1
  ds_read_b64_tr_b16 a[212:213], v13 offset:3072
  v_mfma_f32_16x16x32_bf16 v[108:111], a[228:231], a[108:111], v[108:111]
  s_waitcnt lgkmcnt(5)
  buffer_load_dwordx4 a[148:151], v222, s[20:23], s34 offen offset:256 sc1
  v_mfma_f32_16x16x32_bf16 v[112:115], a[232:235], a[96:99], v[112:115]
  ds_read_b64_tr_b16 a[214:215], v13 offset:21504
  v_mfma_f32_16x16x32_bf16 v[120:123], a[232:235], a[100:103], v[120:123]
  v_mfma_f32_16x16x32_bf16 v[128:131], a[232:235], a[104:107], v[128:131]
  s_add_u32 s42, s42, 4096
  buffer_load_dwordx4 a[152:155], v222, s[20:23], s42 offen sc1
  s_mul_i32 s47, s37, 9216
  v_mfma_f32_16x16x32_bf16 v[136:139], a[232:235], a[108:111], v[136:139]
  s_waitcnt lgkmcnt(4)
  ds_read_b64_tr_b16 a[216:217], v12 offset:39936
  v_mfma_f32_16x16x32_bf16 v[116:119], a[236:239], a[96:99], v[116:119]
  ds_read_b64_tr_b16 a[218:219], v12 offset:58368
  v_mfma_f32_16x16x32_bf16 v[124:127], a[236:239], a[100:103], v[124:127]
  v_mfma_f32_16x16x32_bf16 v[132:135], a[236:239], a[104:107], v[132:135]
  s_add_u32 s47, s47, s40
  ds_read_b64_tr_b16 a[220:221], v13 offset:39936
  v_mfma_f32_16x16x32_bf16 v[140:143], a[236:239], a[108:111], v[140:143]
  s_waitcnt lgkmcnt(5)
  buffer_load_dwordx4 a[156:159], v222, s[20:23], s42 offen offset:256 sc1
  s_waitcnt vmcnt(13)
  v_mfma_f32_16x16x32_bf16 v[80:83], a[208:211], a[112:115], v[80:83]
  ds_read_b64_tr_b16 a[222:223], v13 offset:58368
  s_waitcnt vmcnt(12)
  v_mfma_f32_16x16x32_bf16 v[88:91], a[208:211], a[116:119], v[88:91]
  v_and_b32 v228, 15, v1
  s_waitcnt vmcnt(10)
  v_mfma_f32_16x16x32_bf16 v[96:99], a[208:211], a[120:123], v[96:99]
  ds_read_b64_tr_b16 a[224:225], v12 offset:4096
  buffer_load_dwordx4 a[160:163], v222, s[20:23], s34 offen offset:2048 sc1
  s_waitcnt vmcnt(9)
  v_mfma_f32_16x16x32_bf16 v[104:107], a[208:211], a[124:127], v[104:107]
  s_waitcnt lgkmcnt(5)
  v_lshlrev_b32 v228, 2, v228
  s_add_u32 s47, s47, s93
  v_mfma_f32_16x16x32_bf16 v[84:87], a[212:215], a[112:115], v[84:87]
  ds_read_b64_tr_b16 a[226:227], v12 offset:22528
  v_mfma_f32_16x16x32_bf16 v[92:95], a[212:215], a[116:119], v[92:95]
  v_add_u32 v229, 8192, v228
  v_mfma_f32_16x16x32_bf16 v[100:103], a[212:215], a[120:123], v[100:103]
  s_add_u32 s93, s93, 147456
  ds_read_b64_tr_b16 a[228:229], v13 offset:4096
  s_xor_b32 s40, s28, s95
  v_mfma_f32_16x16x32_bf16 v[108:111], a[212:215], a[124:127], v[108:111]
  s_waitcnt lgkmcnt(5)
  buffer_load_dwordx4 a[164:167], v222, s[20:23], s34 offen offset:2304 sc1
  v_mfma_f32_16x16x32_bf16 v[112:115], a[216:219], a[112:115], v[112:115]
  v_min_u32 v226, v226, v227
  v_cmp_gt_u32 vcc, 2, v226
  s_nop 0
  s_cmp_eq_u64 vcc, 0
  s_cbranch_scc0 sequential_preLN__spectral_fnet__swiglu_ffn__prompt_kernel_spinq
sequential_preLN__spectral_fnet__swiglu_ffn__prompt_kernel_goq:
  v_mfma_f32_16x16x32_bf16 v[120:123], a[216:219], a[116:119], v[120:123]
  ds_read_b64_tr_b16 a[230:231], v13 offset:22528
  v_mfma_f32_16x16x32_bf16 v[128:131], a[216:219], a[120:123], v[128:131]
  s_lshl_b32 s40, s40, 12
  ds_read_b64_tr_b16 a[232:233], v12 offset:40960
  v_mfma_f32_16x16x32_bf16 v[136:139], a[216:219], a[124:127], v[136:139]
  s_waitcnt lgkmcnt(5)
  buffer_load_dwordx4 a[168:171], v222, s[20:23], s42 offen offset:2048 sc1
  v_mfma_f32_16x16x32_bf16 v[116:119], a[220:223], a[112:115], v[116:119]
  ds_read_b64_tr_b16 a[234:235], v12 offset:59392
  v_mfma_f32_16x16x32_bf16 v[124:127], a[220:223], a[116:119], v[124:127]
  buffer_load_dword v16, v228, s[20:23], s96 offen sc1
  v_mfma_f32_16x16x32_bf16 v[132:135], a[220:223], a[120:123], v[132:135]
  s_add_u32 s74, s40, s93
  ds_read_b64_tr_b16 a[236:237], v13 offset:40960
  v_mfma_f32_16x16x32_bf16 v[140:143], a[220:223], a[124:127], v[140:143]
  s_waitcnt lgkmcnt(5)
  buffer_load_dwordx4 a[172:175], v222, s[20:23], s42 offen offset:2304 sc1
  s_waitcnt vmcnt(12)
  v_mfma_f32_16x16x32_bf16 v[80:83], a[224:227], a[128:131], v[80:83]
  ds_read_b64_tr_b16 a[238:239], v13 offset:59392
  s_waitcnt vmcnt(11)
  v_mfma_f32_16x16x32_bf16 v[88:91], a[224:227], a[132:135], v[88:91]
  buffer_load_dword v17, v229, s[20:23], s96 offen sc1
  s_waitcnt vmcnt(11)
  v_mfma_f32_16x16x32_bf16 v[96:99], a[224:227], a[136:139], v[96:99]
  s_add_u32 s34, s34, 4096
  buffer_load_dwordx4 a[176:179], v222, s[20:23], s34 offen sc1
  s_lshr_b32 s40, s95, 1
  s_waitcnt vmcnt(11)
  v_mfma_f32_16x16x32_bf16 v[104:107], a[224:227], a[140:143], v[104:107]
  s_waitcnt lgkmcnt(4)
  ds_read_b64_tr_b16 a[208:209], v12 offset:5120
  v_mfma_f32_16x16x32_bf16 v[84:87], a[228:231], a[128:131], v[84:87]
  ds_read_b64_tr_b16 a[210:211], v12 offset:23552
  v_mfma_f32_16x16x32_bf16 v[92:95], a[228:231], a[132:135], v[92:95]
  buffer_load_dword v20, v228, s[20:23], s96 offen offset:64 sc1
  v_mfma_f32_16x16x32_bf16 v[100:103], a[228:231], a[136:139], v[100:103]
  s_xor_b32 s40, s40, s37
  ds_read_b64_tr_b16 a[212:213], v13 offset:5120
  v_mfma_f32_16x16x32_bf16 v[108:111], a[228:231], a[140:143], v[108:111]
  s_waitcnt lgkmcnt(5)
  buffer_load_dwordx4 a[180:183], v222, s[20:23], s34 offen offset:256 sc1
  v_mfma_f32_16x16x32_bf16 v[112:115], a[232:235], a[128:131], v[112:115]
  ds_read_b64_tr_b16 a[214:215], v13 offset:23552
  v_mfma_f32_16x16x32_bf16 v[120:123], a[232:235], a[132:135], v[120:123]
  buffer_load_dword v21, v229, s[20:23], s96 offen offset:64 sc1
  v_mfma_f32_16x16x32_bf16 v[128:131], a[232:235], a[136:139], v[128:131]
  s_add_u32 s42, s42, 4096
  buffer_load_dwordx4 a[184:187], v222, s[20:23], s42 offen sc1
  s_lshl_b32 s40, s40, 10
  v_mfma_f32_16x16x32_bf16 v[136:139], a[232:235], a[140:143], v[136:139]
  s_waitcnt lgkmcnt(4)
  ds_read_b64_tr_b16 a[216:217], v12 offset:41984
  v_mfma_f32_16x16x32_bf16 v[116:119], a[236:239], a[128:131], v[116:119]
  ds_read_b64_tr_b16 a[218:219], v12 offset:60416
  v_mfma_f32_16x16x32_bf16 v[124:127], a[236:239], a[132:135], v[124:127]
  buffer_load_dword v24, v228, s[20:23], s97 offen sc1
  v_mfma_f32_16x16x32_bf16 v[132:135], a[236:239], a[136:139], v[132:135]
  s_add_u32 s40, s40, s93
  ds_read_b64_tr_b16 a[220:221], v13 offset:41984
  v_mfma_f32_16x16x32_bf16 v[140:143], a[236:239], a[140:143], v[140:143]
  s_add_u32 s75, s40, 16384
  buffer_load_dwordx4 a[188:191], v222, s[20:23], s42 offen offset:256 sc1
  s_waitcnt vmcnt(16) lgkmcnt(5)
  v_mfma_f32_16x16x32_bf16 v[80:83], a[208:211], a[144:147], v[80:83]
  ds_read_b64_tr_b16 a[222:223], v13 offset:60416
  s_waitcnt vmcnt(15)
  v_mfma_f32_16x16x32_bf16 v[88:91], a[208:211], a[148:151], v[88:91]
  buffer_load_dword v25, v229, s[20:23], s97 offen sc1
  s_waitcnt vmcnt(15)
  v_mfma_f32_16x16x32_bf16 v[96:99], a[208:211], a[152:155], v[96:99]
  s_lshl_b32 s76, s28, 12
  ds_read_b64_tr_b16 a[224:225], v12 offset:6144
  s_waitcnt vmcnt(14)
  v_mfma_f32_16x16x32_bf16 v[104:107], a[208:211], a[156:159], v[104:107]
  s_waitcnt lgkmcnt(5)
  buffer_load_dwordx4 a[192:195], v222, s[20:23], s34 offen offset:2048 sc1
  v_mfma_f32_16x16x32_bf16 v[84:87], a[212:215], a[144:147], v[84:87]
  ds_read_b64_tr_b16 a[226:227], v12 offset:24576
  v_mfma_f32_16x16x32_bf16 v[92:95], a[212:215], a[148:151], v[92:95]
  buffer_load_dword v28, v228, s[20:23], s97 offen offset:64 sc1
  v_mfma_f32_16x16x32_bf16 v[100:103], a[212:215], a[152:155], v[100:103]
  s_lshl_b32 s40, s37, 10
  ds_read_b64_tr_b16 a[228:229], v13 offset:6144
  v_mfma_f32_16x16x32_bf16 v[108:111], a[212:215], a[156:159], v[108:111]
  s_waitcnt lgkmcnt(5)
  buffer_load_dwordx4 a[196:199], v222, s[20:23], s34 offen offset:2304 sc1
  v_mfma_f32_16x16x32_bf16 v[112:115], a[216:219], a[144:147], v[112:115]
  ds_read_b64_tr_b16 a[230:231], v13 offset:24576
  v_mfma_f32_16x16x32_bf16 v[120:123], a[216:219], a[148:151], v[120:123]
  buffer_load_dword v29, v229, s[20:23], s97 offen offset:64 sc1
  v_mfma_f32_16x16x32_bf16 v[128:131], a[216:219], a[152:155], v[128:131]
  s_add_u32 s77, s40, 16384
  ds_read_b64_tr_b16 a[232:233], v12 offset:43008
  v_mfma_f32_16x16x32_bf16 v[136:139], a[216:219], a[156:159], v[136:139]
  s_waitcnt lgkmcnt(5)
  buffer_load_dwordx4 a[200:203], v222, s[20:23], s42 offen offset:2048 sc1
  v_mfma_f32_16x16x32_bf16 v[116:119], a[220:223], a[144:147], v[116:119]
  ds_read_b64_tr_b16 a[234:235], v12 offset:61440
  v_mfma_f32_16x16x32_bf16 v[124:127], a[220:223], a[148:151], v[124:127]
  v_mfma_f32_16x16x32_bf16 v[132:135], a[220:223], a[152:155], v[132:135]
  ds_read_b64_tr_b16 a[236:237], v13 offset:43008
  v_mfma_f32_16x16x32_bf16 v[140:143], a[220:223], a[156:159], v[140:143]
  s_waitcnt lgkmcnt(5)
  buffer_load_dwordx4 a[204:207], v222, s[20:23], s42 offen offset:2304 sc1
  s_waitcnt vmcnt(19)
  v_mfma_f32_16x16x32_bf16 v[80:83], a[224:227], a[160:163], v[80:83]
  ds_read_b64_tr_b16 a[238:239], v13 offset:61440
  s_waitcnt vmcnt(18)
  v_mfma_f32_16x16x32_bf16 v[88:91], a[224:227], a[164:167], v[88:91]
  s_waitcnt vmcnt(17)
  v_mfma_f32_16x16x32_bf16 v[96:99], a[224:227], a[168:171], v[96:99]
  s_add_u32 s3, s44, 128
  ds_read_b64_tr_b16 a[208:209], v12 offset:7168
  s_waitcnt vmcnt(15)
  v_mfma_f32_16x16x32_bf16 v[104:107], a[224:227], a[172:175], v[104:107]
  s_waitcnt lgkmcnt(5)
  v_mfma_f32_16x16x32_bf16 v[84:87], a[228:231], a[160:163], v[84:87]
  ds_read_b64_tr_b16 a[210:211], v12 offset:25600
  v_mfma_f32_16x16x32_bf16 v[92:95], a[228:231], a[164:167], v[92:95]
  buffer_load_dword v223, v250, s[8:11], s3 offen
  v_mfma_f32_16x16x32_bf16 v[100:103], a[228:231], a[168:171], v[100:103]
  ds_read_b64_tr_b16 a[212:213], v13 offset:7168
  v_mfma_f32_16x16x32_bf16 v[108:111], a[228:231], a[172:175], v[108:111]
  s_waitcnt lgkmcnt(5)
  v_mfma_f32_16x16x32_bf16 v[112:115], a[232:235], a[160:163], v[112:115]
  ds_read_b64_tr_b16 a[214:215], v13 offset:25600
  v_mfma_f32_16x16x32_bf16 v[120:123], a[232:235], a[164:167], v[120:123]
  v_mfma_f32_16x16x32_bf16 v[128:131], a[232:235], a[168:171], v[128:131]
  ds_read_b64_tr_b16 a[216:217], v12 offset:44032
  v_mfma_f32_16x16x32_bf16 v[136:139], a[232:235], a[172:175], v[136:139]
  s_waitcnt lgkmcnt(5)
  v_mfma_f32_16x16x32_bf16 v[116:119], a[236:239], a[160:163], v[116:119]
  ds_read_b64_tr_b16 a[218:219], v12 offset:62464
  v_mfma_f32_16x16x32_bf16 v[124:127], a[236:239], a[164:167], v[124:127]
  v_mfma_f32_16x16x32_bf16 v[132:135], a[236:239], a[168:171], v[132:135]
  ds_read_b64_tr_b16 a[220:221], v13 offset:44032
  v_mfma_f32_16x16x32_bf16 v[140:143], a[236:239], a[172:175], v[140:143]
  s_waitcnt lgkmcnt(5)
  s_waitcnt vmcnt(14)
  v_mfma_f32_16x16x32_bf16 v[80:83], a[208:211], a[176:179], v[80:83]
  ds_read_b64_tr_b16 a[222:223], v13 offset:62464
  s_waitcnt vmcnt(12)
  v_mfma_f32_16x16x32_bf16 v[88:91], a[208:211], a[180:183], v[88:91]
  s_waitcnt vmcnt(10)
  v_mfma_f32_16x16x32_bf16 v[96:99], a[208:211], a[184:187], v[96:99]
  ds_read_b64_tr_b16 a[224:225], v12 offset:8192
  s_waitcnt vmcnt(8)
  v_mfma_f32_16x16x32_bf16 v[104:107], a[208:211], a[188:191], v[104:107]
  s_waitcnt lgkmcnt(5)
  v_mfma_f32_16x16x32_bf16 v[84:87], a[212:215], a[176:179], v[84:87]
  ds_read_b64_tr_b16 a[226:227], v12 offset:26624
  v_mfma_f32_16x16x32_bf16 v[92:95], a[212:215], a[180:183], v[92:95]
  v_mfma_f32_16x16x32_bf16 v[100:103], a[212:215], a[184:187], v[100:103]
  ds_read_b64_tr_b16 a[228:229], v13 offset:8192
  v_mfma_f32_16x16x32_bf16 v[108:111], a[212:215], a[188:191], v[108:111]
  s_waitcnt lgkmcnt(5)
  v_mfma_f32_16x16x32_bf16 v[112:115], a[216:219], a[176:179], v[112:115]
  ds_read_b64_tr_b16 a[230:231], v13 offset:26624
  v_mov_b32 v196, 0x3727c5ac
  v_mfma_f32_16x16x32_bf16 v[120:123], a[216:219], a[180:183], v[120:123]
  v_mov_b32 v197, 0x3727c5ac
  v_mov_b32 v198, 0x3727c5ac
  v_mfma_f32_16x16x32_bf16 v[128:131], a[216:219], a[184:187], v[128:131]
  s_add_u32 s3, s44, 2654336
  ds_read_b64_tr_b16 a[232:233], v12 offset:45056
  v_mov_b32 v199, 0x3727c5ac
  v_mfma_f32_16x16x32_bf16 v[136:139], a[216:219], a[188:191], v[136:139]
  s_waitcnt lgkmcnt(5)
  v_add_f32 v16, v17, v16
  v_add_f32 v20, v21, v20
  v_mfma_f32_16x16x32_bf16 v[116:119], a[220:223], a[176:179], v[116:119]
  ds_read_b64_tr_b16 a[234:235], v12 offset:63488
  s_waitcnt vmcnt(7)
  v_add_f32 v24, v25, v24
  v_mfma_f32_16x16x32_bf16 v[124:127], a[220:223], a[180:183], v[124:127]
  buffer_load_dword v223, v250, s[8:11], s3 offen
  s_waitcnt vmcnt(4)
  v_add_f32 v28, v29, v28
  v_mfma_f32_16x16x32_bf16 v[132:135], a[220:223], a[184:187], v[132:135]
  ds_read_b64_tr_b16 a[236:237], v13 offset:45056
  v_fmac_f32 v196, 0x3ae38e39, v16
  v_mfma_f32_16x16x32_bf16 v[140:143], a[220:223], a[188:191], v[140:143]
  s_waitcnt lgkmcnt(5)
  buffer_load_dword v223, v15, s[4:7], 0 offen
  v_fmac_f32 v197, 0x3ae38e39, v20
  v_mfma_f32_16x16x32_bf16 v[80:83], a[224:227], a[192:195], v[80:83]
  ds_read_b64_tr_b16 a[238:239], v13 offset:63488
  v_fmac_f32 v198, 0x3ae38e39, v24
  v_mfma_f32_16x16x32_bf16 v[88:91], a[224:227], a[196:199], v[88:91]
  v_fmac_f32 v199, 0x3ae38e39, v28
  s_waitcnt vmcnt(4)
  v_mfma_f32_16x16x32_bf16 v[96:99], a[224:227], a[200:203], v[96:99]
  ds_read_b64_tr_b16 a[208:209], v10 offset:512
  s_waitcnt vmcnt(3)
  v_mfma_f32_16x16x32_bf16 v[104:107], a[224:227], a[204:207], v[104:107]
  s_waitcnt lgkmcnt(5)
  v_rsq_f32 v192, v196
  v_mfma_f32_16x16x32_bf16 v[84:87], a[228:231], a[192:195], v[84:87]
  ds_read_b64_tr_b16 a[210:211], v10 offset:18944
  v_mul_f32 v192, 0xbfb8aa3b, v192
  v_mfma_f32_16x16x32_bf16 v[92:95], a[228:231], a[196:199], v[92:95]
  v_rsq_f32 v193, v197
  v_mfma_f32_16x16x32_bf16 v[100:103], a[228:231], a[200:203], v[100:103]
  ds_read_b64_tr_b16 a[212:213], v10 offset:1536
  v_mul_f32 v193, 0xbfb8aa3b, v193
  v_mfma_f32_16x16x32_bf16 v[108:111], a[228:231], a[204:207], v[108:111]
  s_waitcnt lgkmcnt(5)
  v_rsq_f32 v194, v198
  v_mfma_f32_16x16x32_bf16 v[112:115], a[232:235], a[192:195], v[112:115]
  ds_read_b64_tr_b16 a[214:215], v10 offset:19968
  v_mul_f32 v194, 0xbfb8aa3b, v194
  v_mfma_f32_16x16x32_bf16 v[120:123], a[232:235], a[196:199], v[120:123]
  v_rsq_f32 v195, v199
  v_mfma_f32_16x16x32_bf16 v[128:131], a[232:235], a[200:203], v[128:131]
  ds_read_b64_tr_b16 a[216:217], v10 offset:2560
  v_mul_f32 v195, 0xbfb8aa3b, v195
  v_mfma_f32_16x16x32_bf16 v[136:139], a[232:235], a[204:207], v[136:139]
  s_waitcnt lgkmcnt(5)
  v_mfma_f32_16x16x32_bf16 v[116:119], a[236:239], a[192:195], v[116:119]
  ds_read_b64_tr_b16 a[218:219], v10 offset:20992
  v_mul_f32 v224, v80, v192
  v_mfma_f32_16x16x32_bf16 v[124:127], a[236:239], a[196:199], v[124:127]
  v_mul_f32 v225, v81, v192
  v_mul_f32 v226, v82, v192
  v_mfma_f32_16x16x32_bf16 v[132:135], a[236:239], a[200:203], v[132:135]
  ds_read_b64_tr_b16 a[220:221], v10 offset:3584
  v_mul_f32 v227, v83, v192
  v_mfma_f32_16x16x32_bf16 v[140:143], a[236:239], a[204:207], v[140:143]
  s_waitcnt lgkmcnt(5)
  v_exp_f32 v224, v224
  v_mfma_f32_16x16x32_bf16 v[48:51], a[208:211], v[144:147], 0
  ds_read_b64_tr_b16 a[222:223], v10 offset:22016
  v_fma_f32 v224, v224, v196, v196
  v_mfma_f32_16x16x32_bf16 v[56:59], a[208:211], v[148:151], 0
  v_exp_f32 v225, v225
  v_mfma_f32_16x16x32_bf16 v[64:67], a[208:211], v[152:155], 0
  s_add_u32 s3, s44, 128
  ds_read_b64_tr_b16 a[224:225], v10 offset:4608
  v_fma_f32 v225, v225, v196, v196
  v_mfma_f32_16x16x32_bf16 v[72:75], a[208:211], v[156:159], 0
  s_waitcnt lgkmcnt(5)
  v_exp_f32 v226, v226
  v_mfma_f32_16x16x32_bf16 v[48:51], a[212:215], v[160:163], v[48:51]
  ds_read_b64_tr_b16 a[226:227], v10 offset:23040
  buffer_load_dword v223, v250, s[12:15], s3 offen
  v_mfma_f32_16x16x32_bf16 v[56:59], a[212:215], v[164:167], v[56:59]
  v_exp_f32 v227, v227
  v_mfma_f32_16x16x32_bf16 v[64:67], a[212:215], v[168:171], v[64:67]
  ds_read_b64_tr_b16 a[228:229], v10 offset:5632
  v_fma_f32 v226, v226, v196, v196
  v_mfma_f32_16x16x32_bf16 v[72:75], a[212:215], v[172:175], v[72:75]
  s_waitcnt lgkmcnt(5)
  v_fma_f32 v227, v227, v196, v196
  v_mfma_f32_16x16x32_bf16 v[48:51], a[216:219], v[176:179], v[48:51]
  ds_read_b64_tr_b16 a[230:231], v10 offset:24064
  v_mul_f32 v228, v88, v193
  v_mfma_f32_16x16x32_bf16 v[56:59], a[216:219], v[180:183], v[56:59]
  v_rcp_f32 v224, v224
  v_mfma_f32_16x16x32_bf16 v[64:67], a[216:219], v[184:187], v[64:67]
  ds_read_b64_tr_b16 a[232:233], v10 offset:6656
  v_mul_f32 v80, v80, v224
  v_mfma_f32_16x16x32_bf16 v[72:75], a[216:219], v[188:191], v[72:75]
  s_waitcnt lgkmcnt(5)
  v_rcp_f32 v225, v225
  v_mfma_f32_16x16x32_bf16 v[48:51], a[220:223], v[204:207], v[48:51]
  ds_read_b64_tr_b16 a[234:235], v10 offset:25088
  v_mul_f32 v81, v81, v225
  v_mfma_f32_16x16x32_bf16 v[56:59], a[220:223], v[208:211], v[56:59]
  v_rcp_f32 v226, v226
  v_mfma_f32_16x16x32_bf16 v[64:67], a[220:223], v[212:215], v[64:67]
  ds_read_b64_tr_b16 a[236:237], v10 offset:7680
  v_mul_f32 v82, v82, v226
  v_mfma_f32_16x16x32_bf16 v[72:75], a[220:223], v[216:219], v[72:75]
  s_waitcnt lgkmcnt(5)
  v_rcp_f32 v227, v227
  v_mfma_f32_16x16x32_bf16 v[48:51], a[224:227], v[232:235], v[48:51]
  ds_read_b64_tr_b16 a[238:239], v10 offset:26112
  v_mul_f32 v83, v83, v227
  v_mfma_f32_16x16x32_bf16 v[56:59], a[224:227], v[236:239], v[56:59]
  v_mul_f32 v229, v89, v193
  v_mul_f32 v230, v90, v193
  v_mfma_f32_16x16x32_bf16 v[64:67], a[224:227], v[240:243], v[64:67]
  ds_read_b64_tr_b16 a[208:209], v10 offset:8704
  v_mul_f32 v231, v91, v193
  v_mfma_f32_16x16x32_bf16 v[72:75], a[224:227], v[244:247], v[72:75]
  s_waitcnt lgkmcnt(5)
  v_exp_f32 v228, v228
  v_mfma_f32_16x16x32_bf16 v[48:51], a[228:231], a[0:3], v[48:51]
  ds_read_b64_tr_b16 a[210:211], v10 offset:27136
  v_fma_f32 v228, v228, v197, v197
  v_mfma_f32_16x16x32_bf16 v[56:59], a[228:231], a[4:7], v[56:59]
  v_exp_f32 v229, v229
  v_mfma_f32_16x16x32_bf16 v[64:67], a[228:231], a[8:11], v[64:67]
  ds_read_b64_tr_b16 a[212:213], v11 offset:512
  v_fma_f32 v229, v229, v197, v197
  v_mfma_f32_16x16x32_bf16 v[72:75], a[228:231], a[12:15], v[72:75]
  s_waitcnt lgkmcnt(5)
  v_exp_f32 v230, v230
  v_mfma_f32_16x16x32_bf16 v[48:51], a[232:235], a[16:19], v[48:51]
  ds_read_b64_tr_b16 a[214:215], v11 offset:18944
  v_fma_f32 v230, v230, v197, v197
  v_mfma_f32_16x16x32_bf16 v[56:59], a[232:235], a[20:23], v[56:59]
  v_exp_f32 v231, v231
  v_mfma_f32_16x16x32_bf16 v[64:67], a[232:235], a[24:27], v[64:67]
  s_add_u32 s3, s44, 2654336
  ds_read_b64_tr_b16 a[216:217], v11 offset:1536
  v_fma_f32 v231, v231, v197, v197
  v_mfma_f32_16x16x32_bf16 v[72:75], a[232:235], a[28:31], v[72:75]
  s_waitcnt lgkmcnt(5)
  v_rcp_f32 v228, v228
  v_mfma_f32_16x16x32_bf16 v[48:51], a[236:239], a[32:35], v[48:51]
  ds_read_b64_tr_b16 a[218:219], v11 offset:19968
  buffer_load_dword v223, v250, s[12:15], s3 offen
  v_mfma_f32_16x16x32_bf16 v[56:59], a[236:239], a[36:39], v[56:59]
  v_rcp_f32 v229, v229
  v_mfma_f32_16x16x32_bf16 v[64:67], a[236:239], a[40:43], v[64:67]
  ds_read_b64_tr_b16 a[220:221], v11 offset:2560
  v_mul_f32 v88, v88, v228
  v_mfma_f32_16x16x32_bf16 v[72:75], a[236:239], a[44:47], v[72:75]
  s_waitcnt lgkmcnt(5)
  v_rcp_f32 v230, v230
  v_mfma_f32_16x16x32_bf16 v[48:51], a[208:211], a[48:51], v[48:51]
  ds_read_b64_tr_b16 a[222:223], v11 offset:20992
  v_mul_f32 v89, v89, v229
  v_mfma_f32_16x16x32_bf16 v[56:59], a[208:211], a[52:55], v[56:59]
  v_rcp_f32 v231, v231
  v_mfma_f32_16x16x32_bf16 v[64:67], a[208:211], a[56:59], v[64:67]
  ds_read_b64_tr_b16 a[224:225], v11 offset:3584
  v_mul_f32 v90, v90, v230
  v_mfma_f32_16x16x32_bf16 v[72:75], a[208:211], a[60:63], v[72:75]
  s_waitcnt lgkmcnt(5)
  v_mul_f32 v91, v91, v231
  v_mul_f32 v224, v96, v194
  v_mfma_f32_16x16x32_bf16 v[52:55], a[212:215], v[144:147], 0
  ds_read_b64_tr_b16 a[226:227], v11 offset:22016
  v_mul_f32 v225, v97, v194
  v_mfma_f32_16x16x32_bf16 v[60:63], a[212:215], v[148:151], 0
  v_mul_f32 v226, v98, v194
  v_mul_f32 v227, v99, v194
  v_mfma_f32_16x16x32_bf16 v[68:71], a[212:215], v[152:155], 0
  ds_read_b64_tr_b16 a[228:229], v11 offset:4608
  v_mfma_f32_16x16x32_bf16 v[76:79], a[212:215], v[156:159], 0
  s_waitcnt lgkmcnt(5)
  v_exp_f32 v224, v224
  v_mfma_f32_16x16x32_bf16 v[52:55], a[216:219], v[160:163], v[52:55]
  ds_read_b64_tr_b16 a[230:231], v11 offset:23040
  v_fma_f32 v224, v224, v198, v198
  v_mfma_f32_16x16x32_bf16 v[60:63], a[216:219], v[164:167], v[60:63]
  v_exp_f32 v225, v225
  v_mfma_f32_16x16x32_bf16 v[68:71], a[216:219], v[168:171], v[68:71]
  ds_read_b64_tr_b16 a[232:233], v11 offset:5632
  v_fma_f32 v225, v225, v198, v198
  v_mfma_f32_16x16x32_bf16 v[76:79], a[216:219], v[172:175], v[76:79]
  s_waitcnt lgkmcnt(5)
  v_exp_f32 v226, v226
  v_mfma_f32_16x16x32_bf16 v[52:55], a[220:223], v[176:179], v[52:55]
  ds_read_b64_tr_b16 a[234:235], v11 offset:24064
  v_fma_f32 v226, v226, v198, v198
  v_mfma_f32_16x16x32_bf16 v[60:63], a[220:223], v[180:183], v[60:63]
  v_exp_f32 v227, v227
  v_mfma_f32_16x16x32_bf16 v[68:71], a[220:223], v[184:187], v[68:71]
  ds_read_b64_tr_b16 a[236:237], v11 offset:6656
  v_fma_f32 v227, v227, v198, v198
  v_mfma_f32_16x16x32_bf16 v[76:79], a[220:223], v[188:191], v[76:79]
  s_waitcnt lgkmcnt(5)
  v_rcp_f32 v224, v224
  v_mfma_f32_16x16x32_bf16 v[52:55], a[224:227], v[204:207], v[52:55]
  ds_read_b64_tr_b16 a[238:239], v11 offset:25088
  v_mul_f32 v96, v96, v224
  v_mfma_f32_16x16x32_bf16 v[60:63], a[224:227], v[208:211], v[60:63]
  v_rcp_f32 v225, v225
  v_mfma_f32_16x16x32_bf16 v[68:71], a[224:227], v[212:215], v[68:71]
  s_add_u32 s3, s33, 0
  ds_read_b64_tr_b16 a[208:209], v11 offset:7680
  v_mul_f32 v97, v97, v225
  v_mfma_f32_16x16x32_bf16 v[76:79], a[224:227], v[216:219], v[76:79]
  s_waitcnt lgkmcnt(5)
  v_rcp_f32 v226, v226
  v_mfma_f32_16x16x32_bf16 v[52:55], a[228:231], v[232:235], v[52:55]
  ds_read_b64_tr_b16 a[210:211], v11 offset:26112
  buffer_load_dword v223, v251, s[16:19], s3 offen
  v_mfma_f32_16x16x32_bf16 v[60:63], a[228:231], v[236:239], v[60:63]
  v_rcp_f32 v227, v227
  v_mfma_f32_16x16x32_bf16 v[68:71], a[228:231], v[240:243], v[68:71]
  ds_read_b64_tr_b16 a[212:213], v11 offset:8704
  v_mul_f32 v98, v98, v226
  v_mfma_f32_16x16x32_bf16 v[76:79], a[228:231], v[244:247], v[76:79]
  s_waitcnt lgkmcnt(5)
  v_mul_f32 v99, v99, v227
  v_mul_f32 v228, v104, v195
  v_mfma_f32_16x16x32_bf16 v[52:55], a[232:235], a[0:3], v[52:55]
  ds_read_b64_tr_b16 a[214:215], v11 offset:27136
  v_mul_f32 v229, v105, v195
  v_mfma_f32_16x16x32_bf16 v[60:63], a[232:235], a[4:7], v[60:63]
  v_mul_f32 v230, v106, v195
  v_mul_f32 v231, v107, v195
  v_mfma_f32_16x16x32_bf16 v[68:71], a[232:235], a[8:11], v[68:71]
  ds_read_b64_tr_b16 a[216:217], v12 offset:512
  v_mfma_f32_16x16x32_bf16 v[76:79], a[232:235], a[12:15], v[76:79]
  s_waitcnt lgkmcnt(5)
  v_exp_f32 v228, v228
  v_mfma_f32_16x16x32_bf16 v[52:55], a[236:239], a[16:19], v[52:55]
  ds_read_b64_tr_b16 a[218:219], v12 offset:18944
  v_fma_f32 v228, v228, v199, v199
  v_mfma_f32_16x16x32_bf16 v[60:63], a[236:239], a[20:23], v[60:63]
  v_exp_f32 v229, v229
  v_mfma_f32_16x16x32_bf16 v[68:71], a[236:239], a[24:27], v[68:71]
  ds_read_b64_tr_b16 a[220:221], v12 offset:1536
  v_fma_f32 v229, v229, v199, v199
  v_mfma_f32_16x16x32_bf16 v[76:79], a[236:239], a[28:31], v[76:79]
  s_waitcnt lgkmcnt(5)
  v_exp_f32 v230, v230
  v_exp_f32 v231, v231
  v_mfma_f32_16x16x32_bf16 v[52:55], a[208:211], a[32:35], v[52:55]
  s_waitcnt lgkmcnt(3)
  s_barrier
  ds_read_b64_tr_b16 a[222:223], v12 offset:19968
  v_fma_f32 v230, v230, v199, v199
  v_mfma_f32_16x16x32_bf16 v[60:63], a[208:211], a[36:39], v[60:63]
  v_fma_f32 v231, v231, v199, v199
  v_mul_f32 v80, v80, v112
  v_mfma_f32_16x16x32_bf16 v[68:71], a[208:211], a[40:43], v[68:71]
  ds_read_b64_tr_b16 a[224:225], v12 offset:2560
  v_mul_f32 v81, v81, v113
  v_mfma_f32_16x16x32_bf16 v[76:79], a[208:211], a[44:47], v[76:79]
  v_rcp_f32 v228, v228
  v_mfma_f32_16x16x32_bf16 v[52:55], a[212:215], a[48:51], v[52:55]
  ds_read_b64_tr_b16 a[226:227], v12 offset:20992
  v_mul_f32 v104, v104, v228
  v_mfma_f32_16x16x32_bf16 v[60:63], a[212:215], a[52:55], v[60:63]
  v_rcp_f32 v229, v229
  v_mfma_f32_16x16x32_bf16 v[68:71], a[212:215], a[56:59], v[68:71]
  ds_read_b64_tr_b16 a[228:229], v12 offset:3584
  v_mul_f32 v105, v105, v229
  v_mfma_f32_16x16x32_bf16 v[76:79], a[212:215], a[60:63], v[76:79]
  s_waitcnt lgkmcnt(5)
  v_rcp_f32 v230, v230
  v_mfma_f32_16x16x32_bf16 v[48:51], a[216:219], a[64:67], v[48:51]
  ds_read_b64_tr_b16 a[230:231], v12 offset:22016
  v_mul_f32 v106, v106, v230
  v_mfma_f32_16x16x32_bf16 v[56:59], a[216:219], a[68:71], v[56:59]
  v_rcp_f32 v231, v231
  v_mfma_f32_16x16x32_bf16 v[64:67], a[216:219], a[72:75], v[64:67]
  s_add_u32 s3, s33, 1152
  ds_read_b64_tr_b16 a[232:233], v12 offset:4608
  v_mul_f32 v107, v107, v231
  v_mfma_f32_16x16x32_bf16 v[72:75], a[216:219], a[76:79], v[72:75]
  s_waitcnt lgkmcnt(5)
  v_mul_f32 v82, v82, v114
  v_mul_f32 v83, v83, v115
  v_mfma_f32_16x16x32_bf16 v[48:51], a[220:223], a[80:83], v[48:51]
  ds_read_b64_tr_b16 a[234:235], v12 offset:23040
  v_cvt_pk_bf16_f32 v16, v80, v81
  v_mfma_f32_16x16x32_bf16 v[56:59], a[220:223], a[84:87], v[56:59]
  buffer_load_dword v223, v251, s[16:19], s3 offen
  v_cvt_pk_bf16_f32 v17, v82, v83
  v_mfma_f32_16x16x32_bf16 v[64:67], a[220:223], a[88:91], v[64:67]
  ds_read_b64_tr_b16 a[236:237], v12 offset:5632
  v_mul_f32 v88, v88, v120
  v_mfma_f32_16x16x32_bf16 v[72:75], a[220:223], a[92:95], v[72:75]
  s_waitcnt lgkmcnt(5)
  v_mul_f32 v89, v89, v121
  v_mul_f32 v90, v90, v122
  v_mfma_f32_16x16x32_bf16 v[48:51], a[224:227], a[96:99], v[48:51]
  ds_read_b64_tr_b16 a[238:239], v12 offset:24064
  v_mul_f32 v91, v91, v123
  v_mfma_f32_16x16x32_bf16 v[56:59], a[224:227], a[100:103], v[56:59]
  v_cvt_pk_bf16_f32 v20, v88, v89
  v_cvt_pk_bf16_f32 v21, v90, v91
  v_mfma_f32_16x16x32_bf16 v[64:67], a[224:227], a[104:107], v[64:67]
  ds_read_b64_tr_b16 a[208:209], v12 offset:6656
  v_mul_f32 v96, v96, v128
  v_mfma_f32_16x16x32_bf16 v[72:75], a[224:227], a[108:111], v[72:75]
  s_waitcnt lgkmcnt(5)
  v_mul_f32 v97, v97, v129
  v_mul_f32 v98, v98, v130
  v_mfma_f32_16x16x32_bf16 v[48:51], a[228:231], a[112:115], v[48:51]
  ds_read_b64_tr_b16 a[210:211], v12 offset:25088
  v_mul_f32 v99, v99, v131
  v_mfma_f32_16x16x32_bf16 v[56:59], a[228:231], a[116:119], v[56:59]
  v_cvt_pk_bf16_f32 v24, v96, v97
  v_cvt_pk_bf16_f32 v25, v98, v99
  v_mfma_f32_16x16x32_bf16 v[64:67], a[228:231], a[120:123], v[64:67]
  ds_read_b64_tr_b16 a[212:213], v12 offset:7680
  v_mul_f32 v104, v104, v136
  v_mfma_f32_16x16x32_bf16 v[72:75], a[228:231], a[124:127], v[72:75]
  s_waitcnt lgkmcnt(5)
  v_mul_f32 v105, v105, v137
  v_mul_f32 v106, v106, v138
  v_mfma_f32_16x16x32_bf16 v[48:51], a[232:235], a[128:131], v[48:51]
  ds_read_b64_tr_b16 a[214:215], v12 offset:26112
  v_mul_f32 v107, v107, v139
  v_mfma_f32_16x16x32_bf16 v[56:59], a[232:235], a[132:135], v[56:59]
  v_cvt_pk_bf16_f32 v28, v104, v105
  v_cvt_pk_bf16_f32 v29, v106, v107
  v_mfma_f32_16x16x32_bf16 v[64:67], a[232:235], a[136:139], v[64:67]
  ds_read_b64_tr_b16 a[216:217], v12 offset:8704
  v_mul_f32 v224, v84, v192
  v_mfma_f32_16x16x32_bf16 v[72:75], a[232:235], a[140:143], v[72:75]
  s_waitcnt lgkmcnt(5)
  v_mul_f32 v225, v85, v192
  v_mul_f32 v226, v86, v192
  v_mfma_f32_16x16x32_bf16 v[48:51], a[236:239], a[144:147], v[48:51]
  ds_read_b64_tr_b16 a[218:219], v12 offset:27136
  v_mul_f32 v227, v87, v192
  v_mfma_f32_16x16x32_bf16 v[56:59], a[236:239], a[148:151], v[56:59]
  v_exp_f32 v224, v224
  v_mfma_f32_16x16x32_bf16 v[64:67], a[236:239], a[152:155], v[64:67]
  ds_read_b64_tr_b16 a[220:221], v13 offset:512
  v_fma_f32 v224, v224, v196, v196
  v_mfma_f32_16x16x32_bf16 v[72:75], a[236:239], a[156:159], v[72:75]
  s_waitcnt lgkmcnt(5)
  v_exp_f32 v225, v225
  v_mfma_f32_16x16x32_bf16 v[48:51], a[208:211], a[160:163], v[48:51]
  ds_read_b64_tr_b16 a[222:223], v13 offset:18944
  v_fma_f32 v225, v225, v196, v196
  v_mfma_f32_16x16x32_bf16 v[56:59], a[208:211], a[164:167], v[56:59]
  v_exp_f32 v226, v226
  v_mfma_f32_16x16x32_bf16 v[64:67], a[208:211], a[168:171], v[64:67]
  s_add_u32 s3, s33, 2304
  ds_read_b64_tr_b16 a[224:225], v13 offset:1536
  v_fma_f32 v226, v226, v196, v196
  v_mfma_f32_16x16x32_bf16 v[72:75], a[208:211], a[172:175], v[72:75]
  s_waitcnt lgkmcnt(5)
  v_exp_f32 v227, v227
  v_mfma_f32_16x16x32_bf16 v[48:51], a[212:215], a[176:179], v[48:51]
  ds_read_b64_tr_b16 a[226:227], v13 offset:19968
  v_fma_f32 v227, v227, v196, v196
  v_mfma_f32_16x16x32_bf16 v[56:59], a[212:215], a[180:183], v[56:59]
  buffer_load_dword v223, v251, s[16:19], s3 offen
  v_mul_f32 v228, v92, v193
  v_mfma_f32_16x16x32_bf16 v[64:67], a[212:215], a[184:187], v[64:67]
  ds_read_b64_tr_b16 a[228:229], v13 offset:2560
  v_mul_f32 v229, v93, v193
  v_mfma_f32_16x16x32_bf16 v[72:75], a[212:215], a[188:191], v[72:75]
  s_waitcnt lgkmcnt(5)
  v_rcp_f32 v224, v224
  v_rcp_f32 v225, v225
  v_mfma_f32_16x16x32_bf16 v[48:51], a[216:219], a[192:195], v[48:51]
  ds_read_b64_tr_b16 a[230:231], v13 offset:20992
  v_mul_f32 v84, v84, v224
  v_mfma_f32_16x16x32_bf16 v[56:59], a[216:219], a[196:199], v[56:59]
  v_rcp_f32 v226, v226
  v_mfma_f32_16x16x32_bf16 v[64:67], a[216:219], a[200:203], v[64:67]
  ds_read_b64_tr_b16 a[232:233], v13 offset:3584
  v_mul_f32 v85, v85, v225
  v_mfma_f32_16x16x32_bf16 v[72:75], a[216:219], a[204:207], v[72:75]
  s_waitcnt lgkmcnt(5)
  v_rcp_f32 v227, v227
  v_mfma_f32_16x16x32_bf16 v[52:55], a[220:223], a[64:67], v[52:55]
  ds_read_b64_tr_b16 a[234:235], v13 offset:22016
  v_mul_f32 v86, v86, v226
  v_mfma_f32_16x16x32_bf16 v[60:63], a[220:223], a[68:71], v[60:63]
  v_mul_f32 v87, v87, v227
  v_mul_f32 v230, v94, v193
  v_mfma_f32_16x16x32_bf16 v[68:71], a[220:223], a[72:75], v[68:71]
  ds_read_b64_tr_b16 a[236:237], v13 offset:4608
  v_mul_f32 v231, v95, v193
  v_mfma_f32_16x16x32_bf16 v[76:79], a[220:223], a[76:79], v[76:79]
  s_waitcnt lgkmcnt(5)
  v_exp_f32 v228, v228
  v_mfma_f32_16x16x32_bf16 v[52:55], a[224:227], a[80:83], v[52:55]
  ds_read_b64_tr_b16 a[238:239], v13 offset:23040
  v_fma_f32 v228, v228, v197, v197
  v_mfma_f32_16x16x32_bf16 v[60:63], a[224:227], a[84:87], v[60:63]
  v_exp_f32 v229, v229
  v_mfma_f32_16x16x32_bf16 v[68:71], a[224:227], a[88:91], v[68:71]
  ds_read_b64_tr_b16 a[208:209], v13 offset:5632
  v_fma_f32 v229, v229, v197, v197
  v_mfma_f32_16x16x32_bf16 v[76:79], a[224:227], a[92:95], v[76:79]
  s_waitcnt lgkmcnt(5)
  v_exp_f32 v230, v230
  v_mfma_f32_16x16x32_bf16 v[52:55], a[228:231], a[96:99], v[52:55]
  ds_read_b64_tr_b16 a[210:211], v13 offset:24064
  v_fma_f32 v230, v230, v197, v197
  v_mfma_f32_16x16x32_bf16 v[60:63], a[228:231], a[100:103], v[60:63]
  v_exp_f32 v231, v231
  v_mfma_f32_16x16x32_bf16 v[68:71], a[228:231], a[104:107], v[68:71]
  ds_read_b64_tr_b16 a[212:213], v13 offset:6656
  v_fma_f32 v231, v231, v197, v197
  v_mfma_f32_16x16x32_bf16 v[76:79], a[228:231], a[108:111], v[76:79]
  s_waitcnt lgkmcnt(5)
  v_rcp_f32 v228, v228
  v_mfma_f32_16x16x32_bf16 v[52:55], a[232:235], a[112:115], v[52:55]
  ds_read_b64_tr_b16 a[214:215], v13 offset:25088
  v_mul_f32 v92, v92, v228
  v_mfma_f32_16x16x32_bf16 v[60:63], a[232:235], a[116:119], v[60:63]
  v_rcp_f32 v229, v229
  v_mfma_f32_16x16x32_bf16 v[68:71], a[232:235], a[120:123], v[68:71]
  s_add_u32 s3, s33, 3456
  ds_read_b64_tr_b16 a[216:217], v13 offset:7680
  v_mul_f32 v93, v93, v229
  v_mfma_f32_16x16x32_bf16 v[76:79], a[232:235], a[124:127], v[76:79]
  s_waitcnt lgkmcnt(5)
  v_rcp_f32 v230, v230
  v_mfma_f32_16x16x32_bf16 v[52:55], a[236:239], a[128:131], v[52:55]
  ds_read_b64_tr_b16 a[218:219], v13 offset:26112
  buffer_load_dword v223, v251, s[16:19], s3 offen
  v_mfma_f32_16x16x32_bf16 v[60:63], a[236:239], a[132:135], v[60:63]
  v_rcp_f32 v231, v231
  v_mfma_f32_16x16x32_bf16 v[68:71], a[236:239], a[136:139], v[68:71]
  ds_read_b64_tr_b16 a[220:221], v13 offset:8704
  v_mul_f32 v94, v94, v230
  v_mfma_f32_16x16x32_bf16 v[76:79], a[236:239], a[140:143], v[76:79]
  s_waitcnt lgkmcnt(5)
  v_mul_f32 v95, v95, v231
  v_mul_f32 v224, v100, v194
  v_mfma_f32_16x16x32_bf16 v[52:55], a[208:211], a[144:147], v[52:55]
  ds_read_b64_tr_b16 a[222:223], v13 offset:27136
  v_mul_f32 v225, v101, v194
  v_mfma_f32_16x16x32_bf16 v[60:63], a[208:211], a[148:151], v[60:63]
  v_mul_f32 v226, v102, v194
  v_mul_f32 v227, v103, v194
  v_mfma_f32_16x16x32_bf16 v[68:71], a[208:211], a[152:155], v[68:71]
  ds_read_b64_tr_b16 a[224:225], v10 offset:37376
  v_mfma_f32_16x16x32_bf16 v[76:79], a[208:211], a[156:159], v[76:79]
  s_waitcnt lgkmcnt(5)
  v_exp_f32 v224, v224
  v_mfma_f32_16x16x32_bf16 v[52:55], a[212:215], a[160:163], v[52:55]
  ds_read_b64_tr_b16 a[226:227], v10 offset:55808
  v_fma_f32 v224, v224, v198, v198
  v_mfma_f32_16x16x32_bf16 v[60:63], a[212:215], a[164:167], v[60:63]
  v_exp_f32 v225, v225
  v_mfma_f32_16x16x32_bf16 v[68:71], a[212:215], a[168:171], v[68:71]
  ds_read_b64_tr_b16 a[228:229], v10 offset:38400
  v_fma_f32 v225, v225, v198, v198
  v_mfma_f32_16x16x32_bf16 v[76:79], a[212:215], a[172:175], v[76:79]
  s_waitcnt lgkmcnt(5)
  v_exp_f32 v226, v226
  v_mfma_f32_16x16x32_bf16 v[52:55], a[216:219], a[176:179], v[52:55]
  s_waitcnt lgkmcnt(3)
  s_barrier
  ds_read_b64_tr_b16 a[230:231], v10 offset:56832
  v_fma_f32 v226, v226, v198, v198
  v_mfma_f32_16x16x32_bf16 v[60:63], a[216:219], a[180:183], v[60:63]
  v_exp_f32 v227, v227
  v_mfma_f32_16x16x32_bf16 v[68:71], a[216:219], a[184:187], v[68:71]
  ds_read_b64_tr_b16 a[232:233], v10 offset:39424
  v_fma_f32 v227, v227, v198, v198
  v_mfma_f32_16x16x32_bf16 v[76:79], a[216:219], a[188:191], v[76:79]
  v_rcp_f32 v224, v224
  v_mfma_f32_16x16x32_bf16 v[52:55], a[220:223], a[192:195], v[52:55]
  ds_read_b64_tr_b16 a[234:235], v10 offset:57856
  v_mul_f32 v100, v100, v224
  v_mfma_f32_16x16x32_bf16 v[60:63], a[220:223], a[196:199], v[60:63]
  v_rcp_f32 v225, v225
  v_mfma_f32_16x16x32_bf16 v[68:71], a[220:223], a[200:203], v[68:71]
  ds_read_b64_tr_b16 a[236:237], v10 offset:40448
  v_mul_f32 v101, v101, v225
  v_mfma_f32_16x16x32_bf16 v[76:79], a[220:223], a[204:207], v[76:79]
  s_waitcnt lgkmcnt(5)
  v_rcp_f32 v226, v226
  v_mfma_f32_16x16x32_bf16 v[112:115], a[224:227], v[144:147], 0
  ds_read_b64_tr_b16 a[238:239], v10 offset:58880
  v_mul_f32 v102, v102, v226
  v_mfma_f32_16x16x32_bf16 v[120:123], a[224:227], v[148:151], 0
  v_rcp_f32 v227, v227
  v_mfma_f32_16x16x32_bf16 v[128:131], a[224:227], v[152:155], 0
  s_add_u32 s3, s33, 4608
  ds_read_b64_tr_b16 a[208:209], v10 offset:41472
  v_mul_f32 v103, v103, v227
  v_mfma_f32_16x16x32_bf16 v[136:139], a[224:227], v[156:159], 0
  s_waitcnt lgkmcnt(5)
  v_mul_f32 v228, v108, v195
  v_mul_f32 v229, v109, v195
  v_mfma_f32_16x16x32_bf16 v[112:115], a[228:231], v[160:163], v[112:115]
  ds_read_b64_tr_b16 a[210:211], v10 offset:59904
  v_mul_f32 v230, v110, v195
  v_mfma_f32_16x16x32_bf16 v[120:123], a[228:231], v[164:167], v[120:123]
  buffer_load_dword v223, v251, s[16:19], s3 offen
  v_mul_f32 v231, v111, v195
  v_mfma_f32_16x16x32_bf16 v[128:131], a[228:231], v[168:171], v[128:131]
  ds_read_b64_tr_b16 a[212:213], v10 offset:42496
  v_mfma_f32_16x16x32_bf16 v[136:139], a[228:231], v[172:175], v[136:139]
  s_waitcnt lgkmcnt(5)
  v_exp_f32 v228, v228
  v_mfma_f32_16x16x32_bf16 v[112:115], a[232:235], v[176:179], v[112:115]
  ds_read_b64_tr_b16 a[214:215], v10 offset:60928
  v_fma_f32 v228, v228, v199, v199
  v_mfma_f32_16x16x32_bf16 v[120:123], a[232:235], v[180:183], v[120:123]
  v_exp_f32 v229, v229
  v_mfma_f32_16x16x32_bf16 v[128:131], a[232:235], v[184:187], v[128:131]
  ds_read_b64_tr_b16 a[216:217], v10 offset:43520
  v_fma_f32 v229, v229, v199, v199
  v_mfma_f32_16x16x32_bf16 v[136:139], a[232:235], v[188:191], v[136:139]
  s_waitcnt lgkmcnt(5)
  v_exp_f32 v230, v230
  v_exp_f32 v231, v231
  v_mfma_f32_16x16x32_bf16 v[112:115], a[236:239], v[204:207], v[112:115]
  ds_read_b64_tr_b16 a[218:219], v10 offset:61952
  v_fma_f32 v230, v230, v199, v199
  v_mfma_f32_16x16x32_bf16 v[120:123], a[236:239], v[208:211], v[120:123]
  v_fma_f32 v231, v231, v199, v199
  v_mul_f32 v84, v84, v116
  v_mfma_f32_16x16x32_bf16 v[128:131], a[236:239], v[212:215], v[128:131]
  ds_read_b64_tr_b16 a[220:221], v10 offset:44544
  v_mul_f32 v85, v85, v117
  v_mfma_f32_16x16x32_bf16 v[136:139], a[236:239], v[216:219], v[136:139]
  s_waitcnt lgkmcnt(5)
  v_rcp_f32 v228, v228
  v_mfma_f32_16x16x32_bf16 v[112:115], a[208:211], v[232:235], v[112:115]
  ds_read_b64_tr_b16 a[222:223], v10 offset:62976
  v_mul_f32 v108, v108, v228
  v_mfma_f32_16x16x32_bf16 v[120:123], a[208:211], v[236:239], v[120:123]
  v_rcp_f32 v229, v229
  v_mfma_f32_16x16x32_bf16 v[128:131], a[208:211], v[240:243], v[128:131]
  ds_read_b64_tr_b16 a[224:225], v10 offset:45568
  v_mul_f32 v109, v109, v229
  v_mfma_f32_16x16x32_bf16 v[136:139], a[208:211], v[244:247], v[136:139]
  s_waitcnt lgkmcnt(5)
  v_rcp_f32 v230, v230
  v_rcp_f32 v231, v231
  v_mfma_f32_16x16x32_bf16 v[112:115], a[212:215], a[0:3], v[112:115]
  ds_read_b64_tr_b16 a[226:227], v10 offset:64000
  v_mul_f32 v110, v110, v230
  v_mfma_f32_16x16x32_bf16 v[120:123], a[212:215], a[4:7], v[120:123]
  v_mul_f32 v111, v111, v231
  v_mul_f32 v86, v86, v118
  v_mfma_f32_16x16x32_bf16 v[128:131], a[212:215], a[8:11], v[128:131]
  ds_read_b64_tr_b16 a[228:229], v11 offset:37376
  v_mul_f32 v87, v87, v119
  v_mfma_f32_16x16x32_bf16 v[136:139], a[212:215], a[12:15], v[136:139]
  s_waitcnt lgkmcnt(5)
  v_cvt_pk_bf16_f32 v18, v84, v85
  v_cvt_pk_bf16_f32 v19, v86, v87
  v_mfma_f32_16x16x32_bf16 v[112:115], a[216:219], a[16:19], v[112:115]
  ds_read_b64_tr_b16 a[230:231], v11 offset:55808
  v_mul_f32 v92, v92, v124
  v_mfma_f32_16x16x32_bf16 v[120:123], a[216:219], a[20:23], v[120:123]
  v_mul_f32 v93, v93, v125
  v_mul_f32 v94, v94, v126
  v_mfma_f32_16x16x32_bf16 v[128:131], a[216:219], a[24:27], v[128:131]
  ds_read_b64_tr_b16 a[232:233], v11 offset:38400
  v_mul_f32 v95, v95, v127
  v_mfma_f32_16x16x32_bf16 v[136:139], a[216:219], a[28:31], v[136:139]
  s_waitcnt lgkmcnt(5)
  v_cvt_pk_bf16_f32 v22, v92, v93
  v_cvt_pk_bf16_f32 v23, v94, v95
  v_mfma_f32_16x16x32_bf16 v[112:115], a[220:223], a[32:35], v[112:115]
  ds_read_b64_tr_b16 a[234:235], v11 offset:56832
  v_mul_f32 v100, v100, v132
  v_mfma_f32_16x16x32_bf16 v[120:123], a[220:223], a[36:39], v[120:123]
  v_mul_f32 v101, v101, v133
  v_mul_f32 v102, v102, v134
  v_mfma_f32_16x16x32_bf16 v[128:131], a[220:223], a[40:43], v[128:131]
  ds_read_b64_tr_b16 a[236:237], v11 offset:39424
  v_mul_f32 v103, v103, v135
  v_mfma_f32_16x16x32_bf16 v[136:139], a[220:223], a[44:47], v[136:139]
  s_waitcnt lgkmcnt(5)
  v_cvt_pk_bf16_f32 v26, v100, v101
  v_cvt_pk_bf16_f32 v27, v102, v103
  v_mfma_f32_16x16x32_bf16 v[112:115], a[224:227], a[48:51], v[112:115]
  ds_read_b64_tr_b16 a[238:239], v11 offset:57856
  v_mul_f32 v108, v108, v140
  v_mfma_f32_16x16x32_bf16 v[120:123], a[224:227], a[52:55], v[120:123]
  v_mul_f32 v109, v109, v141
  v_mul_f32 v110, v110, v142
  v_mul_f32 v111, v111, v143
  v_cvt_pk_bf16_f32 v30, v108, v109
  v_cvt_pk_bf16_f32 v31, v110, v111
  v_mfma_f32_16x16x32_bf16 v[128:131], a[224:227], a[56:59], v[128:131]
  ds_read_b64_tr_b16 a[208:209], v11 offset:40448
  v_mul_f32 v224, v48, v192
  v_mfma_f32_16x16x32_bf16 v[136:139], a[224:227], a[60:63], v[136:139]
  s_waitcnt lgkmcnt(5)
  v_mul_f32 v225, v49, v192
  v_mul_f32 v226, v50, v192
  v_mfma_f32_16x16x32_bf16 v[116:119], a[228:231], v[144:147], 0
  ds_read_b64_tr_b16 a[210:211], v11 offset:58880
  v_mul_f32 v227, v51, v192
  v_mfma_f32_16x16x32_bf16 v[124:127], a[228:231], v[148:151], 0
  v_exp_f32 v224, v224
  v_mfma_f32_16x16x32_bf16 v[132:135], a[228:231], v[152:155], 0
  ds_read_b64_tr_b16 a[212:213], v11 offset:41472
  v_fma_f32 v224, v224, v196, v196
  v_mfma_f32_16x16x32_bf16 v[140:143], a[228:231], v[156:159], 0
  s_waitcnt lgkmcnt(5)
  v_exp_f32 v225, v225
  v_mfma_f32_16x16x32_bf16 v[116:119], a[232:235], v[160:163], v[116:119]
  ds_read_b64_tr_b16 a[214:215], v11 offset:59904
  v_fma_f32 v225, v225, v196, v196
  v_mfma_f32_16x16x32_bf16 v[124:127], a[232:235], v[164:167], v[124:127]
  v_exp_f32 v226, v226
  v_mfma_f32_16x16x32_bf16 v[132:135], a[232:235], v[168:171], v[132:135]
  ds_read_b64_tr_b16 a[216:217], v11 offset:42496
  v_fma_f32 v226, v226, v196, v196
  v_mfma_f32_16x16x32_bf16 v[140:143], a[232:235], v[172:175], v[140:143]
  s_waitcnt lgkmcnt(5)
  v_exp_f32 v227, v227
  v_mfma_f32_16x16x32_bf16 v[116:119], a[236:239], v[176:179], v[116:119]
  ds_read_b64_tr_b16 a[218:219], v11 offset:60928
  v_fma_f32 v227, v227, v196, v196
  v_mfma_f32_16x16x32_bf16 v[124:127], a[236:239], v[180:183], v[124:127]
  v_rcp_f32 v224, v224
  v_mfma_f32_16x16x32_bf16 v[132:135], a[236:239], v[184:187], v[132:135]
  ds_read_b64_tr_b16 a[220:221], v11 offset:43520
  v_mul_f32 v48, v48, v224
  v_mfma_f32_16x16x32_bf16 v[140:143], a[236:239], v[188:191], v[140:143]
  s_waitcnt lgkmcnt(5)
  v_rcp_f32 v225, v225
  v_mfma_f32_16x16x32_bf16 v[116:119], a[208:211], v[204:207], v[116:119]
  ds_read_b64_tr_b16 a[222:223], v11 offset:61952
  v_mul_f32 v49, v49, v225
  v_mfma_f32_16x16x32_bf16 v[124:127], a[208:211], v[208:211], v[124:127]
  v_rcp_f32 v226, v226
  v_mfma_f32_16x16x32_bf16 v[132:135], a[208:211], v[212:215], v[132:135]
  ds_read_b64_tr_b16 a[224:225], v11 offset:44544
  v_mul_f32 v50, v50, v226
  v_mfma_f32_16x16x32_bf16 v[140:143], a[208:211], v[216:219], v[140:143]
  s_waitcnt lgkmcnt(5)
  v_rcp_f32 v227, v227
  v_mfma_f32_16x16x32_bf16 v[116:119], a[212:215], v[232:235], v[116:119]
  ds_read_b64_tr_b16 a[226:227], v11 offset:62976
  v_mul_f32 v51, v51, v227
  v_mfma_f32_16x16x32_bf16 v[124:127], a[212:215], v[236:239], v[124:127]
  v_mul_f32 v228, v56, v193
  v_mul_f32 v229, v57, v193
  v_mfma_f32_16x16x32_bf16 v[132:135], a[212:215], v[240:243], v[132:135]
  s_add_u32 m0, s32, 0
  ds_read_b64_tr_b16 a[228:229], v11 offset:45568
  v_mul_f32 v230, v58, v193
  v_mfma_f32_16x16x32_bf16 v[140:143], a[212:215], v[244:247], v[140:143]
  s_waitcnt lgkmcnt(5)
  v_mul_f32 v231, v59, v193
  v_mfma_f32_16x16x32_bf16 v[116:119], a[216:219], a[0:3], v[116:119]
  s_add_u32 s41, s46, 128
  ds_read_b64_tr_b16 a[230:231], v11 offset:64000
  v_mfma_f32_16x16x32_bf16 v[124:127], a[216:219], a[4:7], v[124:127]
  v_exp_f32 v228, v228
  v_mfma_f32_16x16x32_bf16 v[132:135], a[216:219], a[8:11], v[132:135]
  ds_read_b64_tr_b16 a[232:233], v12 offset:37376
  buffer_load_dwordx4 v200, s[8:11], s41 offen lds
  v_mfma_f32_16x16x32_bf16 v[140:143], a[216:219], a[12:15], v[140:143]
  s_waitcnt lgkmcnt(5)
  v_exp_f32 v229, v229
  v_mfma_f32_16x16x32_bf16 v[116:119], a[220:223], a[16:19], v[116:119]
  ds_read_b64_tr_b16 a[234:235], v12 offset:55808
  v_fma_f32 v228, v228, v197, v197
  v_mfma_f32_16x16x32_bf16 v[124:127], a[220:223], a[20:23], v[124:127]
  v_exp_f32 v230, v230
  v_mfma_f32_16x16x32_bf16 v[132:135], a[220:223], a[24:27], v[132:135]
  ds_read_b64_tr_b16 a[236:237], v12 offset:38400
  v_fma_f32 v229, v229, v197, v197
  v_mfma_f32_16x16x32_bf16 v[140:143], a[220:223], a[28:31], v[140:143]
  s_waitcnt lgkmcnt(5)
  v_exp_f32 v231, v231
  v_mfma_f32_16x16x32_bf16 v[116:119], a[224:227], a[32:35], v[116:119]
  s_waitcnt lgkmcnt(3)
  s_barrier
  ds_read_b64_tr_b16 a[238:239], v12 offset:56832
  v_fma_f32 v230, v230, v197, v197
  v_mfma_f32_16x16x32_bf16 v[124:127], a[224:227], a[36:39], v[124:127]
  buffer_load_dwordx4 v201, s[8:11], s41 offen offset:1024 lds
  v_fma_f32 v231, v231, v197, v197
  v_mfma_f32_16x16x32_bf16 v[132:135], a[224:227], a[40:43], v[132:135]
  ds_read_b64_tr_b16 a[208:209], v12 offset:39424
  v_mfma_f32_16x16x32_bf16 v[140:143], a[224:227], a[44:47], v[140:143]
  v_rcp_f32 v228, v228
  v_mfma_f32_16x16x32_bf16 v[116:119], a[228:231], a[48:51], v[116:119]
  ds_read_b64_tr_b16 a[210:211], v12 offset:57856
  v_mul_f32 v56, v56, v228
  v_mfma_f32_16x16x32_bf16 v[124:127], a[228:231], a[52:55], v[124:127]
  v_rcp_f32 v229, v229
  v_mfma_f32_16x16x32_bf16 v[132:135], a[228:231], a[56:59], v[132:135]
  ds_read_b64_tr_b16 a[212:213], v12 offset:40448
  buffer_load_dwordx4 v202, s[8:11], s41 offen offset:2048 lds
  v_mfma_f32_16x16x32_bf16 v[140:143], a[228:231], a[60:63], v[140:143]
  s_waitcnt lgkmcnt(5)
  v_rcp_f32 v230, v230
  v_mfma_f32_16x16x32_bf16 v[112:115], a[232:235], a[64:67], v[112:115]
  ds_read_b64_tr_b16 a[214:215], v12 offset:58880
  v_mul_f32 v57, v57, v229
  v_mfma_f32_16x16x32_bf16 v[120:123], a[232:235], a[68:71], v[120:123]
  v_rcp_f32 v231, v231
  v_mfma_f32_16x16x32_bf16 v[128:131], a[232:235], a[72:75], v[128:131]
  ds_read_b64_tr_b16 a[216:217], v12 offset:41472
  v_mul_f32 v58, v58, v230
  v_mfma_f32_16x16x32_bf16 v[136:139], a[232:235], a[76:79], v[136:139]
  s_waitcnt lgkmcnt(5)
  v_mul_f32 v59, v59, v231
  v_mul_f32 v224, v64, v194
  v_mfma_f32_16x16x32_bf16 v[112:115], a[236:239], a[80:83], v[112:115]
  ds_read_b64_tr_b16 a[218:219], v12 offset:59904
  v_mul_f32 v225, v65, v194
  v_mfma_f32_16x16x32_bf16 v[120:123], a[236:239], a[84:87], v[120:123]
  buffer_load_dwordx4 v203, s[8:11], s41 offen offset:3072 lds
  v_mul_f32 v226, v66, v194
  v_mfma_f32_16x16x32_bf16 v[128:131], a[236:239], a[88:91], v[128:131]
  s_add_u32 m0, s32, 4096
  ds_read_b64_tr_b16 a[220:221], v12 offset:42496
  v_mul_f32 v227, v67, v194
  v_mfma_f32_16x16x32_bf16 v[136:139], a[236:239], a[92:95], v[136:139]
  s_waitcnt lgkmcnt(5)
  v_exp_f32 v224, v224
  v_mfma_f32_16x16x32_bf16 v[112:115], a[208:211], a[96:99], v[112:115]
  s_add_u32 s41, s46, 1179776
  ds_read_b64_tr_b16 a[222:223], v12 offset:60928
  v_fma_f32 v224, v224, v198, v198
  v_mfma_f32_16x16x32_bf16 v[120:123], a[208:211], a[100:103], v[120:123]
  v_exp_f32 v225, v225
  v_mfma_f32_16x16x32_bf16 v[128:131], a[208:211], a[104:107], v[128:131]
  ds_read_b64_tr_b16 a[224:225], v12 offset:43520
  buffer_load_dwordx4 v200, s[8:11], s41 offen lds
  v_mfma_f32_16x16x32_bf16 v[136:139], a[208:211], a[108:111], v[136:139]
  s_waitcnt lgkmcnt(5)
  v_exp_f32 v226, v226
  v_mfma_f32_16x16x32_bf16 v[112:115], a[212:215], a[112:115], v[112:115]
  ds_read_b64_tr_b16 a[226:227], v12 offset:61952
  v_fma_f32 v225, v225, v198, v198
  v_mfma_f32_16x16x32_bf16 v[120:123], a[212:215], a[116:119], v[120:123]
  v_exp_f32 v227, v227
  v_mfma_f32_16x16x32_bf16 v[128:131], a[212:215], a[120:123], v[128:131]
  ds_read_b64_tr_b16 a[228:229], v12 offset:44544
  v_fma_f32 v226, v226, v198, v198
  v_mfma_f32_16x16x32_bf16 v[136:139], a[212:215], a[124:127], v[136:139]
  s_waitcnt lgkmcnt(5)
  v_fma_f32 v227, v227, v198, v198
  v_mfma_f32_16x16x32_bf16 v[112:115], a[216:219], a[128:131], v[112:115]
  ds_read_b64_tr_b16 a[230:231], v12 offset:62976
  buffer_load_dwordx4 v201, s[8:11], s41 offen offset:1024 lds
  v_mfma_f32_16x16x32_bf16 v[120:123], a[216:219], a[132:135], v[120:123]
  v_rcp_f32 v224, v224
  v_mfma_f32_16x16x32_bf16 v[128:131], a[216:219], a[136:139], v[128:131]
  ds_read_b64_tr_b16 a[232:233], v12 offset:45568
  v_mul_f32 v64, v64, v224
  v_mfma_f32_16x16x32_bf16 v[136:139], a[216:219], a[140:143], v[136:139]
  s_waitcnt lgkmcnt(5)
  v_rcp_f32 v225, v225
  v_mfma_f32_16x16x32_bf16 v[112:115], a[220:223], a[144:147], v[112:115]
  ds_read_b64_tr_b16 a[234:235], v12 offset:64000
  v_mul_f32 v65, v65, v225
  v_mfma_f32_16x16x32_bf16 v[120:123], a[220:223], a[148:151], v[120:123]
  v_rcp_f32 v226, v226
  v_mfma_f32_16x16x32_bf16 v[128:131], a[220:223], a[152:155], v[128:131]
  ds_read_b64_tr_b16 a[236:237], v13 offset:37376
  buffer_load_dwordx4 v202, s[8:11], s41 offen offset:2048 lds
  v_mfma_f32_16x16x32_bf16 v[136:139], a[220:223], a[156:159], v[136:139]
  s_waitcnt lgkmcnt(5)
  v_rcp_f32 v227, v227
  v_mfma_f32_16x16x32_bf16 v[112:115], a[224:227], a[160:163], v[112:115]
  ds_read_b64_tr_b16 a[238:239], v13 offset:55808
  v_mul_f32 v66, v66, v226
  v_mfma_f32_16x16x32_bf16 v[120:123], a[224:227], a[164:167], v[120:123]
  v_mul_f32 v67, v67, v227
  v_mul_f32 v228, v72, v195
  v_mfma_f32_16x16x32_bf16 v[128:131], a[224:227], a[168:171], v[128:131]
  ds_read_b64_tr_b16 a[208:209], v13 offset:38400
  v_mul_f32 v229, v73, v195
  v_mfma_f32_16x16x32_bf16 v[136:139], a[224:227], a[172:175], v[136:139]
  s_waitcnt lgkmcnt(5)
  v_mul_f32 v230, v74, v195
  v_mul_f32 v231, v75, v195
  v_mfma_f32_16x16x32_bf16 v[112:115], a[228:231], a[176:179], v[112:115]
  ds_read_b64_tr_b16 a[210:211], v13 offset:56832
  buffer_load_dwordx4 v203, s[8:11], s41 offen offset:3072 lds
  v_mfma_f32_16x16x32_bf16 v[120:123], a[228:231], a[180:183], v[120:123]
  v_exp_f32 v228, v228
  v_mfma_f32_16x16x32_bf16 v[128:131], a[228:231], a[184:187], v[128:131]
  s_add_u32 m0, s32, 8192
  ds_read_b64_tr_b16 a[212:213], v13 offset:39424
  v_fma_f32 v228, v228, v199, v199
  v_mfma_f32_16x16x32_bf16 v[136:139], a[228:231], a[188:191], v[136:139]
  s_waitcnt lgkmcnt(5)
  v_exp_f32 v229, v229
  v_mfma_f32_16x16x32_bf16 v[112:115], a[232:235], a[192:195], v[112:115]
  s_add_u32 s41, s46, 2359424
  ds_read_b64_tr_b16 a[214:215], v13 offset:57856
  v_fma_f32 v229, v229, v199, v199
  v_mfma_f32_16x16x32_bf16 v[120:123], a[232:235], a[196:199], v[120:123]
  v_exp_f32 v230, v230
  v_mfma_f32_16x16x32_bf16 v[128:131], a[232:235], a[200:203], v[128:131]
  ds_read_b64_tr_b16 a[216:217], v13 offset:40448
  buffer_load_dwordx4 v200, s[8:11], s41 offen lds
  v_mfma_f32_16x16x32_bf16 v[136:139], a[232:235], a[204:207], v[136:139]
  s_waitcnt lgkmcnt(5)
  v_exp_f32 v231, v231
  v_mfma_f32_16x16x32_bf16 v[116:119], a[236:239], a[64:67], v[116:119]
  s_add_u32 m0, s32, 73728
  ds_read_b64_tr_b16 a[218:219], v13 offset:58880
  v_fma_f32 v230, v230, v199, v199
  v_mfma_f32_16x16x32_bf16 v[124:127], a[236:239], a[68:71], v[124:127]
  v_fma_f32 v231, v231, v199, v199
  v_mfma_f32_16x16x32_bf16 v[132:135], a[236:239], a[72:75], v[132:135]
  s_add_u32 s41, s46, 2654336
  ds_read_b64_tr_b16 a[220:221], v13 offset:41472
  v_mfma_f32_16x16x32_bf16 v[140:143], a[236:239], a[76:79], v[140:143]
  s_waitcnt lgkmcnt(5)
  v_rcp_f32 v228, v228
  v_mfma_f32_16x16x32_bf16 v[116:119], a[208:211], a[80:83], v[116:119]
  ds_read_b64_tr_b16 a[222:223], v13 offset:59904
  buffer_load_dwordx4 v200, s[8:11], s41 offen lds
  v_mfma_f32_16x16x32_bf16 v[124:127], a[208:211], a[84:87], v[124:127]
  v_rcp_f32 v229, v229
  v_mfma_f32_16x16x32_bf16 v[132:135], a[208:211], a[88:91], v[132:135]
  ds_read_b64_tr_b16 a[224:225], v13 offset:42496
  v_mul_f32 v72, v72, v228
  v_mfma_f32_16x16x32_bf16 v[140:143], a[208:211], a[92:95], v[140:143]
  s_waitcnt lgkmcnt(5)
  v_rcp_f32 v230, v230
  v_mfma_f32_16x16x32_bf16 v[116:119], a[212:215], a[96:99], v[116:119]
  ds_read_b64_tr_b16 a[226:227], v13 offset:60928
  v_mul_f32 v73, v73, v229
  v_mfma_f32_16x16x32_bf16 v[124:127], a[212:215], a[100:103], v[124:127]
  v_rcp_f32 v231, v231
  v_mfma_f32_16x16x32_bf16 v[132:135], a[212:215], a[104:107], v[132:135]
  ds_read_b64_tr_b16 a[228:229], v13 offset:43520
  v_mul_f32 v74, v74, v230
  v_mfma_f32_16x16x32_bf16 v[140:143], a[212:215], a[108:111], v[140:143]
  s_waitcnt lgkmcnt(5)
  buffer_load_dwordx4 v201, s[8:11], s41 offen offset:1024 lds
  v_mul_f32 v75, v75, v231
  v_mfma_f32_16x16x32_bf16 v[116:119], a[216:219], a[112:115], v[116:119]
  ds_read_b64_tr_b16 a[230:231], v13 offset:61952
  v_mul_f32 v48, v48, v112
  v_mfma_f32_16x16x32_bf16 v[124:127], a[216:219], a[116:119], v[124:127]
  v_mul_f32 v49, v49, v113
  v_mul_f32 v50, v50, v114
  v_mfma_f32_16x16x32_bf16 v[132:135], a[216:219], a[120:123], v[132:135]
  ds_read_b64_tr_b16 a[232:233], v13 offset:44544
  v_mul_f32 v51, v51, v115
  v_mfma_f32_16x16x32_bf16 v[140:143], a[216:219], a[124:127], v[140:143]
  s_waitcnt lgkmcnt(5)
  v_cvt_pk_bf16_f32 v32, v48, v49
  v_cvt_pk_bf16_f32 v33, v50, v51
  v_mfma_f32_16x16x32_bf16 v[116:119], a[220:223], a[128:131], v[116:119]
  ds_read_b64_tr_b16 a[234:235], v13 offset:62976
  v_mul_f32 v56, v56, v120
  v_mfma_f32_16x16x32_bf16 v[124:127], a[220:223], a[132:135], v[124:127]
  buffer_load_dwordx4 v202, s[8:11], s41 offen offset:2048 lds
  v_mul_f32 v57, v57, v121
  v_mfma_f32_16x16x32_bf16 v[132:135], a[220:223], a[136:139], v[132:135]
  ds_read_b64_tr_b16 a[236:237], v13 offset:45568
  v_mul_f32 v58, v58, v122
  v_mfma_f32_16x16x32_bf16 v[140:143], a[220:223], a[140:143], v[140:143]
  s_waitcnt lgkmcnt(5)
  v_mul_f32 v59, v59, v123
  v_cvt_pk_bf16_f32 v36, v56, v57
  v_mfma_f32_16x16x32_bf16 v[116:119], a[224:227], a[144:147], v[116:119]
  ds_read_b64_tr_b16 a[238:239], v13 offset:64000
  v_cvt_pk_bf16_f32 v37, v58, v59
  v_mfma_f32_16x16x32_bf16 v[124:127], a[224:227], a[148:151], v[124:127]
  v_mul_f32 v64, v64, v128
  v_mul_f32 v65, v65, v129
  v_mfma_f32_16x16x32_bf16 v[132:135], a[224:227], a[152:155], v[132:135]
  buffer_load_dwordx4 v203, s[8:11], s41 offen offset:3072 lds
  v_mul_f32 v66, v66, v130
  v_mfma_f32_16x16x32_bf16 v[140:143], a[224:227], a[156:159], v[140:143]
  s_waitcnt lgkmcnt(4)
  v_mul_f32 v67, v67, v131
  v_cvt_pk_bf16_f32 v40, v64, v65
  v_mfma_f32_16x16x32_bf16 v[116:119], a[228:231], a[160:163], v[116:119]
  s_add_u32 m0, s32, 77824
  v_cvt_pk_bf16_f32 v41, v66, v67
  v_mul_f32 v72, v72, v136
  v_mfma_f32_16x16x32_bf16 v[124:127], a[228:231], a[164:167], v[124:127]
  v_mul_f32 v73, v73, v137
  v_mul_f32 v74, v74, v138
  v_mfma_f32_16x16x32_bf16 v[132:135], a[228:231], a[168:171], v[132:135]
  s_add_u32 s41, s46, 3833984
  v_mul_f32 v75, v75, v139
  v_cvt_pk_bf16_f32 v44, v72, v73
  v_mfma_f32_16x16x32_bf16 v[140:143], a[228:231], a[172:175], v[140:143]
  s_waitcnt lgkmcnt(2)
  v_cvt_pk_bf16_f32 v45, v74, v75
  v_mul_f32 v224, v52, v192
  v_mfma_f32_16x16x32_bf16 v[116:119], a[232:235], a[176:179], v[116:119]
  s_waitcnt vmcnt(4) lgkmcnt(0)
  s_barrier
  ds_read_b64_tr_b16 a[208:209], v10 offset:0
  ds_read_b64_tr_b16 a[210:211], v10 offset:18432
  v_mfma_f32_16x16x32_bf16 v[124:127], a[232:235], a[180:183], v[124:127]
  buffer_load_dwordx4 v200, s[8:11], s41 offen lds
  v_mul_f32 v225, v53, v192
  v_mfma_f32_16x16x32_bf16 v[132:135], a[232:235], a[184:187], v[132:135]
  ds_read_b64_tr_b16 a[212:213], v10 offset:1024
  v_mul_f32 v226, v54, v192
  v_mfma_f32_16x16x32_bf16 v[140:143], a[232:235], a[188:191], v[140:143]
  ds_read_b64_tr_b16 a[216:217], v10 offset:2048
  v_mul_f32 v227, v55, v192
  v_mfma_f32_16x16x32_bf16 v[116:119], a[236:239], a[192:195], v[116:119]
  ds_read_b64_tr_b16 a[214:215], v10 offset:19456
  ds_read_b64_tr_b16 a[218:219], v10 offset:20480
  v_mfma_f32_16x16x32_bf16 v[124:127], a[236:239], a[196:199], v[124:127]
  v_exp_f32 v224, v224
  v_mfma_f32_16x16x32_bf16 v[132:135], a[236:239], a[200:203], v[132:135]
  ds_read_b64_tr_b16 a[220:221], v10 offset:3072
  buffer_load_dwordx4 v201, s[8:11], s41 offen offset:1024 lds
  v_mfma_f32_16x16x32_bf16 v[140:143], a[236:239], a[204:207], v[140:143]
  s_waitcnt lgkmcnt(5)
  v_exp_f32 v225, v225
  v_mfma_f32_16x16x32_bf16 v[80:83], a[208:211], v[144:147], 0
  ds_read_b64_tr_b16 a[222:223], v10 offset:21504
  v_fma_f32 v224, v224, v196, v196
  v_mfma_f32_16x16x32_bf16 v[88:91], a[208:211], v[148:151], 0
  v_exp_f32 v226, v226
  v_mfma_f32_16x16x32_bf16 v[96:99], a[208:211], v[152:155], 0
  ds_read_b64_tr_b16 a[224:225], v10 offset:4096
  v_fma_f32 v225, v225, v196, v196
  v_mfma_f32_16x16x32_bf16 v[104:107], a[208:211], v[156:159], 0
  s_waitcnt lgkmcnt(4)
  v_exp_f32 v227, v227
  v_mfma_f32_16x16x32_bf16 v[80:83], a[212:215], v[160:163], v[80:83]
  ds_read_b64_tr_b16 a[226:227], v10 offset:22528
  v_fma_f32 v226, v226, v196, v196
  v_mfma_f32_16x16x32_bf16 v[88:91], a[212:215], v[164:167], v[88:91]
  buffer_load_dwordx4 v202, s[8:11], s41 offen offset:2048 lds
  v_fma_f32 v227, v227, v196, v196
  v_mfma_f32_16x16x32_bf16 v[96:99], a[212:215], v[168:171], v[96:99]
  ds_read_b64_tr_b16 a[228:229], v10 offset:5120
  v_mfma_f32_16x16x32_bf16 v[104:107], a[212:215], v[172:175], v[104:107]
  s_waitcnt lgkmcnt(5)
  v_rcp_f32 v224, v224
  v_mfma_f32_16x16x32_bf16 v[80:83], a[216:219], v[176:179], v[80:83]
  ds_read_b64_tr_b16 a[230:231], v10 offset:23552
  v_mfma_f32_16x16x32_bf16 v[88:91], a[216:219], v[180:183], v[88:91]
  v_rcp_f32 v225, v225
  v_mfma_f32_16x16x32_bf16 v[96:99], a[216:219], v[184:187], v[96:99]
  ds_read_b64_tr_b16 a[232:233], v10 offset:6144
  buffer_load_dwordx4 v203, s[8:11], s41 offen offset:3072 lds
  v_mfma_f32_16x16x32_bf16 v[104:107], a[216:219], v[188:191], v[104:107]
  s_waitcnt lgkmcnt(5)
  v_rcp_f32 v226, v226
  v_mfma_f32_16x16x32_bf16 v[80:83], a[220:223], v[204:207], v[80:83]
  s_add_u32 m0, s32, 81920
  ds_read_b64_tr_b16 a[234:235], v10 offset:24576
  v_mul_f32 v52, v52, v224
  v_mfma_f32_16x16x32_bf16 v[88:91], a[220:223], v[208:211], v[88:91]
  v_rcp_f32 v227, v227
  v_mfma_f32_16x16x32_bf16 v[96:99], a[220:223], v[212:215], v[96:99]
  s_add_u32 s41, s46, 5013632
  ds_read_b64_tr_b16 a[236:237], v10 offset:7168
  v_mul_f32 v53, v53, v225
  v_mfma_f32_16x16x32_bf16 v[104:107], a[220:223], v[216:219], v[104:107]
  s_waitcnt lgkmcnt(5)
  v_mul_f32 v54, v54, v226
  v_mul_f32 v55, v55, v227
  v_mfma_f32_16x16x32_bf16 v[80:83], a[224:227], v[232:235], v[80:83]
  ds_read_b64_tr_b16 a[238:239], v10 offset:25600
  v_mul_f32 v228, v60, v193
  v_mfma_f32_16x16x32_bf16 v[88:91], a[224:227], v[236:239], v[88:91]
  buffer_load_dwordx4 v200, s[8:11], s41 offen lds
  v_mul_f32 v229, v61, v193
  v_mfma_f32_16x16x32_bf16 v[96:99], a[224:227], v[240:243], v[96:99]
  s_add_u32 m0, s32, 36864
  ds_read_b64_tr_b16 a[208:209], v10 offset:8192
  v_mul_f32 v230, v62, v193
  v_mfma_f32_16x16x32_bf16 v[104:107], a[224:227], v[244:247], v[104:107]
  s_waitcnt lgkmcnt(5)
  v_mul_f32 v231, v63, v193
  v_mfma_f32_16x16x32_bf16 v[80:83], a[228:231], a[0:3], v[80:83]
  s_add_u32 s41, s46, 128
  ds_read_b64_tr_b16 a[210:211], v10 offset:26624
  v_mfma_f32_16x16x32_bf16 v[88:91], a[228:231], a[4:7], v[88:91]
  v_exp_f32 v228, v228
  v_mfma_f32_16x16x32_bf16 v[96:99], a[228:231], a[8:11], v[96:99]
  ds_read_b64_tr_b16 a[212:213], v11 offset:0
  buffer_load_dwordx4 v200, s[12:15], s41 offen lds
  v_mfma_f32_16x16x32_bf16 v[104:107], a[228:231], a[12:15], v[104:107]
  s_waitcnt lgkmcnt(5)
  v_exp_f32 v229, v229
  v_mfma_f32_16x16x32_bf16 v[80:83], a[232:235], a[16:19], v[80:83]
  ds_read_b64_tr_b16 a[214:215], v11 offset:18432
  buffer_load_dword v220, v221, s[20:23], s43 offen offset:1152 sc1
  v_mfma_f32_16x16x32_bf16 v[88:91], a[232:235], a[20:23], v[88:91]
  v_exp_f32 v230, v230
  v_mfma_f32_16x16x32_bf16 v[96:99], a[232:235], a[24:27], v[96:99]
  ds_read_b64_tr_b16 a[216:217], v11 offset:1024
  v_fma_f32 v228, v228, v197, v197
  v_mfma_f32_16x16x32_bf16 v[104:107], a[232:235], a[28:31], v[104:107]
  s_waitcnt lgkmcnt(5)
  v_exp_f32 v231, v231
  v_mfma_f32_16x16x32_bf16 v[80:83], a[236:239], a[32:35], v[80:83]
  ds_read_b64_tr_b16 a[218:219], v11 offset:19456
  buffer_load_dwordx4 v201, s[12:15], s41 offen offset:1024 lds
  v_mfma_f32_16x16x32_bf16 v[88:91], a[236:239], a[36:39], v[88:91]
  buffer_load_dword v8, v9, s[20:23], s99 offen sc1
  v_fma_f32 v229, v229, v197, v197
  v_mfma_f32_16x16x32_bf16 v[96:99], a[236:239], a[40:43], v[96:99]
  ds_read_b64_tr_b16 a[220:221], v11 offset:2048
  v_fma_f32 v230, v230, v197, v197
  v_mfma_f32_16x16x32_bf16 v[104:107], a[236:239], a[44:47], v[104:107]
  s_waitcnt lgkmcnt(5)
  v_fma_f32 v231, v231, v197, v197
  v_mfma_f32_16x16x32_bf16 v[80:83], a[208:211], a[48:51], v[80:83]
  ds_read_b64_tr_b16 a[222:223], v11 offset:20480
  v_mfma_f32_16x16x32_bf16 v[88:91], a[208:211], a[52:55], v[88:91]
  v_rcp_f32 v228, v228
  v_mfma_f32_16x16x32_bf16 v[96:99], a[208:211], a[56:59], v[96:99]
  ds_read_b64_tr_b16 a[224:225], v11 offset:3072
  buffer_load_dwordx4 v202, s[12:15], s41 offen offset:2048 lds
  v_mfma_f32_16x16x32_bf16 v[104:107], a[208:211], a[60:63], v[104:107]
  s_waitcnt lgkmcnt(5)
  buffer_load_dword v223, v15, s[4:7], 0 offen
  v_mul_f32 v60, v60, v228
  v_mfma_f32_16x16x32_bf16 v[84:87], a[212:215], v[144:147], 0
  ds_read_b64_tr_b16 a[226:227], v11 offset:21504
  v_mul_f32 v224, v68, v194
  v_mfma_f32_16x16x32_bf16 v[92:95], a[212:215], v[148:151], 0
  v_rcp_f32 v229, v229
  v_mfma_f32_16x16x32_bf16 v[100:103], a[212:215], v[152:155], 0
  ds_read_b64_tr_b16 a[228:229], v11 offset:4096
  v_mul_f32 v61, v61, v229
  v_mfma_f32_16x16x32_bf16 v[108:111], a[212:215], v[156:159], 0
  s_waitcnt lgkmcnt(5)
  v_rcp_f32 v230, v230
  v_mfma_f32_16x16x32_bf16 v[84:87], a[216:219], v[160:163], v[84:87]
  ds_read_b64_tr_b16 a[230:231], v11 offset:22528
  buffer_load_dwordx4 v203, s[12:15], s41 offen offset:3072 lds
  v_mfma_f32_16x16x32_bf16 v[92:95], a[216:219], v[164:167], v[92:95]
  v_rcp_f32 v231, v231
  v_mfma_f32_16x16x32_bf16 v[100:103], a[216:219], v[168:171], v[100:103]
  s_add_u32 m0, s32, 40960
  ds_read_b64_tr_b16 a[232:233], v11 offset:5120
  v_mul_f32 v62, v62, v230
  v_mfma_f32_16x16x32_bf16 v[108:111], a[216:219], v[172:175], v[108:111]
  s_waitcnt lgkmcnt(5)
  v_mul_f32 v63, v63, v231
  v_mul_f32 v225, v69, v194
  v_mfma_f32_16x16x32_bf16 v[84:87], a[220:223], v[176:179], v[84:87]
  s_add_u32 s41, s46, 1179776
  ds_read_b64_tr_b16 a[234:235], v11 offset:23552
  v_mul_f32 v226, v70, v194
  v_mfma_f32_16x16x32_bf16 v[92:95], a[220:223], v[180:183], v[92:95]
  v_mul_f32 v227, v71, v194
  v_mfma_f32_16x16x32_bf16 v[100:103], a[220:223], v[184:187], v[100:103]
  ds_read_b64_tr_b16 a[236:237], v11 offset:6144
  buffer_load_dwordx4 v200, s[12:15], s41 offen lds
  v_mfma_f32_16x16x32_bf16 v[108:111], a[220:223], v[188:191], v[108:111]
  s_waitcnt lgkmcnt(5)
  v_exp_f32 v224, v224
  v_mfma_f32_16x16x32_bf16 v[84:87], a[224:227], v[204:207], v[84:87]
  ds_read_b64_tr_b16 a[238:239], v11 offset:24576
  v_fma_f32 v224, v224, v198, v198
  v_mfma_f32_16x16x32_bf16 v[92:95], a[224:227], v[208:211], v[92:95]
  v_exp_f32 v225, v225
  v_mfma_f32_16x16x32_bf16 v[100:103], a[224:227], v[212:215], v[100:103]
  ds_read_b64_tr_b16 a[208:209], v11 offset:7168
  v_fma_f32 v225, v225, v198, v198
  v_mfma_f32_16x16x32_bf16 v[108:111], a[224:227], v[216:219], v[108:111]
  s_waitcnt lgkmcnt(5)
  v_exp_f32 v226, v226
  v_mfma_f32_16x16x32_bf16 v[84:87], a[228:231], v[232:235], v[84:87]
  ds_read_b64_tr_b16 a[210:211], v11 offset:25600
  buffer_load_dwordx4 v201, s[12:15], s41 offen offset:1024 lds
  v_mfma_f32_16x16x32_bf16 v[92:95], a[228:231], v[236:239], v[92:95]
  v_exp_f32 v227, v227
  v_mfma_f32_16x16x32_bf16 v[100:103], a[228:231], v[240:243], v[100:103]
  ds_read_b64_tr_b16 a[212:213], v11 offset:8192
  v_fma_f32 v226, v226, v198, v198
  v_mfma_f32_16x16x32_bf16 v[108:111], a[228:231], v[244:247], v[108:111]
  s_waitcnt lgkmcnt(5)
  v_fma_f32 v227, v227, v198, v198
  v_mfma_f32_16x16x32_bf16 v[84:87], a[232:235], a[0:3], v[84:87]
  ds_read_b64_tr_b16 a[214:215], v11 offset:26624
  v_mul_f32 v228, v76, v195
  v_mfma_f32_16x16x32_bf16 v[92:95], a[232:235], a[4:7], v[92:95]
  v_rcp_f32 v224, v224
  v_mfma_f32_16x16x32_bf16 v[100:103], a[232:235], a[8:11], v[100:103]
  buffer_load_dwordx4 v202, s[12:15], s41 offen offset:2048 lds
  v_mul_f32 v68, v68, v224
  v_mfma_f32_16x16x32_bf16 v[108:111], a[232:235], a[12:15], v[108:111]
  s_waitcnt lgkmcnt(4)
  v_rcp_f32 v225, v225
  v_mfma_f32_16x16x32_bf16 v[84:87], a[236:239], a[16:19], v[84:87]
  v_rcp_f32 v227, v227
  v_mfma_f32_16x16x32_bf16 v[92:95], a[236:239], a[20:23], v[92:95]
  v_rcp_f32 v226, v226
  v_mfma_f32_16x16x32_bf16 v[100:103], a[236:239], a[24:27], v[100:103]
  v_mul_f32 v69, v69, v225
  v_mul_f32 v70, v70, v226
  v_mfma_f32_16x16x32_bf16 v[108:111], a[236:239], a[28:31], v[108:111]
  s_waitcnt lgkmcnt(2)
  v_mul_f32 v71, v71, v227
  v_mul_f32 v229, v77, v195
  v_mfma_f32_16x16x32_bf16 v[84:87], a[208:211], a[32:35], v[84:87]
  s_waitcnt vmcnt(10)
  s_barrier
  ds_read_b64_tr_b16 a[216:217], v12 offset:0
  ds_read_b64_tr_b16 a[218:219], v12 offset:18432
  v_mfma_f32_16x16x32_bf16 v[92:95], a[208:211], a[36:39], v[92:95]
  buffer_load_dwordx4 v203, s[12:15], s41 offen offset:3072 lds
  v_mul_f32 v230, v78, v195
  v_mfma_f32_16x16x32_bf16 v[100:103], a[208:211], a[40:43], v[100:103]
  s_add_u32 m0, s32, 45056
  ds_read_b64_tr_b16 a[220:221], v12 offset:1024
  v_mul_f32 v231, v79, v195
  v_mfma_f32_16x16x32_bf16 v[108:111], a[208:211], a[44:47], v[108:111]
  s_waitcnt lgkmcnt(3)
  ds_read_b64_tr_b16 a[224:225], v12 offset:2048
  v_mfma_f32_16x16x32_bf16 v[84:87], a[212:215], a[48:51], v[84:87]
  s_add_u32 s41, s46, 2359424
  ds_read_b64_tr_b16 a[222:223], v12 offset:19456
  ds_read_b64_tr_b16 a[226:227], v12 offset:20480
  v_mfma_f32_16x16x32_bf16 v[92:95], a[212:215], a[52:55], v[92:95]
  v_exp_f32 v228, v228
  v_mfma_f32_16x16x32_bf16 v[100:103], a[212:215], a[56:59], v[100:103]
  ds_read_b64_tr_b16 a[228:229], v12 offset:3072
  buffer_load_dwordx4 v200, s[12:15], s41 offen lds
  v_mfma_f32_16x16x32_bf16 v[108:111], a[212:215], a[60:63], v[108:111]
  s_waitcnt lgkmcnt(5)
  v_exp_f32 v229, v229
  v_mfma_f32_16x16x32_bf16 v[80:83], a[216:219], a[64:67], v[80:83]
  s_add_u32 m0, s32, 110592
  ds_read_b64_tr_b16 a[230:231], v12 offset:21504
  v_fma_f32 v228, v228, v199, v199
  v_mfma_f32_16x16x32_bf16 v[88:91], a[216:219], a[68:71], v[88:91]
  v_exp_f32 v230, v230
  v_mfma_f32_16x16x32_bf16 v[96:99], a[216:219], a[72:75], v[96:99]
  s_add_u32 s41, s46, 2654336
  ds_read_b64_tr_b16 a[232:233], v12 offset:4096
  v_fma_f32 v229, v229, v199, v199
  v_mfma_f32_16x16x32_bf16 v[104:107], a[216:219], a[76:79], v[104:107]
  s_waitcnt lgkmcnt(4)
  v_exp_f32 v231, v231
  v_mfma_f32_16x16x32_bf16 v[80:83], a[220:223], a[80:83], v[80:83]
  ds_read_b64_tr_b16 a[234:235], v12 offset:22528
  v_fma_f32 v230, v230, v199, v199
  v_mfma_f32_16x16x32_bf16 v[88:91], a[220:223], a[84:87], v[88:91]
  buffer_load_dwordx4 v200, s[12:15], s41 offen lds
  v_fma_f32 v231, v231, v199, v199
  v_mfma_f32_16x16x32_bf16 v[96:99], a[220:223], a[88:91], v[96:99]
  ds_read_b64_tr_b16 a[236:237], v12 offset:5120
  v_mfma_f32_16x16x32_bf16 v[104:107], a[220:223], a[92:95], v[104:107]
  s_waitcnt lgkmcnt(5)
  v_rcp_f32 v228, v228
  v_mfma_f32_16x16x32_bf16 v[80:83], a[224:227], a[96:99], v[80:83]
  ds_read_b64_tr_b16 a[238:239], v12 offset:23552
  v_mul_f32 v76, v76, v228
  v_mfma_f32_16x16x32_bf16 v[88:91], a[224:227], a[100:103], v[88:91]
  v_rcp_f32 v229, v229
  v_mfma_f32_16x16x32_bf16 v[96:99], a[224:227], a[104:107], v[96:99]
  ds_read_b64_tr_b16 a[208:209], v12 offset:6144
  buffer_load_dwordx4 v201, s[12:15], s41 offen offset:1024 lds
  v_mfma_f32_16x16x32_bf16 v[104:107], a[224:227], a[108:111], v[104:107]
  s_waitcnt lgkmcnt(5)
  v_rcp_f32 v230, v230
  v_mfma_f32_16x16x32_bf16 v[80:83], a[228:231], a[112:115], v[80:83]
  ds_read_b64_tr_b16 a[210:211], v12 offset:24576
  v_mul_f32 v77, v77, v229
  v_mfma_f32_16x16x32_bf16 v[88:91], a[228:231], a[116:119], v[88:91]
  v_rcp_f32 v231, v231
  v_mfma_f32_16x16x32_bf16 v[96:99], a[228:231], a[120:123], v[96:99]
  ds_read_b64_tr_b16 a[212:213], v12 offset:7168
  v_mul_f32 v78, v78, v230
  v_mfma_f32_16x16x32_bf16 v[104:107], a[228:231], a[124:127], v[104:107]
  s_waitcnt lgkmcnt(5)
  v_mul_f32 v79, v79, v231
  v_mul_f32 v52, v52, v116
  v_mfma_f32_16x16x32_bf16 v[80:83], a[232:235], a[128:131], v[80:83]
  ds_read_b64_tr_b16 a[214:215], v12 offset:25600
  v_mul_f32 v53, v53, v117
  v_mfma_f32_16x16x32_bf16 v[88:91], a[232:235], a[132:135], v[88:91]
  buffer_load_dwordx4 v202, s[12:15], s41 offen offset:2048 lds
  v_mul_f32 v54, v54, v118
  v_mfma_f32_16x16x32_bf16 v[96:99], a[232:235], a[136:139], v[96:99]
  ds_read_b64_tr_b16 a[216:217], v12 offset:8192
  v_mul_f32 v55, v55, v119
  v_mfma_f32_16x16x32_bf16 v[104:107], a[232:235], a[140:143], v[104:107]
  s_waitcnt lgkmcnt(5)
  v_cvt_pk_bf16_f32 v34, v52, v53
  v_cvt_pk_bf16_f32 v35, v54, v55
  v_mfma_f32_16x16x32_bf16 v[80:83], a[236:239], a[144:147], v[80:83]
  ds_read_b64_tr_b16 a[218:219], v12 offset:26624
  v_mul_f32 v60, v60, v124
  v_mfma_f32_16x16x32_bf16 v[88:91], a[236:239], a[148:151], v[88:91]
  v_mul_f32 v61, v61, v125
  v_mul_f32 v62, v62, v126
  v_mfma_f32_16x16x32_bf16 v[96:99], a[236:239], a[152:155], v[96:99]
  ds_read_b64_tr_b16 a[220:221], v13 offset:0
  v_mul_f32 v63, v63, v127
  v_mfma_f32_16x16x32_bf16 v[104:107], a[236:239], a[156:159], v[104:107]
  s_waitcnt lgkmcnt(5)
  buffer_load_dwordx4 v203, s[12:15], s41 offen offset:3072 lds
  v_cvt_pk_bf16_f32 v38, v60, v61
  v_mfma_f32_16x16x32_bf16 v[80:83], a[208:211], a[160:163], v[80:83]
  s_add_u32 m0, s32, 114688
  ds_read_b64_tr_b16 a[222:223], v13 offset:18432
  v_cvt_pk_bf16_f32 v39, v62, v63
  v_mfma_f32_16x16x32_bf16 v[88:91], a[208:211], a[164:167], v[88:91]
  v_mul_f32 v68, v68, v132
  v_mul_f32 v69, v69, v133
  v_mfma_f32_16x16x32_bf16 v[96:99], a[208:211], a[168:171], v[96:99]
  s_add_u32 s41, s46, 3833984
  ds_read_b64_tr_b16 a[224:225], v13 offset:1024
  v_mul_f32 v70, v70, v134
  v_mfma_f32_16x16x32_bf16 v[104:107], a[208:211], a[172:175], v[104:107]
  s_waitcnt lgkmcnt(5)
  v_mul_f32 v71, v71, v135
  v_cvt_pk_bf16_f32 v42, v68, v69
  v_mfma_f32_16x16x32_bf16 v[80:83], a[212:215], a[176:179], v[80:83]
  ds_read_b64_tr_b16 a[226:227], v13 offset:19456
  v_cvt_pk_bf16_f32 v43, v70, v71
  v_mfma_f32_16x16x32_bf16 v[88:91], a[212:215], a[180:183], v[88:91]
  buffer_load_dwordx4 v200, s[12:15], s41 offen lds
  v_mul_f32 v76, v76, v140
  v_mfma_f32_16x16x32_bf16 v[96:99], a[212:215], a[184:187], v[96:99]
  ds_read_b64_tr_b16 a[228:229], v13 offset:2048
  v_mul_f32 v77, v77, v141
  v_mfma_f32_16x16x32_bf16 v[104:107], a[212:215], a[188:191], v[104:107]
  s_waitcnt lgkmcnt(5)
  v_mul_f32 v78, v78, v142
  v_mul_f32 v79, v79, v143
  v_mfma_f32_16x16x32_bf16 v[80:83], a[216:219], a[192:195], v[80:83]
  s_waitcnt vmcnt(13)
  v_min_u32 v220, v220, v8
  v_cmp_gt_u32 vcc, 1, v220
  s_nop 0
  s_cmp_eq_u32 vcc_lo, 0
  s_cbranch_scc0 sequential_preLN__spectral_fnet__swiglu_ffn__prompt_kernel_spin0
sequential_preLN__spectral_fnet__swiglu_ffn__prompt_kernel_go0:
  v_mfma_f32_16x16x32_bf16 v[88:91], a[216:219], a[196:199], v[88:91]
  ds_read_b64_tr_b16 a[230:231], v13 offset:20480
  v_cvt_pk_bf16_f32 v46, v76, v77
  v_cvt_pk_bf16_f32 v47, v78, v79
  v_mfma_f32_16x16x32_bf16 v[96:99], a[216:219], a[200:203], v[96:99]
  ds_read_b64_tr_b16 a[232:233], v13 offset:3072
  v_mfma_f32_16x16x32_bf16 v[104:107], a[216:219], a[204:207], v[104:107]
  s_waitcnt lgkmcnt(5)
  buffer_load_dwordx4 v201, s[12:15], s41 offen offset:1024 lds
  v_mfma_f32_16x16x32_bf16 v[84:87], a[220:223], a[64:67], v[84:87]
  ds_read_b64_tr_b16 a[234:235], v13 offset:21504
  v_mfma_f32_16x16x32_bf16 v[92:95], a[220:223], a[68:71], v[92:95]
  v_mfma_f32_16x16x32_bf16 v[100:103], a[220:223], a[72:75], v[100:103]
  ds_read_b64_tr_b16 a[236:237], v13 offset:4096
  v_mfma_f32_16x16x32_bf16 v[108:111], a[220:223], a[76:79], v[108:111]
  s_waitcnt lgkmcnt(5)
  v_mfma_f32_16x16x32_bf16 v[84:87], a[224:227], a[80:83], v[84:87]
  ds_read_b64_tr_b16 a[238:239], v13 offset:22528
  v_mul_f32 v224, v80, v192
  v_mfma_f32_16x16x32_bf16 v[92:95], a[224:227], a[84:87], v[92:95]
  buffer_load_dwordx4 v202, s[12:15], s41 offen offset:2048 lds
  v_mul_f32 v225, v81, v192
  v_mfma_f32_16x16x32_bf16 v[100:103], a[224:227], a[88:91], v[100:103]
  ds_read_b64_tr_b16 a[208:209], v13 offset:5120
  v_mul_f32 v226, v82, v192
  v_mfma_f32_16x16x32_bf16 v[108:111], a[224:227], a[92:95], v[108:111]
  s_waitcnt lgkmcnt(5)
  v_mul_f32 v227, v83, v192
  v_mfma_f32_16x16x32_bf16 v[84:87], a[228:231], a[96:99], v[84:87]
  ds_read_b64_tr_b16 a[210:211], v13 offset:23552
  v_mfma_f32_16x16x32_bf16 v[92:95], a[228:231], a[100:103], v[92:95]
  v_exp_f32 v224, v224
  v_mfma_f32_16x16x32_bf16 v[100:103], a[228:231], a[104:107], v[100:103]
  ds_read_b64_tr_b16 a[212:213], v13 offset:6144
  buffer_load_dwordx4 v203, s[12:15], s41 offen offset:3072 lds
  v_mfma_f32_16x16x32_bf16 v[108:111], a[228:231], a[108:111], v[108:111]
  s_waitcnt lgkmcnt(5)
  v_exp_f32 v225, v225
  v_mfma_f32_16x16x32_bf16 v[84:87], a[232:235], a[112:115], v[84:87]
  s_add_u32 m0, s32, 118784
  ds_read_b64_tr_b16 a[214:215], v13 offset:24576
  v_fma_f32 v224, v224, v196, v196
  v_mfma_f32_16x16x32_bf16 v[92:95], a[232:235], a[116:119], v[92:95]
  v_exp_f32 v226, v226
  v_mfma_f32_16x16x32_bf16 v[100:103], a[232:235], a[120:123], v[100:103]
  s_add_u32 s41, s46, 5013632
  ds_read_b64_tr_b16 a[216:217], v13 offset:7168
  v_fma_f32 v225, v225, v196, v196
  v_mfma_f32_16x16x32_bf16 v[108:111], a[232:235], a[124:127], v[108:111]
  s_waitcnt lgkmcnt(5)
  v_exp_f32 v227, v227
  v_mfma_f32_16x16x32_bf16 v[84:87], a[236:239], a[128:131], v[84:87]
  ds_read_b64_tr_b16 a[218:219], v13 offset:25600
  buffer_load_dwordx4 v200, s[12:15], s41 offen lds
  v_mfma_f32_16x16x32_bf16 v[92:95], a[236:239], a[132:135], v[92:95]
  buffer_store_dwordx4 v[16:19], v14, s[24:27], s38 offen sc1
  v_fma_f32 v226, v226, v196, v196
  v_mfma_f32_16x16x32_bf16 v[100:103], a[236:239], a[136:139], v[100:103]
  ds_read_b64_tr_b16 a[220:221], v13 offset:8192
  v_fma_f32 v227, v227, v196, v196
  v_mfma_f32_16x16x32_bf16 v[108:111], a[236:239], a[140:143], v[108:111]
  s_waitcnt lgkmcnt(5)
  v_rcp_f32 v224, v224
  v_mfma_f32_16x16x32_bf16 v[84:87], a[208:211], a[144:147], v[84:87]
  ds_read_b64_tr_b16 a[222:223], v13 offset:26624
  v_mul_f32 v80, v80, v224
  v_mfma_f32_16x16x32_bf16 v[92:95], a[208:211], a[148:151], v[92:95]
  v_rcp_f32 v225, v225
  v_mfma_f32_16x16x32_bf16 v[100:103], a[208:211], a[152:155], v[100:103]
  v_rcp_f32 v227, v227
  v_mfma_f32_16x16x32_bf16 v[108:111], a[208:211], a[156:159], v[108:111]
  s_waitcnt lgkmcnt(4)
  v_rcp_f32 v226, v226
  v_mfma_f32_16x16x32_bf16 v[84:87], a[212:215], a[160:163], v[84:87]
  v_mul_f32 v81, v81, v225
  v_mul_f32 v82, v82, v226
  v_mfma_f32_16x16x32_bf16 v[92:95], a[212:215], a[164:167], v[92:95]
  v_mul_f32 v83, v83, v227
  v_mul_f32 v228, v88, v193
  v_mfma_f32_16x16x32_bf16 v[100:103], a[212:215], a[168:171], v[100:103]
  v_mul_f32 v229, v89, v193
  v_mul_f32 v230, v90, v193
  v_mfma_f32_16x16x32_bf16 v[108:111], a[212:215], a[172:175], v[108:111]
  s_waitcnt lgkmcnt(2)
  v_mul_f32 v231, v91, v193
  v_mfma_f32_16x16x32_bf16 v[84:87], a[216:219], a[176:179], v[84:87]
  s_waitcnt vmcnt(10)
  s_barrier
  ds_read_b64_tr_b16 a[224:225], v10 offset:36864
  ds_read_b64_tr_b16 a[226:227], v10 offset:55296
  v_mfma_f32_16x16x32_bf16 v[92:95], a[216:219], a[180:183], v[92:95]
  v_exp_f32 v228, v228
  v_mfma_f32_16x16x32_bf16 v[100:103], a[216:219], a[184:187], v[100:103]
  ds_read_b64_tr_b16 a[228:229], v10 offset:37888
  ds_read_b64_tr_b16 a[232:233], v10 offset:38912
  v_mfma_f32_16x16x32_bf16 v[108:111], a[216:219], a[188:191], v[108:111]
  s_waitcnt lgkmcnt(4)
  v_exp_f32 v229, v229
  v_mfma_f32_16x16x32_bf16 v[84:87], a[220:223], a[192:195], v[84:87]
  ds_read_b64_tr_b16 a[230:231], v10 offset:56320
  ds_read_b64_tr_b16 a[234:235], v10 offset:57344
  v_mfma_f32_16x16x32_bf16 v[92:95], a[220:223], a[196:199], v[92:95]
  v_exp_f32 v230, v230
  v_mfma_f32_16x16x32_bf16 v[100:103], a[220:223], a[200:203], v[100:103]
  ds_read_b64_tr_b16 a[236:237], v10 offset:39936
  v_fma_f32 v228, v228, v197, v197
  v_mfma_f32_16x16x32_bf16 v[108:111], a[220:223], a[204:207], v[108:111]
  s_waitcnt lgkmcnt(5)
  v_exp_f32 v231, v231
  v_mfma_f32_16x16x32_bf16 v[112:115], a[224:227], v[144:147], 0
  ds_read_b64_tr_b16 a[238:239], v10 offset:58368
  v_fma_f32 v229, v229, v197, v197
  v_mfma_f32_16x16x32_bf16 v[120:123], a[224:227], v[148:151], 0
  v_fma_f32 v230, v230, v197, v197
  v_fma_f32 v231, v231, v197, v197
  v_mfma_f32_16x16x32_bf16 v[128:131], a[224:227], v[152:155], 0
  ds_read_b64_tr_b16 a[208:209], v10 offset:40960
  v_mul_f32 v224, v96, v194
  v_mfma_f32_16x16x32_bf16 v[136:139], a[224:227], v[156:159], 0
  s_waitcnt lgkmcnt(4)
  v_rcp_f32 v228, v228
  v_mfma_f32_16x16x32_bf16 v[112:115], a[228:231], v[160:163], v[112:115]
  ds_read_b64_tr_b16 a[210:211], v10 offset:59392
  v_mul_f32 v88, v88, v228
  v_mfma_f32_16x16x32_bf16 v[120:123], a[228:231], v[164:167], v[120:123]
  v_rcp_f32 v229, v229
  v_mfma_f32_16x16x32_bf16 v[128:131], a[228:231], v[168:171], v[128:131]
  ds_read_b64_tr_b16 a[212:213], v10 offset:41984
  v_mul_f32 v89, v89, v229
  v_mfma_f32_16x16x32_bf16 v[136:139], a[228:231], v[172:175], v[136:139]
  s_waitcnt lgkmcnt(5)
  v_rcp_f32 v230, v230
  v_mfma_f32_16x16x32_bf16 v[112:115], a[232:235], v[176:179], v[112:115]
  ds_read_b64_tr_b16 a[214:215], v10 offset:60416
  buffer_store_dwordx4 v[20:23], v14, s[24:27], s38 offen offset:1024 sc1
  v_mfma_f32_16x16x32_bf16 v[120:123], a[232:235], v[180:183], v[120:123]
  v_rcp_f32 v231, v231
  v_mfma_f32_16x16x32_bf16 v[128:131], a[232:235], v[184:187], v[128:131]
  ds_read_b64_tr_b16 a[216:217], v10 offset:43008
  v_mul_f32 v90, v90, v230
  v_mfma_f32_16x16x32_bf16 v[136:139], a[232:235], v[188:191], v[136:139]
  s_waitcnt lgkmcnt(5)
  v_mul_f32 v91, v91, v231
  v_mul_f32 v225, v97, v194
  v_mfma_f32_16x16x32_bf16 v[112:115], a[236:239], v[204:207], v[112:115]
  ds_read_b64_tr_b16 a[218:219], v10 offset:61440
  v_mul_f32 v226, v98, v194
  v_mfma_f32_16x16x32_bf16 v[120:123], a[236:239], v[208:211], v[120:123]
  v_mul_f32 v227, v99, v194
  v_mfma_f32_16x16x32_bf16 v[128:131], a[236:239], v[212:215], v[128:131]
  ds_read_b64_tr_b16 a[220:221], v10 offset:44032
  v_mfma_f32_16x16x32_bf16 v[136:139], a[236:239], v[216:219], v[136:139]
  s_waitcnt lgkmcnt(5)
  v_exp_f32 v224, v224
  v_mfma_f32_16x16x32_bf16 v[112:115], a[208:211], v[232:235], v[112:115]
  ds_read_b64_tr_b16 a[222:223], v10 offset:62464
  v_fma_f32 v224, v224, v198, v198
  v_mfma_f32_16x16x32_bf16 v[120:123], a[208:211], v[236:239], v[120:123]
  v_exp_f32 v225, v225
  v_mfma_f32_16x16x32_bf16 v[128:131], a[208:211], v[240:243], v[128:131]
  ds_read_b64_tr_b16 a[224:225], v10 offset:45056
  v_fma_f32 v225, v225, v198, v198
  v_mfma_f32_16x16x32_bf16 v[136:139], a[208:211], v[244:247], v[136:139]
  s_waitcnt lgkmcnt(5)
  v_exp_f32 v226, v226
  v_mfma_f32_16x16x32_bf16 v[112:115], a[212:215], a[0:3], v[112:115]
  ds_read_b64_tr_b16 a[226:227], v10 offset:63488
  v_fma_f32 v226, v226, v198, v198
  v_mfma_f32_16x16x32_bf16 v[120:123], a[212:215], a[4:7], v[120:123]
  v_exp_f32 v227, v227
  v_mfma_f32_16x16x32_bf16 v[128:131], a[212:215], a[8:11], v[128:131]
  ds_read_b64_tr_b16 a[228:229], v11 offset:36864
  v_fma_f32 v227, v227, v198, v198
  v_mfma_f32_16x16x32_bf16 v[136:139], a[212:215], a[12:15], v[136:139]
  s_waitcnt lgkmcnt(5)
  v_rcp_f32 v224, v224
  v_mfma_f32_16x16x32_bf16 v[112:115], a[216:219], a[16:19], v[112:115]
  ds_read_b64_tr_b16 a[230:231], v11 offset:55296
  v_mul_f32 v96, v96, v224
  v_mfma_f32_16x16x32_bf16 v[120:123], a[216:219], a[20:23], v[120:123]
  v_rcp_f32 v225, v225
  v_mfma_f32_16x16x32_bf16 v[128:131], a[216:219], a[24:27], v[128:131]
  ds_read_b64_tr_b16 a[232:233], v11 offset:37888
  v_mul_f32 v97, v97, v225
  v_mfma_f32_16x16x32_bf16 v[136:139], a[216:219], a[28:31], v[136:139]
  s_waitcnt lgkmcnt(5)
  v_rcp_f32 v226, v226
  v_mfma_f32_16x16x32_bf16 v[112:115], a[220:223], a[32:35], v[112:115]
  ds_read_b64_tr_b16 a[234:235], v11 offset:56320
  v_mul_f32 v98, v98, v226
  v_mfma_f32_16x16x32_bf16 v[120:123], a[220:223], a[36:39], v[120:123]
  v_rcp_f32 v227, v227
  v_mfma_f32_16x16x32_bf16 v[128:131], a[220:223], a[40:43], v[128:131]
  ds_read_b64_tr_b16 a[236:237], v11 offset:38912
  v_mul_f32 v99, v99, v227
  v_mfma_f32_16x16x32_bf16 v[136:139], a[220:223], a[44:47], v[136:139]
  s_waitcnt lgkmcnt(5)
  v_mul_f32 v228, v104, v195
  v_mul_f32 v229, v105, v195
  v_mfma_f32_16x16x32_bf16 v[112:115], a[224:227], a[48:51], v[112:115]
  ds_read_b64_tr_b16 a[238:239], v11 offset:57344
  v_mul_f32 v230, v106, v195
  v_mfma_f32_16x16x32_bf16 v[120:123], a[224:227], a[52:55], v[120:123]
  v_mul_f32 v231, v107, v195
  v_mfma_f32_16x16x32_bf16 v[128:131], a[224:227], a[56:59], v[128:131]
  ds_read_b64_tr_b16 a[208:209], v11 offset:39936
  v_mfma_f32_16x16x32_bf16 v[136:139], a[224:227], a[60:63], v[136:139]
  s_waitcnt lgkmcnt(5)
  v_exp_f32 v228, v228
  v_mfma_f32_16x16x32_bf16 v[116:119], a[228:231], v[144:147], 0
  ds_read_b64_tr_b16 a[210:211], v11 offset:58368
  buffer_store_dwordx4 v[24:27], v14, s[24:27], s38 offen offset:2048 sc1
  v_mfma_f32_16x16x32_bf16 v[124:127], a[228:231], v[148:151], 0
  v_exp_f32 v229, v229
  v_mfma_f32_16x16x32_bf16 v[132:135], a[228:231], v[152:155], 0
  ds_read_b64_tr_b16 a[212:213], v11 offset:40960
  v_fma_f32 v228, v228, v199, v199
  v_mfma_f32_16x16x32_bf16 v[140:143], a[228:231], v[156:159], 0
  s_waitcnt lgkmcnt(5)
  v_exp_f32 v230, v230
  v_mfma_f32_16x16x32_bf16 v[116:119], a[232:235], v[160:163], v[116:119]
  ds_read_b64_tr_b16 a[214:215], v11 offset:59392
  v_fma_f32 v229, v229, v199, v199
  v_mfma_f32_16x16x32_bf16 v[124:127], a[232:235], v[164:167], v[124:127]
  v_exp_f32 v231, v231
  v_mfma_f32_16x16x32_bf16 v[132:135], a[232:235], v[168:171], v[132:135]
  ds_read_b64_tr_b16 a[216:217], v11 offset:41984
  v_fma_f32 v230, v230, v199, v199
  v_mfma_f32_16x16x32_bf16 v[140:143], a[232:235], v[172:175], v[140:143]
  s_waitcnt lgkmcnt(5)
  v_fma_f32 v231, v231, v199, v199
  v_mul_f32 v224, v84, v192
  v_mfma_f32_16x16x32_bf16 v[116:119], a[236:239], v[176:179], v[116:119]
  ds_read_b64_tr_b16 a[218:219], v11 offset:60416
  v_mul_f32 v225, v85, v192
  v_mfma_f32_16x16x32_bf16 v[124:127], a[236:239], v[180:183], v[124:127]
  v_rcp_f32 v228, v228
  v_mfma_f32_16x16x32_bf16 v[132:135], a[236:239], v[184:187], v[132:135]
  ds_read_b64_tr_b16 a[220:221], v11 offset:43008
  v_mul_f32 v104, v104, v228
  v_mfma_f32_16x16x32_bf16 v[140:143], a[236:239], v[188:191], v[140:143]
  s_waitcnt lgkmcnt(5)
  v_rcp_f32 v229, v229
  v_rcp_f32 v230, v230
  v_mfma_f32_16x16x32_bf16 v[116:119], a[208:211], v[204:207], v[116:119]
  ds_read_b64_tr_b16 a[222:223], v11 offset:61440
  v_mul_f32 v105, v105, v229
  v_mfma_f32_16x16x32_bf16 v[124:127], a[208:211], v[208:211], v[124:127]
  v_rcp_f32 v231, v231
  v_mfma_f32_16x16x32_bf16 v[132:135], a[208:211], v[212:215], v[132:135]
  ds_read_b64_tr_b16 a[224:225], v11 offset:44032
  v_mul_f32 v106, v106, v230
  v_mfma_f32_16x16x32_bf16 v[140:143], a[208:211], v[216:219], v[140:143]
  s_waitcnt lgkmcnt(5)
  v_mul_f32 v107, v107, v231
  v_mul_f32 v226, v86, v192
  v_mfma_f32_16x16x32_bf16 v[116:119], a[212:215], v[232:235], v[116:119]
  ds_read_b64_tr_b16 a[226:227], v11 offset:62464
  v_mul_f32 v227, v87, v192
  v_mfma_f32_16x16x32_bf16 v[124:127], a[212:215], v[236:239], v[124:127]
  v_exp_f32 v224, v224
  v_mfma_f32_16x16x32_bf16 v[132:135], a[212:215], v[240:243], v[132:135]
  ds_read_b64_tr_b16 a[228:229], v11 offset:45056
  v_fma_f32 v224, v224, v196, v196
  v_mfma_f32_16x16x32_bf16 v[140:143], a[212:215], v[244:247], v[140:143]
  s_waitcnt lgkmcnt(5)
  v_exp_f32 v225, v225
  v_mfma_f32_16x16x32_bf16 v[116:119], a[216:219], a[0:3], v[116:119]
  ds_read_b64_tr_b16 a[230:231], v11 offset:63488
  v_fma_f32 v225, v225, v196, v196
  v_mfma_f32_16x16x32_bf16 v[124:127], a[216:219], a[4:7], v[124:127]
  v_exp_f32 v226, v226
  v_mfma_f32_16x16x32_bf16 v[132:135], a[216:219], a[8:11], v[132:135]
  v_fma_f32 v226, v226, v196, v196
  v_mfma_f32_16x16x32_bf16 v[140:143], a[216:219], a[12:15], v[140:143]
  s_waitcnt lgkmcnt(4)
  v_exp_f32 v227, v227
  v_mfma_f32_16x16x32_bf16 v[116:119], a[220:223], a[16:19], v[116:119]
  v_fma_f32 v227, v227, v196, v196
  v_mul_f32 v228, v92, v193
  v_mfma_f32_16x16x32_bf16 v[124:127], a[220:223], a[20:23], v[124:127]
  v_rcp_f32 v224, v224
  v_mfma_f32_16x16x32_bf16 v[132:135], a[220:223], a[24:27], v[132:135]
  v_rcp_f32 v226, v226
  v_mfma_f32_16x16x32_bf16 v[140:143], a[220:223], a[28:31], v[140:143]
  s_waitcnt lgkmcnt(2)
  v_rcp_f32 v225, v225
  v_mfma_f32_16x16x32_bf16 v[116:119], a[224:227], a[32:35], v[116:119]
  s_waitcnt vmcnt(3)
  s_barrier
  ds_read_b64_tr_b16 a[232:233], v12 offset:36864
  ds_read_b64_tr_b16 a[234:235], v12 offset:55296
  v_mfma_f32_16x16x32_bf16 v[124:127], a[224:227], a[36:39], v[124:127]
  buffer_store_dwordx4 v[28:31], v14, s[24:27], s38 offen offset:3072 sc1
  v_mul_f32 v84, v84, v224
  v_mfma_f32_16x16x32_bf16 v[132:135], a[224:227], a[40:43], v[132:135]
  ds_read_b64_tr_b16 a[236:237], v12 offset:37888
  ds_read_b64_tr_b16 a[208:209], v12 offset:38912
  v_mfma_f32_16x16x32_bf16 v[140:143], a[224:227], a[44:47], v[140:143]
  s_waitcnt lgkmcnt(4)
  v_rcp_f32 v227, v227
  v_mul_f32 v85, v85, v225
  v_mfma_f32_16x16x32_bf16 v[116:119], a[228:231], a[48:51], v[116:119]
  ds_read_b64_tr_b16 a[238:239], v12 offset:56320
  v_mul_f32 v86, v86, v226
  v_mfma_f32_16x16x32_bf16 v[124:127], a[228:231], a[52:55], v[124:127]
  ds_read_b64_tr_b16 a[210:211], v12 offset:57344
  v_mul_f32 v87, v87, v227
  v_mfma_f32_16x16x32_bf16 v[132:135], a[228:231], a[56:59], v[132:135]
  ds_read_b64_tr_b16 a[212:213], v12 offset:39936
  v_mul_f32 v229, v93, v193
  v_mfma_f32_16x16x32_bf16 v[140:143], a[228:231], a[60:63], v[140:143]
  s_waitcnt lgkmcnt(5)
  v_mul_f32 v230, v94, v193
  v_mul_f32 v231, v95, v193
  v_mfma_f32_16x16x32_bf16 v[112:115], a[232:235], a[64:67], v[112:115]
  ds_read_b64_tr_b16 a[214:215], v12 offset:58368
  v_mfma_f32_16x16x32_bf16 v[120:123], a[232:235], a[68:71], v[120:123]
  v_exp_f32 v228, v228
  v_mfma_f32_16x16x32_bf16 v[128:131], a[232:235], a[72:75], v[128:131]
  ds_read_b64_tr_b16 a[216:217], v12 offset:40960
  v_fma_f32 v228, v228, v197, v197
  v_mfma_f32_16x16x32_bf16 v[136:139], a[232:235], a[76:79], v[136:139]
  s_waitcnt lgkmcnt(4)
  v_exp_f32 v229, v229
  v_mfma_f32_16x16x32_bf16 v[112:115], a[236:239], a[80:83], v[112:115]
  ds_read_b64_tr_b16 a[218:219], v12 offset:59392
  v_fma_f32 v229, v229, v197, v197
  v_mfma_f32_16x16x32_bf16 v[120:123], a[236:239], a[84:87], v[120:123]
  v_exp_f32 v230, v230
  v_mfma_f32_16x16x32_bf16 v[128:131], a[236:239], a[88:91], v[128:131]
  ds_read_b64_tr_b16 a[220:221], v12 offset:41984
  v_fma_f32 v230, v230, v197, v197
  v_mfma_f32_16x16x32_bf16 v[136:139], a[236:239], a[92:95], v[136:139]
  s_waitcnt lgkmcnt(5)
  v_exp_f32 v231, v231
  v_mfma_f32_16x16x32_bf16 v[112:115], a[208:211], a[96:99], v[112:115]
  ds_read_b64_tr_b16 a[222:223], v12 offset:60416
  v_fma_f32 v231, v231, v197, v197
  v_mfma_f32_16x16x32_bf16 v[120:123], a[208:211], a[100:103], v[120:123]
  v_rcp_f32 v228, v228
  v_mfma_f32_16x16x32_bf16 v[128:131], a[208:211], a[104:107], v[128:131]
  ds_read_b64_tr_b16 a[224:225], v12 offset:43008
  v_mul_f32 v92, v92, v228
  v_mfma_f32_16x16x32_bf16 v[136:139], a[208:211], a[108:111], v[136:139]
  s_waitcnt lgkmcnt(5)
  v_rcp_f32 v229, v229
  v_mfma_f32_16x16x32_bf16 v[112:115], a[212:215], a[112:115], v[112:115]
  ds_read_b64_tr_b16 a[226:227], v12 offset:61440
  v_mul_f32 v93, v93, v229
  v_mfma_f32_16x16x32_bf16 v[120:123], a[212:215], a[116:119], v[120:123]
  v_rcp_f32 v230, v230
  v_mfma_f32_16x16x32_bf16 v[128:131], a[212:215], a[120:123], v[128:131]
  ds_read_b64_tr_b16 a[228:229], v12 offset:44032
  v_mul_f32 v94, v94, v230
  v_mfma_f32_16x16x32_bf16 v[136:139], a[212:215], a[124:127], v[136:139]
  s_waitcnt lgkmcnt(5)
  v_rcp_f32 v231, v231
  v_mfma_f32_16x16x32_bf16 v[112:115], a[216:219], a[128:131], v[112:115]
  ds_read_b64_tr_b16 a[230:231], v12 offset:62464
  v_mul_f32 v95, v95, v231
  v_mfma_f32_16x16x32_bf16 v[120:123], a[216:219], a[132:135], v[120:123]
  v_mul_f32 v224, v100, v194
  v_mul_f32 v225, v101, v194
  v_mfma_f32_16x16x32_bf16 v[128:131], a[216:219], a[136:139], v[128:131]
  s_add_u32 s38, s38, 4096
  ds_read_b64_tr_b16 a[232:233], v12 offset:45056
  v_mul_f32 v226, v102, v194
  v_mfma_f32_16x16x32_bf16 v[136:139], a[216:219], a[140:143], v[136:139]
  s_waitcnt lgkmcnt(5)
  v_mul_f32 v227, v103, v194
  v_mfma_f32_16x16x32_bf16 v[112:115], a[220:223], a[144:147], v[112:115]
  ds_read_b64_tr_b16 a[234:235], v12 offset:63488
  buffer_store_dwordx4 v[32:35], v14, s[24:27], s38 offen sc1
  v_mfma_f32_16x16x32_bf16 v[120:123], a[220:223], a[148:151], v[120:123]
  v_exp_f32 v224, v224
  v_mfma_f32_16x16x32_bf16 v[128:131], a[220:223], a[152:155], v[128:131]
  ds_read_b64_tr_b16 a[236:237], v13 offset:36864
  v_fma_f32 v224, v224, v198, v198
  v_mfma_f32_16x16x32_bf16 v[136:139], a[220:223], a[156:159], v[136:139]
  s_waitcnt lgkmcnt(5)
  v_exp_f32 v225, v225
  v_mfma_f32_16x16x32_bf16 v[112:115], a[224:227], a[160:163], v[112:115]
  ds_read_b64_tr_b16 a[238:239], v13 offset:55296
  v_fma_f32 v225, v225, v198, v198
  v_mfma_f32_16x16x32_bf16 v[120:123], a[224:227], a[164:167], v[120:123]
  v_exp_f32 v226, v226
  v_mfma_f32_16x16x32_bf16 v[128:131], a[224:227], a[168:171], v[128:131]
  ds_read_b64_tr_b16 a[208:209], v13 offset:37888
  v_fma_f32 v226, v226, v198, v198
  v_mfma_f32_16x16x32_bf16 v[136:139], a[224:227], a[172:175], v[136:139]
  s_waitcnt lgkmcnt(5)
  v_exp_f32 v227, v227
  v_mfma_f32_16x16x32_bf16 v[112:115], a[228:231], a[176:179], v[112:115]
  ds_read_b64_tr_b16 a[210:211], v13 offset:56320
  v_fma_f32 v227, v227, v198, v198
  v_mfma_f32_16x16x32_bf16 v[120:123], a[228:231], a[180:183], v[120:123]
  v_rcp_f32 v224, v224
  v_mfma_f32_16x16x32_bf16 v[128:131], a[228:231], a[184:187], v[128:131]
  ds_read_b64_tr_b16 a[212:213], v13 offset:38912
  v_mul_f32 v100, v100, v224
  v_mfma_f32_16x16x32_bf16 v[136:139], a[228:231], a[188:191], v[136:139]
  s_waitcnt lgkmcnt(5)
  v_rcp_f32 v225, v225
  v_mfma_f32_16x16x32_bf16 v[112:115], a[232:235], a[192:195], v[112:115]
  ds_read_b64_tr_b16 a[214:215], v13 offset:57344
  v_mul_f32 v101, v101, v225
  v_mfma_f32_16x16x32_bf16 v[120:123], a[232:235], a[196:199], v[120:123]
  v_rcp_f32 v226, v226
  v_mfma_f32_16x16x32_bf16 v[128:131], a[232:235], a[200:203], v[128:131]
  ds_read_b64_tr_b16 a[216:217], v13 offset:39936
  v_mul_f32 v102, v102, v226
  v_mfma_f32_16x16x32_bf16 v[136:139], a[232:235], a[204:207], v[136:139]
  s_waitcnt lgkmcnt(5)
  v_rcp_f32 v227, v227
  v_mfma_f32_16x16x32_bf16 v[116:119], a[236:239], a[64:67], v[116:119]
  ds_read_b64_tr_b16 a[218:219], v13 offset:58368
  v_mul_f32 v103, v103, v227
  v_mfma_f32_16x16x32_bf16 v[124:127], a[236:239], a[68:71], v[124:127]
  v_mul_f32 v228, v108, v195
  v_mul_f32 v229, v109, v195
  v_mfma_f32_16x16x32_bf16 v[132:135], a[236:239], a[72:75], v[132:135]
  ds_read_b64_tr_b16 a[220:221], v13 offset:40960
  v_mul_f32 v230, v110, v195
  v_mfma_f32_16x16x32_bf16 v[140:143], a[236:239], a[76:79], v[140:143]
  s_waitcnt lgkmcnt(5)
  v_mul_f32 v231, v111, v195
  v_mfma_f32_16x16x32_bf16 v[116:119], a[208:211], a[80:83], v[116:119]
  ds_read_b64_tr_b16 a[222:223], v13 offset:59392
  v_mfma_f32_16x16x32_bf16 v[124:127], a[208:211], a[84:87], v[124:127]
  v_exp_f32 v228, v228
  v_mfma_f32_16x16x32_bf16 v[132:135], a[208:211], a[88:91], v[132:135]
  ds_read_b64_tr_b16 a[224:225], v13 offset:41984
  v_fma_f32 v228, v228, v199, v199
  v_mfma_f32_16x16x32_bf16 v[140:143], a[208:211], a[92:95], v[140:143]
  s_waitcnt lgkmcnt(5)
  v_exp_f32 v229, v229
  v_mfma_f32_16x16x32_bf16 v[116:119], a[212:215], a[96:99], v[116:119]
  ds_read_b64_tr_b16 a[226:227], v13 offset:60416
  v_fma_f32 v229, v229, v199, v199
  v_mfma_f32_16x16x32_bf16 v[124:127], a[212:215], a[100:103], v[124:127]
  v_exp_f32 v230, v230
  v_mfma_f32_16x16x32_bf16 v[132:135], a[212:215], a[104:107], v[132:135]
  ds_read_b64_tr_b16 a[228:229], v13 offset:43008
  v_fma_f32 v230, v230, v199, v199
  v_mfma_f32_16x16x32_bf16 v[140:143], a[212:215], a[108:111], v[140:143]
  s_waitcnt lgkmcnt(5)
  v_exp_f32 v231, v231
  v_mfma_f32_16x16x32_bf16 v[116:119], a[216:219], a[112:115], v[116:119]
  ds_read_b64_tr_b16 a[230:231], v13 offset:61440
  v_fma_f32 v231, v231, v199, v199
  v_mfma_f32_16x16x32_bf16 v[124:127], a[216:219], a[116:119], v[124:127]
  buffer_store_dwordx4 v[36:39], v14, s[24:27], s38 offen offset:1024 sc1
  v_mul_f32 v80, v80, v112
  v_mfma_f32_16x16x32_bf16 v[132:135], a[216:219], a[120:123], v[132:135]
  ds_read_b64_tr_b16 a[232:233], v13 offset:44032
  v_mul_f32 v81, v81, v113
  v_mfma_f32_16x16x32_bf16 v[140:143], a[216:219], a[124:127], v[140:143]
  s_waitcnt lgkmcnt(5)
  v_rcp_f32 v228, v228
  v_rcp_f32 v229, v229
  v_mfma_f32_16x16x32_bf16 v[116:119], a[220:223], a[128:131], v[116:119]
  ds_read_b64_tr_b16 a[234:235], v13 offset:62464
  v_mul_f32 v108, v108, v228
  v_mfma_f32_16x16x32_bf16 v[124:127], a[220:223], a[132:135], v[124:127]
  v_rcp_f32 v230, v230
  v_mfma_f32_16x16x32_bf16 v[132:135], a[220:223], a[136:139], v[132:135]
  ds_read_b64_tr_b16 a[236:237], v13 offset:45056
  v_mul_f32 v109, v109, v229
  v_mfma_f32_16x16x32_bf16 v[140:143], a[220:223], a[140:143], v[140:143]
  s_waitcnt lgkmcnt(5)
  v_rcp_f32 v231, v231
  v_mfma_f32_16x16x32_bf16 v[116:119], a[224:227], a[144:147], v[116:119]
  ds_read_b64_tr_b16 a[238:239], v13 offset:63488
  v_mul_f32 v110, v110, v230
  v_mfma_f32_16x16x32_bf16 v[124:127], a[224:227], a[148:151], v[124:127]
  v_mul_f32 v111, v111, v231
  v_mul_f32 v82, v82, v114
  v_mfma_f32_16x16x32_bf16 v[132:135], a[224:227], a[152:155], v[132:135]
  ds_read_b64_tr_b16 a[208:209], v10 offset:512
  v_mul_f32 v83, v83, v115
  v_mfma_f32_16x16x32_bf16 v[140:143], a[224:227], a[156:159], v[140:143]
  s_waitcnt lgkmcnt(5)
  v_cvt_pk_bf16_f32 v48, v80, v81
  v_cvt_pk_bf16_f32 v49, v82, v83
  v_mfma_f32_16x16x32_bf16 v[116:119], a[228:231], a[160:163], v[116:119]
  ds_read_b64_tr_b16 a[210:211], v10 offset:18944
  v_mul_f32 v88, v88, v120
  v_mfma_f32_16x16x32_bf16 v[124:127], a[228:231], a[164:167], v[124:127]
  v_mul_f32 v89, v89, v121
  v_mul_f32 v90, v90, v122
  v_mfma_f32_16x16x32_bf16 v[132:135], a[228:231], a[168:171], v[132:135]
  ds_read_b64_tr_b16 a[212:213], v10 offset:1536
  v_mul_f32 v91, v91, v123
  v_mfma_f32_16x16x32_bf16 v[140:143], a[228:231], a[172:175], v[140:143]
  s_waitcnt lgkmcnt(5)
  v_cvt_pk_bf16_f32 v52, v88, v89
  v_cvt_pk_bf16_f32 v53, v90, v91
  v_mfma_f32_16x16x32_bf16 v[116:119], a[232:235], a[176:179], v[116:119]
  ds_read_b64_tr_b16 a[214:215], v10 offset:19968
  v_mul_f32 v96, v96, v128
  v_mfma_f32_16x16x32_bf16 v[124:127], a[232:235], a[180:183], v[124:127]
  v_mul_f32 v97, v97, v129
  v_mul_f32 v98, v98, v130
  v_mfma_f32_16x16x32_bf16 v[132:135], a[232:235], a[184:187], v[132:135]
  ds_read_b64_tr_b16 a[216:217], v10 offset:2560
  v_mul_f32 v99, v99, v131
  v_mfma_f32_16x16x32_bf16 v[140:143], a[232:235], a[188:191], v[140:143]
  s_waitcnt lgkmcnt(5)
  v_cvt_pk_bf16_f32 v56, v96, v97
  v_cvt_pk_bf16_f32 v57, v98, v99
  v_mfma_f32_16x16x32_bf16 v[116:119], a[236:239], a[192:195], v[116:119]
  ds_read_b64_tr_b16 a[218:219], v10 offset:20992
  v_mul_f32 v104, v104, v136
  v_mfma_f32_16x16x32_bf16 v[124:127], a[236:239], a[196:199], v[124:127]
  v_mul_f32 v105, v105, v137
  v_mul_f32 v106, v106, v138
  v_mul_f32 v107, v107, v139
  v_cvt_pk_bf16_f32 v60, v104, v105
  v_cvt_pk_bf16_f32 v61, v106, v107
  v_mfma_f32_16x16x32_bf16 v[132:135], a[236:239], a[200:203], v[132:135]
  ds_read_b64_tr_b16 a[220:221], v10 offset:3584
  v_mfma_f32_16x16x32_bf16 v[140:143], a[236:239], a[204:207], v[140:143]
  s_waitcnt lgkmcnt(5)
  v_mfma_f32_16x16x32_bf16 v[80:83], a[208:211], v[144:147], 0
  ds_read_b64_tr_b16 a[222:223], v10 offset:22016
  v_mfma_f32_16x16x32_bf16 v[88:91], a[208:211], v[148:151], 0
  v_mfma_f32_16x16x32_bf16 v[96:99], a[208:211], v[152:155], 0
  ds_read_b64_tr_b16 a[224:225], v10 offset:4608
  v_mfma_f32_16x16x32_bf16 v[104:107], a[208:211], v[156:159], 0
  s_waitcnt lgkmcnt(5)
  v_mfma_f32_16x16x32_bf16 v[80:83], a[212:215], v[160:163], v[80:83]
  ds_read_b64_tr_b16 a[226:227], v10 offset:23040
  v_mul_f32 v84, v84, v116
  v_mfma_f32_16x16x32_bf16 v[88:91], a[212:215], v[164:167], v[88:91]
  buffer_store_dwordx4 v[40:43], v14, s[24:27], s38 offen offset:2048 sc1
  v_mul_f32 v85, v85, v117
  v_mfma_f32_16x16x32_bf16 v[96:99], a[212:215], v[168:171], v[96:99]
  ds_read_b64_tr_b16 a[228:229], v10 offset:5632
  v_mul_f32 v86, v86, v118
  v_mfma_f32_16x16x32_bf16 v[104:107], a[212:215], v[172:175], v[104:107]
  s_waitcnt lgkmcnt(5)
  v_mul_f32 v87, v87, v119
  v_cvt_pk_bf16_f32 v50, v84, v85
  v_mfma_f32_16x16x32_bf16 v[80:83], a[216:219], v[176:179], v[80:83]
  ds_read_b64_tr_b16 a[230:231], v10 offset:24064
  v_cvt_pk_bf16_f32 v51, v86, v87
  v_mfma_f32_16x16x32_bf16 v[88:91], a[216:219], v[180:183], v[88:91]
  v_mul_f32 v92, v92, v124
  v_mul_f32 v93, v93, v125
  v_mfma_f32_16x16x32_bf16 v[96:99], a[216:219], v[184:187], v[96:99]
  ds_read_b64_tr_b16 a[232:233], v10 offset:6656
  v_mul_f32 v94, v94, v126
  v_mfma_f32_16x16x32_bf16 v[104:107], a[216:219], v[188:191], v[104:107]
  s_waitcnt lgkmcnt(5)
  v_mul_f32 v95, v95, v127
  v_cvt_pk_bf16_f32 v54, v92, v93
  v_mfma_f32_16x16x32_bf16 v[80:83], a[220:223], v[204:207], v[80:83]
  ds_read_b64_tr_b16 a[234:235], v10 offset:25088
  v_cvt_pk_bf16_f32 v55, v94, v95
  v_mfma_f32_16x16x32_bf16 v[88:91], a[220:223], v[208:211], v[88:91]
  v_mul_f32 v100, v100, v132
  v_mfma_f32_16x16x32_bf16 v[96:99], a[220:223], v[212:215], v[96:99]
  ds_read_b64_tr_b16 a[236:237], v10 offset:7680
  v_mul_f32 v101, v101, v133
  v_mfma_f32_16x16x32_bf16 v[104:107], a[220:223], v[216:219], v[104:107]
  s_waitcnt lgkmcnt(5)
  v_mfma_f32_16x16x32_bf16 v[80:83], a[224:227], v[232:235], v[80:83]
  ds_read_b64_tr_b16 a[238:239], v10 offset:26112
  v_mul_f32 v102, v102, v134
  v_mfma_f32_16x16x32_bf16 v[88:91], a[224:227], v[236:239], v[88:91]
  v_mul_f32 v103, v103, v135
  v_mfma_f32_16x16x32_bf16 v[96:99], a[224:227], v[240:243], v[96:99]
  ds_read_b64_tr_b16 a[208:209], v10 offset:8704
  v_cvt_pk_bf16_f32 v58, v100, v101
  v_mfma_f32_16x16x32_bf16 v[104:107], a[224:227], v[244:247], v[104:107]
  s_waitcnt lgkmcnt(5)
  v_cvt_pk_bf16_f32 v59, v102, v103
  v_mfma_f32_16x16x32_bf16 v[80:83], a[228:231], a[0:3], v[80:83]
  ds_read_b64_tr_b16 a[210:211], v10 offset:27136
  v_mul_f32 v108, v108, v140
  v_mfma_f32_16x16x32_bf16 v[88:91], a[228:231], a[4:7], v[88:91]
  v_mfma_f32_16x16x32_bf16 v[96:99], a[228:231], a[8:11], v[96:99]
  ds_read_b64_tr_b16 a[212:213], v11 offset:512
  v_mul_f32 v109, v109, v141
  v_mfma_f32_16x16x32_bf16 v[104:107], a[228:231], a[12:15], v[104:107]
  s_waitcnt lgkmcnt(5)
  v_mul_f32 v110, v110, v142
  v_mfma_f32_16x16x32_bf16 v[80:83], a[232:235], a[16:19], v[80:83]
  ds_read_b64_tr_b16 a[214:215], v11 offset:18944
  v_mul_f32 v111, v111, v143
  v_mfma_f32_16x16x32_bf16 v[88:91], a[232:235], a[20:23], v[88:91]
  v_mfma_f32_16x16x32_bf16 v[96:99], a[232:235], a[24:27], v[96:99]
  ds_read_b64_tr_b16 a[216:217], v11 offset:1536
  v_cvt_pk_bf16_f32 v62, v108, v109
  v_mfma_f32_16x16x32_bf16 v[104:107], a[232:235], a[28:31], v[104:107]
  s_waitcnt lgkmcnt(5)
  v_cvt_pk_bf16_f32 v63, v110, v111
  v_mfma_f32_16x16x32_bf16 v[80:83], a[236:239], a[32:35], v[80:83]
  ds_read_b64_tr_b16 a[218:219], v11 offset:19968
  v_mfma_f32_16x16x32_bf16 v[88:91], a[236:239], a[36:39], v[88:91]
  v_mfma_f32_16x16x32_bf16 v[96:99], a[236:239], a[40:43], v[96:99]
  ds_read_b64_tr_b16 a[220:221], v11 offset:2560
  v_mfma_f32_16x16x32_bf16 v[104:107], a[236:239], a[44:47], v[104:107]
  s_waitcnt lgkmcnt(5)
  v_mfma_f32_16x16x32_bf16 v[80:83], a[208:211], a[48:51], v[80:83]
  ds_read_b64_tr_b16 a[222:223], v11 offset:20992
  v_mfma_f32_16x16x32_bf16 v[88:91], a[208:211], a[52:55], v[88:91]
  buffer_store_dwordx4 v[44:47], v14, s[24:27], s38 offen offset:3072 sc1
  v_mfma_f32_16x16x32_bf16 v[96:99], a[208:211], a[56:59], v[96:99]
  ds_read_b64_tr_b16 a[224:225], v11 offset:3584
  v_mfma_f32_16x16x32_bf16 v[104:107], a[208:211], a[60:63], v[104:107]
  s_waitcnt lgkmcnt(5)
  v_mfma_f32_16x16x32_bf16 v[84:87], a[212:215], v[144:147], 0
  ds_read_b64_tr_b16 a[226:227], v11 offset:22016
  v_mfma_f32_16x16x32_bf16 v[92:95], a[212:215], v[148:151], 0
  v_mfma_f32_16x16x32_bf16 v[100:103], a[212:215], v[152:155], 0
  ds_read_b64_tr_b16 a[228:229], v11 offset:4608
  v_mfma_f32_16x16x32_bf16 v[108:111], a[212:215], v[156:159], 0
  s_waitcnt lgkmcnt(5)
  v_mfma_f32_16x16x32_bf16 v[84:87], a[216:219], v[160:163], v[84:87]
  ds_read_b64_tr_b16 a[230:231], v11 offset:23040
  v_mfma_f32_16x16x32_bf16 v[92:95], a[216:219], v[164:167], v[92:95]
  v_mfma_f32_16x16x32_bf16 v[100:103], a[216:219], v[168:171], v[100:103]
  ds_read_b64_tr_b16 a[232:233], v11 offset:5632
  v_mfma_f32_16x16x32_bf16 v[108:111], a[216:219], v[172:175], v[108:111]
  s_waitcnt lgkmcnt(5)
  v_mfma_f32_16x16x32_bf16 v[84:87], a[220:223], v[176:179], v[84:87]
  ds_read_b64_tr_b16 a[234:235], v11 offset:24064
  v_mfma_f32_16x16x32_bf16 v[92:95], a[220:223], v[180:183], v[92:95]
  v_mfma_f32_16x16x32_bf16 v[100:103], a[220:223], v[184:187], v[100:103]
  ds_read_b64_tr_b16 a[236:237], v11 offset:6656
  v_mfma_f32_16x16x32_bf16 v[108:111], a[220:223], v[188:191], v[108:111]
  s_waitcnt lgkmcnt(5)
  v_mfma_f32_16x16x32_bf16 v[84:87], a[224:227], v[204:207], v[84:87]
  ds_read_b64_tr_b16 a[238:239], v11 offset:25088
  v_mfma_f32_16x16x32_bf16 v[92:95], a[224:227], v[208:211], v[92:95]
  v_mfma_f32_16x16x32_bf16 v[100:103], a[224:227], v[212:215], v[100:103]
  ds_read_b64_tr_b16 a[208:209], v11 offset:7680
  v_mfma_f32_16x16x32_bf16 v[108:111], a[224:227], v[216:219], v[108:111]
  s_waitcnt lgkmcnt(5)
  v_mfma_f32_16x16x32_bf16 v[84:87], a[228:231], v[232:235], v[84:87]
  ds_read_b64_tr_b16 a[210:211], v11 offset:26112
  v_mfma_f32_16x16x32_bf16 v[92:95], a[228:231], v[236:239], v[92:95]
  v_mfma_f32_16x16x32_bf16 v[100:103], a[228:231], v[240:243], v[100:103]
  ds_read_b64_tr_b16 a[212:213], v11 offset:8704
  v_mfma_f32_16x16x32_bf16 v[108:111], a[228:231], v[244:247], v[108:111]
  s_waitcnt lgkmcnt(5)
  v_mfma_f32_16x16x32_bf16 v[84:87], a[232:235], a[0:3], v[84:87]
  ds_read_b64_tr_b16 a[214:215], v11 offset:27136
  v_mfma_f32_16x16x32_bf16 v[92:95], a[232:235], a[4:7], v[92:95]
  v_mfma_f32_16x16x32_bf16 v[100:103], a[232:235], a[8:11], v[100:103]
  ds_read_b64_tr_b16 a[216:217], v12 offset:512
  v_mfma_f32_16x16x32_bf16 v[108:111], a[232:235], a[12:15], v[108:111]
  s_waitcnt lgkmcnt(5)
  v_mfma_f32_16x16x32_bf16 v[84:87], a[236:239], a[16:19], v[84:87]
  ds_read_b64_tr_b16 a[218:219], v12 offset:18944
  v_mfma_f32_16x16x32_bf16 v[92:95], a[236:239], a[20:23], v[92:95]
  v_mfma_f32_16x16x32_bf16 v[100:103], a[236:239], a[24:27], v[100:103]
  ds_read_b64_tr_b16 a[220:221], v12 offset:1536
  v_mfma_f32_16x16x32_bf16 v[108:111], a[236:239], a[28:31], v[108:111]
  s_waitcnt lgkmcnt(5)
  v_mfma_f32_16x16x32_bf16 v[84:87], a[208:211], a[32:35], v[84:87]
  s_waitcnt lgkmcnt(3)
  s_barrier
  ds_read_b64_tr_b16 a[222:223], v12 offset:19968
  v_mfma_f32_16x16x32_bf16 v[92:95], a[208:211], a[36:39], v[92:95]
  v_mfma_f32_16x16x32_bf16 v[100:103], a[208:211], a[40:43], v[100:103]
  ds_read_b64_tr_b16 a[224:225], v12 offset:2560
  v_mfma_f32_16x16x32_bf16 v[108:111], a[208:211], a[44:47], v[108:111]
  v_mfma_f32_16x16x32_bf16 v[84:87], a[212:215], a[48:51], v[84:87]
  ds_read_b64_tr_b16 a[226:227], v12 offset:20992
  v_mfma_f32_16x16x32_bf16 v[92:95], a[212:215], a[52:55], v[92:95]
  v_mfma_f32_16x16x32_bf16 v[100:103], a[212:215], a[56:59], v[100:103]
  s_add_u32 m0, s32, 0
  ds_read_b64_tr_b16 a[228:229], v12 offset:3584
  v_mfma_f32_16x16x32_bf16 v[108:111], a[212:215], a[60:63], v[108:111]
  s_waitcnt lgkmcnt(5)
  v_mfma_f32_16x16x32_bf16 v[80:83], a[216:219], a[64:67], v[80:83]
  s_add_u32 s41, s47, 0
  ds_read_b64_tr_b16 a[230:231], v12 offset:22016
  v_mfma_f32_16x16x32_bf16 v[88:91], a[216:219], a[68:71], v[88:91]
  v_mfma_f32_16x16x32_bf16 v[96:99], a[216:219], a[72:75], v[96:99]
  s_add_u32 s38, s38, 4096
  ds_read_b64_tr_b16 a[232:233], v12 offset:4608
  v_mfma_f32_16x16x32_bf16 v[104:107], a[216:219], a[76:79], v[104:107]
  s_waitcnt lgkmcnt(5)
  buffer_load_dwordx4 v3, s[24:27], s41 offen sc1 lds
  v_mfma_f32_16x16x32_bf16 v[80:83], a[220:223], a[80:83], v[80:83]
  ds_read_b64_tr_b16 a[234:235], v12 offset:23040
  v_mfma_f32_16x16x32_bf16 v[88:91], a[220:223], a[84:87], v[88:91]
  buffer_store_dwordx4 v[48:51], v14, s[24:27], s38 offen sc1
  v_mfma_f32_16x16x32_bf16 v[96:99], a[220:223], a[88:91], v[96:99]
  ds_read_b64_tr_b16 a[236:237], v12 offset:5632
  v_mfma_f32_16x16x32_bf16 v[104:107], a[220:223], a[92:95], v[104:107]
  s_waitcnt lgkmcnt(5)
  v_mfma_f32_16x16x32_bf16 v[80:83], a[224:227], a[96:99], v[80:83]
  ds_read_b64_tr_b16 a[238:239], v12 offset:24064
  v_mfma_f32_16x16x32_bf16 v[88:91], a[224:227], a[100:103], v[88:91]
  buffer_load_dwordx4 v3, s[24:27], s41 offen offset:1024 sc1 lds
  v_mfma_f32_16x16x32_bf16 v[96:99], a[224:227], a[104:107], v[96:99]
  ds_read_b64_tr_b16 a[208:209], v12 offset:6656
  v_mfma_f32_16x16x32_bf16 v[104:107], a[224:227], a[108:111], v[104:107]
  s_waitcnt lgkmcnt(5)
  v_mfma_f32_16x16x32_bf16 v[80:83], a[228:231], a[112:115], v[80:83]
  ds_read_b64_tr_b16 a[210:211], v12 offset:25088
  v_mfma_f32_16x16x32_bf16 v[88:91], a[228:231], a[116:119], v[88:91]
  v_mfma_f32_16x16x32_bf16 v[96:99], a[228:231], a[120:123], v[96:99]
  ds_read_b64_tr_b16 a[212:213], v12 offset:7680
  v_mfma_f32_16x16x32_bf16 v[104:107], a[228:231], a[124:127], v[104:107]
  s_waitcnt lgkmcnt(5)
  buffer_load_dwordx4 v3, s[24:27], s41 offen offset:2048 sc1 lds
  v_mfma_f32_16x16x32_bf16 v[80:83], a[232:235], a[128:131], v[80:83]
  ds_read_b64_tr_b16 a[214:215], v12 offset:26112
  v_mfma_f32_16x16x32_bf16 v[88:91], a[232:235], a[132:135], v[88:91]
  v_mfma_f32_16x16x32_bf16 v[96:99], a[232:235], a[136:139], v[96:99]
  ds_read_b64_tr_b16 a[216:217], v12 offset:8704
  v_mfma_f32_16x16x32_bf16 v[104:107], a[232:235], a[140:143], v[104:107]
  s_waitcnt lgkmcnt(5)
  v_mfma_f32_16x16x32_bf16 v[80:83], a[236:239], a[144:147], v[80:83]
  ds_read_b64_tr_b16 a[218:219], v12 offset:27136
  v_mfma_f32_16x16x32_bf16 v[88:91], a[236:239], a[148:151], v[88:91]
  buffer_load_dwordx4 v3, s[24:27], s41 offen offset:3072 sc1 lds
  v_mfma_f32_16x16x32_bf16 v[96:99], a[236:239], a[152:155], v[96:99]
  s_add_u32 m0, s32, 4096
  ds_read_b64_tr_b16 a[220:221], v13 offset:512
  v_mfma_f32_16x16x32_bf16 v[104:107], a[236:239], a[156:159], v[104:107]
  s_waitcnt lgkmcnt(5)
  v_mfma_f32_16x16x32_bf16 v[80:83], a[208:211], a[160:163], v[80:83]
  s_add_u32 s41, s47, 4096
  ds_read_b64_tr_b16 a[222:223], v13 offset:18944
  v_mfma_f32_16x16x32_bf16 v[88:91], a[208:211], a[164:167], v[88:91]
  v_mfma_f32_16x16x32_bf16 v[96:99], a[208:211], a[168:171], v[96:99]
  ds_read_b64_tr_b16 a[224:225], v13 offset:1536
  v_mfma_f32_16x16x32_bf16 v[104:107], a[208:211], a[172:175], v[104:107]
  s_waitcnt lgkmcnt(5)
  buffer_load_dwordx4 v3, s[24:27], s41 offen sc1 lds
  v_mfma_f32_16x16x32_bf16 v[80:83], a[212:215], a[176:179], v[80:83]
  ds_read_b64_tr_b16 a[226:227], v13 offset:19968
  v_mfma_f32_16x16x32_bf16 v[88:91], a[212:215], a[180:183], v[88:91]
  v_mfma_f32_16x16x32_bf16 v[96:99], a[212:215], a[184:187], v[96:99]
  ds_read_b64_tr_b16 a[228:229], v13 offset:2560
  v_mfma_f32_16x16x32_bf16 v[104:107], a[212:215], a[188:191], v[104:107]
  s_waitcnt lgkmcnt(5)
  v_mfma_f32_16x16x32_bf16 v[80:83], a[216:219], a[192:195], v[80:83]
  ds_read_b64_tr_b16 a[230:231], v13 offset:20992
  v_mfma_f32_16x16x32_bf16 v[88:91], a[216:219], a[196:199], v[88:91]
  buffer_load_dwordx4 v3, s[24:27], s41 offen offset:1024 sc1 lds
  v_mfma_f32_16x16x32_bf16 v[96:99], a[216:219], a[200:203], v[96:99]
  ds_read_b64_tr_b16 a[232:233], v13 offset:3584
  v_mfma_f32_16x16x32_bf16 v[104:107], a[216:219], a[204:207], v[104:107]
  s_waitcnt lgkmcnt(5)
  v_mfma_f32_16x16x32_bf16 v[84:87], a[220:223], a[64:67], v[84:87]
  ds_read_b64_tr_b16 a[234:235], v13 offset:22016
  v_mfma_f32_16x16x32_bf16 v[92:95], a[220:223], a[68:71], v[92:95]
  v_mfma_f32_16x16x32_bf16 v[100:103], a[220:223], a[72:75], v[100:103]
  ds_read_b64_tr_b16 a[236:237], v13 offset:4608
  v_mfma_f32_16x16x32_bf16 v[108:111], a[220:223], a[76:79], v[108:111]
  s_waitcnt lgkmcnt(5)
  buffer_load_dwordx4 v3, s[24:27], s41 offen offset:2048 sc1 lds
  v_mfma_f32_16x16x32_bf16 v[84:87], a[224:227], a[80:83], v[84:87]
  ds_read_b64_tr_b16 a[238:239], v13 offset:23040
  v_mul_f32 v224, v80, v192
  v_mfma_f32_16x16x32_bf16 v[92:95], a[224:227], a[84:87], v[92:95]
  v_mul_f32 v225, v81, v192
  v_mul_f32 v226, v82, v192
  v_mfma_f32_16x16x32_bf16 v[100:103], a[224:227], a[88:91], v[100:103]
  ds_read_b64_tr_b16 a[208:209], v13 offset:5632
  v_mul_f32 v227, v83, v192
  v_mfma_f32_16x16x32_bf16 v[108:111], a[224:227], a[92:95], v[108:111]
  s_waitcnt lgkmcnt(5)
  v_exp_f32 v224, v224
  v_mfma_f32_16x16x32_bf16 v[84:87], a[228:231], a[96:99], v[84:87]
  ds_read_b64_tr_b16 a[210:211], v13 offset:24064
  buffer_load_dwordx4 v3, s[24:27], s41 offen offset:3072 sc1 lds
  v_mfma_f32_16x16x32_bf16 v[92:95], a[228:231], a[100:103], v[92:95]
  buffer_load_dword v223, v15, s[4:7], 0 offen
  v_fma_f32 v224, v224, v196, v196
  v_mfma_f32_16x16x32_bf16 v[100:103], a[228:231], a[104:107], v[100:103]
  s_add_u32 m0, s32, 8192
  ds_read_b64_tr_b16 a[212:213], v13 offset:6656
  v_mfma_f32_16x16x32_bf16 v[108:111], a[228:231], a[108:111], v[108:111]
  s_waitcnt lgkmcnt(5)
  v_exp_f32 v225, v225
  v_mfma_f32_16x16x32_bf16 v[84:87], a[232:235], a[112:115], v[84:87]
  s_add_u32 s41, s47, 8192
  ds_read_b64_tr_b16 a[214:215], v13 offset:25088
  v_fma_f32 v225, v225, v196, v196
  v_mfma_f32_16x16x32_bf16 v[92:95], a[232:235], a[116:119], v[92:95]
  v_exp_f32 v226, v226
  v_mfma_f32_16x16x32_bf16 v[100:103], a[232:235], a[120:123], v[100:103]
  ds_read_b64_tr_b16 a[216:217], v13 offset:7680
  buffer_load_dwordx4 v3, s[24:27], s41 offen sc1 lds
  v_mfma_f32_16x16x32_bf16 v[108:111], a[232:235], a[124:127], v[108:111]
  s_waitcnt lgkmcnt(5)
  v_exp_f32 v227, v227
  v_mfma_f32_16x16x32_bf16 v[84:87], a[236:239], a[128:131], v[84:87]
  ds_read_b64_tr_b16 a[218:219], v13 offset:26112
  v_fma_f32 v226, v226, v196, v196
  v_mfma_f32_16x16x32_bf16 v[92:95], a[236:239], a[132:135], v[92:95]
  v_fma_f32 v227, v227, v196, v196
  v_mul_f32 v228, v88, v193
  v_mfma_f32_16x16x32_bf16 v[100:103], a[236:239], a[136:139], v[100:103]
  ds_read_b64_tr_b16 a[220:221], v13 offset:8704
  buffer_store_dwordx4 v[52:55], v14, s[24:27], s38 offen offset:1024 sc1
  v_mfma_f32_16x16x32_bf16 v[108:111], a[236:239], a[140:143], v[108:111]
  s_waitcnt lgkmcnt(5)
  v_rcp_f32 v224, v224
  v_mfma_f32_16x16x32_bf16 v[84:87], a[208:211], a[144:147], v[84:87]
  ds_read_b64_tr_b16 a[222:223], v13 offset:27136
  v_mul_f32 v80, v80, v224
  v_mfma_f32_16x16x32_bf16 v[92:95], a[208:211], a[148:151], v[92:95]
  v_rcp_f32 v225, v225
  v_mfma_f32_16x16x32_bf16 v[100:103], a[208:211], a[152:155], v[100:103]
  ds_read_b64_tr_b16 a[224:225], v10 offset:37376
  v_mul_f32 v81, v81, v225
  v_mfma_f32_16x16x32_bf16 v[108:111], a[208:211], a[156:159], v[108:111]
  s_waitcnt lgkmcnt(5)
  v_rcp_f32 v226, v226
  v_mfma_f32_16x16x32_bf16 v[84:87], a[212:215], a[160:163], v[84:87]
  ds_read_b64_tr_b16 a[226:227], v10 offset:55808
  v_mul_f32 v82, v82, v226
  v_mfma_f32_16x16x32_bf16 v[92:95], a[212:215], a[164:167], v[92:95]
  v_rcp_f32 v227, v227
  v_mfma_f32_16x16x32_bf16 v[100:103], a[212:215], a[168:171], v[100:103]
  ds_read_b64_tr_b16 a[228:229], v10 offset:38400
  v_mul_f32 v83, v83, v227
  v_mfma_f32_16x16x32_bf16 v[108:111], a[212:215], a[172:175], v[108:111]
  s_waitcnt lgkmcnt(5)
  v_mul_f32 v229, v89, v193
  v_mul_f32 v230, v90, v193
  v_mfma_f32_16x16x32_bf16 v[84:87], a[216:219], a[176:179], v[84:87]
  s_waitcnt vmcnt(12) lgkmcnt(3)
  s_barrier
  ds_read_b64_tr_b16 a[230:231], v10 offset:56832
  v_mul_f32 v231, v91, v193
  v_mfma_f32_16x16x32_bf16 v[92:95], a[216:219], a[180:183], v[92:95]
  v_exp_f32 v228, v228
  v_mfma_f32_16x16x32_bf16 v[100:103], a[216:219], a[184:187], v[100:103]
  ds_read_b64_tr_b16 a[232:233], v10 offset:39424
  buffer_store_dword v253, v252, s[20:23], s29 offen sc1
  v_mfma_f32_16x16x32_bf16 v[108:111], a[216:219], a[188:191], v[108:111]
  v_exp_f32 v229, v229
  v_mfma_f32_16x16x32_bf16 v[84:87], a[220:223], a[192:195], v[84:87]
  ds_read_b64_tr_b16 a[234:235], v10 offset:57856
  v_fma_f32 v228, v228, v197, v197
  v_mfma_f32_16x16x32_bf16 v[92:95], a[220:223], a[196:199], v[92:95]
  v_exp_f32 v230, v230
  v_mfma_f32_16x16x32_bf16 v[100:103], a[220:223], a[200:203], v[100:103]
  s_add_u32 m0, s32, 73728
  ds_read_b64_tr_b16 a[236:237], v10 offset:40448
  v_fma_f32 v229, v229, v197, v197
  v_mfma_f32_16x16x32_bf16 v[108:111], a[220:223], a[204:207], v[108:111]
  s_waitcnt lgkmcnt(5)
  v_exp_f32 v231, v231
  v_mfma_f32_16x16x32_bf16 v[112:115], a[224:227], v[144:147], 0
  s_add_u32 s41, s68, 0
  ds_read_b64_tr_b16 a[238:239], v10 offset:58880
  v_fma_f32 v230, v230, v197, v197
  v_mfma_f32_16x16x32_bf16 v[120:123], a[224:227], v[148:151], 0
  v_fma_f32 v231, v231, v197, v197
  v_mul_f32 v224, v96, v194
  v_mfma_f32_16x16x32_bf16 v[128:131], a[224:227], v[152:155], 0
  ds_read_b64_tr_b16 a[208:209], v10 offset:41472
  buffer_load_dwordx4 v248, s[16:19], s41 offen lds
  v_mfma_f32_16x16x32_bf16 v[136:139], a[224:227], v[156:159], 0
  s_waitcnt lgkmcnt(5)
  v_rcp_f32 v228, v228
  v_mfma_f32_16x16x32_bf16 v[112:115], a[228:231], v[160:163], v[112:115]
  s_add_u32 m0, s32, 74752
  ds_read_b64_tr_b16 a[210:211], v10 offset:59904
  v_mul_f32 v88, v88, v228
  v_mfma_f32_16x16x32_bf16 v[120:123], a[228:231], v[164:167], v[120:123]
  v_mov_b32 v253, 2
  v_mul_f32 v225, v97, v194
  v_rcp_f32 v229, v229
  v_mfma_f32_16x16x32_bf16 v[128:131], a[228:231], v[168:171], v[128:131]
  s_add_u32 s41, s68, 36864
  ds_read_b64_tr_b16 a[212:213], v10 offset:42496
  v_mul_f32 v89, v89, v229
  v_mfma_f32_16x16x32_bf16 v[136:139], a[228:231], v[172:175], v[136:139]
  s_waitcnt lgkmcnt(5)
  v_rcp_f32 v230, v230
  v_mfma_f32_16x16x32_bf16 v[112:115], a[232:235], v[176:179], v[112:115]
  ds_read_b64_tr_b16 a[214:215], v10 offset:60928
  buffer_load_dwordx4 v248, s[16:19], s41 offen lds
  v_mfma_f32_16x16x32_bf16 v[120:123], a[232:235], v[180:183], v[120:123]
  v_rcp_f32 v231, v231
  v_mfma_f32_16x16x32_bf16 v[128:131], a[232:235], v[184:187], v[128:131]
  s_add_u32 m0, s32, 75776
  ds_read_b64_tr_b16 a[216:217], v10 offset:43520
  v_mul_f32 v90, v90, v230
  v_mfma_f32_16x16x32_bf16 v[136:139], a[232:235], v[188:191], v[136:139]
  s_waitcnt lgkmcnt(5)
  v_mul_f32 v91, v91, v231
  v_mul_f32 v226, v98, v194
  v_mfma_f32_16x16x32_bf16 v[112:115], a[236:239], v[204:207], v[112:115]
  s_add_u32 s41, s68, 73728
  ds_read_b64_tr_b16 a[218:219], v10 offset:61952
  v_mul_f32 v227, v99, v194
  v_mfma_f32_16x16x32_bf16 v[120:123], a[236:239], v[208:211], v[120:123]
  v_exp_f32 v224, v224
  v_mfma_f32_16x16x32_bf16 v[128:131], a[236:239], v[212:215], v[128:131]
  ds_read_b64_tr_b16 a[220:221], v10 offset:44544
  buffer_load_dwordx4 v248, s[16:19], s41 offen lds
  v_mfma_f32_16x16x32_bf16 v[136:139], a[236:239], v[216:219], v[136:139]
  s_waitcnt lgkmcnt(5)
  v_exp_f32 v225, v225
  v_mfma_f32_16x16x32_bf16 v[112:115], a[208:211], v[232:235], v[112:115]
  s_add_u32 m0, s32, 76800
  ds_read_b64_tr_b16 a[222:223], v10 offset:62976
  v_fma_f32 v224, v224, v198, v198
  v_mfma_f32_16x16x32_bf16 v[120:123], a[208:211], v[236:239], v[120:123]
  v_exp_f32 v226, v226
  v_mfma_f32_16x16x32_bf16 v[128:131], a[208:211], v[240:243], v[128:131]
  s_add_u32 s41, s68, 110592
  ds_read_b64_tr_b16 a[224:225], v10 offset:45568
  v_fma_f32 v225, v225, v198, v198
  v_mfma_f32_16x16x32_bf16 v[136:139], a[208:211], v[244:247], v[136:139]
  s_waitcnt lgkmcnt(5)
  v_exp_f32 v227, v227
  v_mfma_f32_16x16x32_bf16 v[112:115], a[212:215], a[0:3], v[112:115]
  ds_read_b64_tr_b16 a[226:227], v10 offset:64000
  v_fma_f32 v226, v226, v198, v198
  v_mfma_f32_16x16x32_bf16 v[120:123], a[212:215], a[4:7], v[120:123]
  buffer_load_dwordx4 v248, s[16:19], s41 offen lds
  v_fma_f32 v227, v227, v198, v198
  v_mfma_f32_16x16x32_bf16 v[128:131], a[212:215], a[8:11], v[128:131]
  s_add_u32 m0, s32, 77824
  ds_read_b64_tr_b16 a[228:229], v11 offset:37376
  v_mul_f32 v228, v104, v195
  v_mfma_f32_16x16x32_bf16 v[136:139], a[212:215], a[12:15], v[136:139]
  s_waitcnt lgkmcnt(5)
  v_rcp_f32 v224, v224
  v_mfma_f32_16x16x32_bf16 v[112:115], a[216:219], a[16:19], v[112:115]
  s_add_u32 s41, s69, 0
  ds_read_b64_tr_b16 a[230:231], v11 offset:55808
  v_mul_f32 v96, v96, v224
  v_mfma_f32_16x16x32_bf16 v[120:123], a[216:219], a[20:23], v[120:123]
  v_rcp_f32 v225, v225
  v_mfma_f32_16x16x32_bf16 v[128:131], a[216:219], a[24:27], v[128:131]
  ds_read_b64_tr_b16 a[232:233], v11 offset:38400
  buffer_load_dwordx4 v248, s[16:19], s41 offen lds
  v_mfma_f32_16x16x32_bf16 v[136:139], a[216:219], a[28:31], v[136:139]
  s_waitcnt lgkmcnt(5)
  v_rcp_f32 v226, v226
  v_rcp_f32 v227, v227
  v_mfma_f32_16x16x32_bf16 v[112:115], a[220:223], a[32:35], v[112:115]
  s_add_u32 m0, s32, 78848
  ds_read_b64_tr_b16 a[234:235], v11 offset:56832
  v_mul_f32 v97, v97, v225
  v_mfma_f32_16x16x32_bf16 v[120:123], a[220:223], a[36:39], v[120:123]
  v_mul_f32 v98, v98, v226
  v_mul_f32 v99, v99, v227
  v_mfma_f32_16x16x32_bf16 v[128:131], a[220:223], a[40:43], v[128:131]
  s_add_u32 s41, s70, 0
  ds_read_b64_tr_b16 a[236:237], v11 offset:39424
  v_mul_f32 v229, v105, v195
  v_mfma_f32_16x16x32_bf16 v[136:139], a[220:223], a[44:47], v[136:139]
  s_waitcnt lgkmcnt(5)
  v_mul_f32 v230, v106, v195
  v_mul_f32 v231, v107, v195
  v_mfma_f32_16x16x32_bf16 v[112:115], a[224:227], a[48:51], v[112:115]
  ds_read_b64_tr_b16 a[238:239], v11 offset:57856
  buffer_load_dwordx4 v248, s[16:19], s41 offen lds
  v_mfma_f32_16x16x32_bf16 v[120:123], a[224:227], a[52:55], v[120:123]
  buffer_store_dwordx4 v[56:59], v14, s[24:27], s38 offen offset:2048 sc1
  v_mfma_f32_16x16x32_bf16 v[128:131], a[224:227], a[56:59], v[128:131]
  s_add_u32 m0, s32, 79872
  ds_read_b64_tr_b16 a[208:209], v11 offset:40448
  v_mfma_f32_16x16x32_bf16 v[136:139], a[224:227], a[60:63], v[136:139]
  s_waitcnt lgkmcnt(5)
  v_exp_f32 v228, v228
  v_mfma_f32_16x16x32_bf16 v[116:119], a[228:231], v[144:147], 0
  s_add_u32 s41, s71, 0
  ds_read_b64_tr_b16 a[210:211], v11 offset:58880
  v_fma_f32 v228, v228, v199, v199
  v_mfma_f32_16x16x32_bf16 v[124:127], a[228:231], v[148:151], 0
  v_exp_f32 v229, v229
  v_mfma_f32_16x16x32_bf16 v[132:135], a[228:231], v[152:155], 0
  ds_read_b64_tr_b16 a[212:213], v11 offset:41472
  buffer_load_dwordx4 v248, s[16:19], s41 offen lds
  v_mfma_f32_16x16x32_bf16 v[140:143], a[228:231], v[156:159], 0
  s_waitcnt lgkmcnt(5)
  v_exp_f32 v230, v230
  v_exp_f32 v231, v231
  v_mfma_f32_16x16x32_bf16 v[116:119], a[232:235], v[160:163], v[116:119]
  s_add_u32 m0, s32, 80896
  ds_read_b64_tr_b16 a[214:215], v11 offset:59904
  v_fma_f32 v229, v229, v199, v199
  v_mfma_f32_16x16x32_bf16 v[124:127], a[232:235], v[164:167], v[124:127]
  v_fma_f32 v230, v230, v199, v199
  v_fma_f32 v231, v231, v199, v199
  v_mfma_f32_16x16x32_bf16 v[132:135], a[232:235], v[168:171], v[132:135]
  s_add_u32 s41, s69, 36864
  ds_read_b64_tr_b16 a[216:217], v11 offset:42496
  v_mul_f32 v224, v84, v192
  v_mfma_f32_16x16x32_bf16 v[140:143], a[232:235], v[172:175], v[140:143]
  s_waitcnt lgkmcnt(5)
  v_rcp_f32 v228, v228
  v_mfma_f32_16x16x32_bf16 v[116:119], a[236:239], v[176:179], v[116:119]
  ds_read_b64_tr_b16 a[218:219], v11 offset:60928
  buffer_load_dwordx4 v248, s[16:19], s41 offen lds
  v_mfma_f32_16x16x32_bf16 v[124:127], a[236:239], v[180:183], v[124:127]
  v_rcp_f32 v229, v229
  v_mfma_f32_16x16x32_bf16 v[132:135], a[236:239], v[184:187], v[132:135]
  s_add_u32 m0, s32, 81920
  ds_read_b64_tr_b16 a[220:221], v11 offset:43520
  v_mul_f32 v104, v104, v228
  v_mfma_f32_16x16x32_bf16 v[140:143], a[236:239], v[188:191], v[140:143]
  s_waitcnt lgkmcnt(5)
  v_rcp_f32 v230, v230
  v_rcp_f32 v231, v231
  v_mfma_f32_16x16x32_bf16 v[116:119], a[208:211], v[204:207], v[116:119]
  s_add_u32 s41, s70, 36864
  ds_read_b64_tr_b16 a[222:223], v11 offset:61952
  v_mul_f32 v105, v105, v229
  v_mfma_f32_16x16x32_bf16 v[124:127], a[208:211], v[208:211], v[124:127]
  v_mul_f32 v106, v106, v230
  v_mul_f32 v107, v107, v231
  v_mfma_f32_16x16x32_bf16 v[132:135], a[208:211], v[212:215], v[132:135]
  ds_read_b64_tr_b16 a[224:225], v11 offset:44544
  v_mul_f32 v225, v85, v192
  v_mfma_f32_16x16x32_bf16 v[140:143], a[208:211], v[216:219], v[140:143]
  s_waitcnt lgkmcnt(5)
  buffer_load_dwordx4 v248, s[16:19], s41 offen lds
  v_mul_f32 v226, v86, v192
  v_mfma_f32_16x16x32_bf16 v[116:119], a[212:215], v[232:235], v[116:119]
  ds_read_b64_tr_b16 a[226:227], v11 offset:62976
  v_mul_f32 v227, v87, v192
  v_mfma_f32_16x16x32_bf16 v[124:127], a[212:215], v[236:239], v[124:127]
  v_exp_f32 v224, v224
  v_mfma_f32_16x16x32_bf16 v[132:135], a[212:215], v[240:243], v[132:135]
  ds_read_b64_tr_b16 a[228:229], v11 offset:45568
  v_fma_f32 v224, v224, v196, v196
  v_mfma_f32_16x16x32_bf16 v[140:143], a[212:215], v[244:247], v[140:143]
  s_waitcnt lgkmcnt(5)
  v_exp_f32 v225, v225
  v_mfma_f32_16x16x32_bf16 v[116:119], a[216:219], a[0:3], v[116:119]
  ds_read_b64_tr_b16 a[230:231], v11 offset:64000
  v_fma_f32 v225, v225, v196, v196
  v_mfma_f32_16x16x32_bf16 v[124:127], a[216:219], a[4:7], v[124:127]
  v_exp_f32 v226, v226
  v_mfma_f32_16x16x32_bf16 v[132:135], a[216:219], a[8:11], v[132:135]
  ds_read_b64_tr_b16 a[232:233], v12 offset:37376
  v_fma_f32 v226, v226, v196, v196
  v_mfma_f32_16x16x32_bf16 v[140:143], a[216:219], a[12:15], v[140:143]
  s_waitcnt lgkmcnt(5)
  v_exp_f32 v227, v227
  v_mfma_f32_16x16x32_bf16 v[116:119], a[220:223], a[16:19], v[116:119]
  ds_read_b64_tr_b16 a[234:235], v12 offset:55808
  v_fma_f32 v227, v227, v196, v196
  v_mfma_f32_16x16x32_bf16 v[124:127], a[220:223], a[20:23], v[124:127]
  v_rcp_f32 v224, v224
  v_mfma_f32_16x16x32_bf16 v[132:135], a[220:223], a[24:27], v[132:135]
  ds_read_b64_tr_b16 a[236:237], v12 offset:38400
  v_mul_f32 v84, v84, v224
  v_mfma_f32_16x16x32_bf16 v[140:143], a[220:223], a[28:31], v[140:143]
  s_waitcnt lgkmcnt(5)
  v_rcp_f32 v225, v225
  v_mfma_f32_16x16x32_bf16 v[116:119], a[224:227], a[32:35], v[116:119]
  s_waitcnt lgkmcnt(3)
  s_barrier
  ds_read_b64_tr_b16 a[238:239], v12 offset:56832
  v_mul_f32 v85, v85, v225
  v_mfma_f32_16x16x32_bf16 v[124:127], a[224:227], a[36:39], v[124:127]
  v_rcp_f32 v226, v226
  v_mfma_f32_16x16x32_bf16 v[132:135], a[224:227], a[40:43], v[132:135]
  ds_read_b64_tr_b16 a[208:209], v12 offset:39424
  v_mul_f32 v86, v86, v226
  v_mfma_f32_16x16x32_bf16 v[140:143], a[224:227], a[44:47], v[140:143]
  v_rcp_f32 v227, v227
  v_mfma_f32_16x16x32_bf16 v[116:119], a[228:231], a[48:51], v[116:119]
  ds_read_b64_tr_b16 a[210:211], v12 offset:57856
  v_mul_f32 v87, v87, v227
  v_mfma_f32_16x16x32_bf16 v[124:127], a[228:231], a[52:55], v[124:127]
  v_mul_f32 v228, v92, v193
  v_mul_f32 v229, v93, v193
  v_mfma_f32_16x16x32_bf16 v[132:135], a[228:231], a[56:59], v[132:135]
  s_add_u32 m0, s32, 36864
  ds_read_b64_tr_b16 a[212:213], v12 offset:40448
  v_mul_f32 v230, v94, v193
  v_mfma_f32_16x16x32_bf16 v[140:143], a[228:231], a[60:63], v[140:143]
  s_waitcnt lgkmcnt(5)
  v_mul_f32 v231, v95, v193
  v_mfma_f32_16x16x32_bf16 v[112:115], a[232:235], a[64:67], v[112:115]
  s_add_u32 s41, s68, 128
  ds_read_b64_tr_b16 a[214:215], v12 offset:58880
  v_mfma_f32_16x16x32_bf16 v[120:123], a[232:235], a[68:71], v[120:123]
  v_exp_f32 v228, v228
  v_mfma_f32_16x16x32_bf16 v[128:131], a[232:235], a[72:75], v[128:131]
  ds_read_b64_tr_b16 a[216:217], v12 offset:41472
  buffer_load_dwordx4 v248, s[16:19], s41 offen lds
  v_mfma_f32_16x16x32_bf16 v[136:139], a[232:235], a[76:79], v[136:139]
  s_waitcnt lgkmcnt(5)
  v_exp_f32 v229, v229
  v_mfma_f32_16x16x32_bf16 v[112:115], a[236:239], a[80:83], v[112:115]
  s_add_u32 m0, s32, 37888
  ds_read_b64_tr_b16 a[218:219], v12 offset:59904
  v_fma_f32 v228, v228, v197, v197
  v_mfma_f32_16x16x32_bf16 v[120:123], a[236:239], a[84:87], v[120:123]
  v_exp_f32 v230, v230
  v_exp_f32 v231, v231
  v_mfma_f32_16x16x32_bf16 v[128:131], a[236:239], a[88:91], v[128:131]
  s_add_u32 s41, s68, 36992
  ds_read_b64_tr_b16 a[220:221], v12 offset:42496
  v_fma_f32 v229, v229, v197, v197
  v_mfma_f32_16x16x32_bf16 v[136:139], a[236:239], a[92:95], v[136:139]
  s_waitcnt lgkmcnt(5)
  v_fma_f32 v230, v230, v197, v197
  v_fma_f32 v231, v231, v197, v197
  v_mfma_f32_16x16x32_bf16 v[112:115], a[208:211], a[96:99], v[112:115]
  ds_read_b64_tr_b16 a[222:223], v12 offset:60928
  buffer_load_dwordx4 v248, s[16:19], s41 offen lds
  v_mfma_f32_16x16x32_bf16 v[120:123], a[208:211], a[100:103], v[120:123]
  v_rcp_f32 v228, v228
  v_mfma_f32_16x16x32_bf16 v[128:131], a[208:211], a[104:107], v[128:131]
  s_add_u32 m0, s32, 38912
  ds_read_b64_tr_b16 a[224:225], v12 offset:43520
  buffer_store_dwordx4 v[60:63], v14, s[24:27], s38 offen offset:3072 sc1
  v_mfma_f32_16x16x32_bf16 v[136:139], a[208:211], a[108:111], v[136:139]
  s_waitcnt lgkmcnt(5)
  v_rcp_f32 v229, v229
  v_mfma_f32_16x16x32_bf16 v[112:115], a[212:215], a[112:115], v[112:115]
  s_add_u32 s41, s68, 73856
  ds_read_b64_tr_b16 a[226:227], v12 offset:61952
  v_mul_f32 v92, v92, v228
  v_mfma_f32_16x16x32_bf16 v[120:123], a[212:215], a[116:119], v[120:123]
  v_rcp_f32 v230, v230
  v_mfma_f32_16x16x32_bf16 v[128:131], a[212:215], a[120:123], v[128:131]
  ds_read_b64_tr_b16 a[228:229], v12 offset:44544
  buffer_load_dwordx4 v248, s[16:19], s41 offen lds
  v_mfma_f32_16x16x32_bf16 v[136:139], a[212:215], a[124:127], v[136:139]
  s_waitcnt lgkmcnt(5)
  v_rcp_f32 v231, v231
  v_mfma_f32_16x16x32_bf16 v[112:115], a[216:219], a[128:131], v[112:115]
  s_add_u32 m0, s32, 39936
  ds_read_b64_tr_b16 a[230:231], v12 offset:62976
  v_mul_f32 v93, v93, v229
  v_mfma_f32_16x16x32_bf16 v[120:123], a[216:219], a[132:135], v[120:123]
  v_mul_f32 v94, v94, v230
  v_mul_f32 v95, v95, v231
  v_mfma_f32_16x16x32_bf16 v[128:131], a[216:219], a[136:139], v[128:131]
  s_add_u32 s41, s68, 110720
  ds_read_b64_tr_b16 a[232:233], v12 offset:45568
  v_mul_f32 v224, v100, v194
  v_mfma_f32_16x16x32_bf16 v[136:139], a[216:219], a[140:143], v[136:139]
  s_waitcnt lgkmcnt(5)
  v_mul_f32 v225, v101, v194
  v_mul_f32 v226, v102, v194
  v_mfma_f32_16x16x32_bf16 v[112:115], a[220:223], a[144:147], v[112:115]
  ds_read_b64_tr_b16 a[234:235], v12 offset:64000
  v_mul_f32 v227, v103, v194
  v_mfma_f32_16x16x32_bf16 v[120:123], a[220:223], a[148:151], v[120:123]
  buffer_load_dwordx4 v248, s[16:19], s41 offen lds
  v_exp_f32 v224, v224
  v_mfma_f32_16x16x32_bf16 v[128:131], a[220:223], a[152:155], v[128:131]
  s_add_u32 m0, s32, 40960
  ds_read_b64_tr_b16 a[236:237], v13 offset:37376
  v_fma_f32 v224, v224, v198, v198
  v_mfma_f32_16x16x32_bf16 v[136:139], a[220:223], a[156:159], v[136:139]
  s_waitcnt lgkmcnt(5)
  v_exp_f32 v225, v225
  v_mfma_f32_16x16x32_bf16 v[112:115], a[224:227], a[160:163], v[112:115]
  s_add_u32 s41, s69, 128
  ds_read_b64_tr_b16 a[238:239], v13 offset:55808
  v_fma_f32 v225, v225, v198, v198
  v_mfma_f32_16x16x32_bf16 v[120:123], a[224:227], a[164:167], v[120:123]
  v_exp_f32 v226, v226
  v_mfma_f32_16x16x32_bf16 v[128:131], a[224:227], a[168:171], v[128:131]
  ds_read_b64_tr_b16 a[208:209], v13 offset:38400
  buffer_load_dwordx4 v248, s[16:19], s41 offen lds
  v_mfma_f32_16x16x32_bf16 v[136:139], a[224:227], a[172:175], v[136:139]
  s_waitcnt lgkmcnt(5)
  v_exp_f32 v227, v227
  v_mfma_f32_16x16x32_bf16 v[112:115], a[228:231], a[176:179], v[112:115]
  s_add_u32 m0, s32, 41984
  ds_read_b64_tr_b16 a[210:211], v13 offset:56832
  v_fma_f32 v226, v226, v198, v198
  v_mfma_f32_16x16x32_bf16 v[120:123], a[228:231], a[180:183], v[120:123]
  v_fma_f32 v227, v227, v198, v198
  v_mul_f32 v228, v108, v195
  v_mfma_f32_16x16x32_bf16 v[128:131], a[228:231], a[184:187], v[128:131]
  s_add_u32 s41, s70, 128
  ds_read_b64_tr_b16 a[212:213], v13 offset:39424
  v_mul_f32 v229, v109, v195
  v_mfma_f32_16x16x32_bf16 v[136:139], a[228:231], a[188:191], v[136:139]
  s_waitcnt lgkmcnt(5)
  v_rcp_f32 v224, v224
  v_rcp_f32 v225, v225
  v_mfma_f32_16x16x32_bf16 v[112:115], a[232:235], a[192:195], v[112:115]
  ds_read_b64_tr_b16 a[214:215], v13 offset:57856
  buffer_load_dwordx4 v248, s[16:19], s41 offen lds
  v_mfma_f32_16x16x32_bf16 v[120:123], a[232:235], a[196:199], v[120:123]
  v_rcp_f32 v226, v226
  v_mfma_f32_16x16x32_bf16 v[128:131], a[232:235], a[200:203], v[128:131]
  s_add_u32 m0, s32, 43008
  ds_read_b64_tr_b16 a[216:217], v13 offset:40448
  v_mul_f32 v100, v100, v224
  v_mfma_f32_16x16x32_bf16 v[136:139], a[232:235], a[204:207], v[136:139]
  s_waitcnt lgkmcnt(5)
  v_rcp_f32 v227, v227
  v_mul_f32 v101, v101, v225
  v_mfma_f32_16x16x32_bf16 v[116:119], a[236:239], a[64:67], v[116:119]
  s_add_u32 s41, s71, 128
  ds_read_b64_tr_b16 a[218:219], v13 offset:58880
  v_mul_f32 v102, v102, v226
  v_mfma_f32_16x16x32_bf16 v[124:127], a[236:239], a[68:71], v[124:127]
  v_mul_f32 v103, v103, v227
  v_mul_f32 v230, v110, v195
  v_mfma_f32_16x16x32_bf16 v[132:135], a[236:239], a[72:75], v[132:135]
  ds_read_b64_tr_b16 a[220:221], v13 offset:41472
  v_mul_f32 v231, v111, v195
  v_mfma_f32_16x16x32_bf16 v[140:143], a[236:239], a[76:79], v[140:143]
  s_waitcnt lgkmcnt(5)
  buffer_load_dwordx4 v248, s[16:19], s41 offen lds
  v_mfma_f32_16x16x32_bf16 v[116:119], a[208:211], a[80:83], v[116:119]
  s_add_u32 m0, s32, 44032
  ds_read_b64_tr_b16 a[222:223], v13 offset:59904
  v_mfma_f32_16x16x32_bf16 v[124:127], a[208:211], a[84:87], v[124:127]
  v_exp_f32 v228, v228
  v_mfma_f32_16x16x32_bf16 v[132:135], a[208:211], a[88:91], v[132:135]
  s_add_u32 s41, s69, 36992
  ds_read_b64_tr_b16 a[224:225], v13 offset:42496
  v_fma_f32 v228, v228, v199, v199
  v_mfma_f32_16x16x32_bf16 v[140:143], a[208:211], a[92:95], v[140:143]
  s_waitcnt lgkmcnt(5)
  v_exp_f32 v229, v229
  v_mfma_f32_16x16x32_bf16 v[116:119], a[212:215], a[96:99], v[116:119]
  ds_read_b64_tr_b16 a[226:227], v13 offset:60928
  buffer_load_dwordx4 v248, s[16:19], s41 offen lds
  v_mfma_f32_16x16x32_bf16 v[124:127], a[212:215], a[100:103], v[124:127]
  v_exp_f32 v230, v230
  v_exp_f32 v231, v231
  v_mfma_f32_16x16x32_bf16 v[132:135], a[212:215], a[104:107], v[132:135]
  s_add_u32 m0, s32, 45056
  ds_read_b64_tr_b16 a[228:229], v13 offset:43520
  v_fma_f32 v229, v229, v199, v199
  v_mfma_f32_16x16x32_bf16 v[140:143], a[212:215], a[108:111], v[140:143]
  s_waitcnt lgkmcnt(5)
  v_fma_f32 v230, v230, v199, v199
  v_fma_f32 v231, v231, v199, v199
  v_mfma_f32_16x16x32_bf16 v[116:119], a[216:219], a[112:115], v[116:119]
  s_add_u32 s41, s70, 36992
  ds_read_b64_tr_b16 a[230:231], v13 offset:61952
  v_mul_f32 v80, v80, v112
  v_mfma_f32_16x16x32_bf16 v[124:127], a[216:219], a[116:119], v[124:127]
  v_rcp_f32 v228, v228
  v_mfma_f32_16x16x32_bf16 v[132:135], a[216:219], a[120:123], v[132:135]
  ds_read_b64_tr_b16 a[232:233], v13 offset:44544
  buffer_load_dwordx4 v248, s[16:19], s41 offen lds
  v_mfma_f32_16x16x32_bf16 v[140:143], a[216:219], a[124:127], v[140:143]
  s_waitcnt lgkmcnt(5)
  v_rcp_f32 v229, v229
  v_mfma_f32_16x16x32_bf16 v[116:119], a[220:223], a[128:131], v[116:119]
  ds_read_b64_tr_b16 a[234:235], v13 offset:62976
  v_mul_f32 v108, v108, v228
  v_mfma_f32_16x16x32_bf16 v[124:127], a[220:223], a[132:135], v[124:127]
  v_rcp_f32 v230, v230
  v_mfma_f32_16x16x32_bf16 v[132:135], a[220:223], a[136:139], v[132:135]
  ds_read_b64_tr_b16 a[236:237], v13 offset:45568
  v_mul_f32 v109, v109, v229
  v_mfma_f32_16x16x32_bf16 v[140:143], a[220:223], a[140:143], v[140:143]
  s_waitcnt lgkmcnt(5)
  v_rcp_f32 v231, v231
  v_mfma_f32_16x16x32_bf16 v[116:119], a[224:227], a[144:147], v[116:119]
  ds_read_b64_tr_b16 a[238:239], v13 offset:64000
  v_mul_f32 v110, v110, v230
  v_mfma_f32_16x16x32_bf16 v[124:127], a[224:227], a[148:151], v[124:127]
  v_mul_f32 v111, v111, v231
  v_mul_f32 v81, v81, v113
  v_mfma_f32_16x16x32_bf16 v[132:135], a[224:227], a[152:155], v[132:135]
  v_mul_f32 v82, v82, v114
  v_mul_f32 v83, v83, v115
  v_mfma_f32_16x16x32_bf16 v[140:143], a[224:227], a[156:159], v[140:143]
  s_waitcnt lgkmcnt(4)
  v_cvt_pk_bf16_f32 v64, v80, v81
  v_cvt_pk_bf16_f32 v65, v82, v83
  v_mfma_f32_16x16x32_bf16 v[116:119], a[228:231], a[160:163], v[116:119]
  v_mul_f32 v88, v88, v120
  v_mul_f32 v89, v89, v121
  v_mfma_f32_16x16x32_bf16 v[124:127], a[228:231], a[164:167], v[124:127]
  v_mul_f32 v90, v90, v122
  v_mul_f32 v91, v91, v123
  v_mfma_f32_16x16x32_bf16 v[132:135], a[228:231], a[168:171], v[132:135]
  v_cvt_pk_bf16_f32 v68, v88, v89
  v_cvt_pk_bf16_f32 v69, v90, v91
  v_mfma_f32_16x16x32_bf16 v[140:143], a[228:231], a[172:175], v[140:143]
  s_waitcnt lgkmcnt(2)
  v_mul_f32 v96, v96, v128
  v_mul_f32 v97, v97, v129
  v_mfma_f32_16x16x32_bf16 v[116:119], a[232:235], a[176:179], v[116:119]
  s_waitcnt vmcnt(22) lgkmcnt(0)
  s_barrier
  ds_read_b64_tr_b16 a[208:209], v255 offset:0
  v_mul_f32 v98, v98, v130
  v_mfma_f32_16x16x32_bf16 v[124:127], a[232:235], a[180:183], v[124:127]
  ds_read_b64_tr_b16 a[210:211], v255 offset:512
  v_mul_f32 v99, v99, v131
  v_mfma_f32_16x16x32_bf16 v[132:135], a[232:235], a[184:187], v[132:135]
  ds_read_b64_tr_b16 a[212:213], v255 offset:1024
  v_cvt_pk_bf16_f32 v72, v96, v97
  v_mfma_f32_16x16x32_bf16 v[140:143], a[232:235], a[188:191], v[140:143]
  ds_read_b64_tr_b16 a[216:217], v255 offset:2048
  v_cvt_pk_bf16_f32 v73, v98, v99
  v_mul_f32 v104, v104, v136
  v_mfma_f32_16x16x32_bf16 v[116:119], a[236:239], a[192:195], v[116:119]
  ds_read_b64_tr_b16 a[214:215], v255 offset:1536
  v_mul_f32 v105, v105, v137
  v_mfma_f32_16x16x32_bf16 v[124:127], a[236:239], a[196:199], v[124:127]
  ds_read_b64_tr_b16 a[218:219], v255 offset:2560
  v_mul_f32 v106, v106, v138
  v_mul_f32 v107, v107, v139
  v_cvt_pk_bf16_f32 v76, v104, v105
  v_cvt_pk_bf16_f32 v77, v106, v107
  v_mfma_f32_16x16x32_bf16 v[132:135], a[236:239], a[200:203], v[132:135]
  s_add_u32 m0, s76, 110592
  ds_read_b64_tr_b16 a[220:221], v255 offset:3072
  v_mfma_f32_16x16x32_bf16 v[140:143], a[236:239], a[204:207], v[140:143]
  s_waitcnt lgkmcnt(5)
  v_mfma_f32_16x16x32_bf16 v[80:83], a[208:211], v[144:147], 0
  s_mov_b32 s41, s74
  ds_read_b64_tr_b16 a[222:223], v255 offset:3584
  v_mfma_f32_16x16x32_bf16 v[88:91], a[208:211], v[148:151], 0
  v_mfma_f32_16x16x32_bf16 v[96:99], a[208:211], v[152:155], 0
  ds_read_b64_tr_b16 a[224:225], v255 offset:4096
  v_mfma_f32_16x16x32_bf16 v[104:107], a[208:211], v[156:159], 0
  s_waitcnt lgkmcnt(4)
  buffer_load_dwordx4 v14, s[24:27], s41 offen sc1 lds
  v_mfma_f32_16x16x32_bf16 v[80:83], a[212:215], v[160:163], v[80:83]
  ds_read_b64_tr_b16 a[226:227], v255 offset:4608
  v_mul_f32 v84, v84, v116
  v_mfma_f32_16x16x32_bf16 v[88:91], a[212:215], v[164:167], v[88:91]
  v_mul_f32 v85, v85, v117
  v_mul_f32 v86, v86, v118
  v_mfma_f32_16x16x32_bf16 v[96:99], a[212:215], v[168:171], v[96:99]
  ds_read_b64_tr_b16 a[228:229], v255 offset:5120
  v_mul_f32 v87, v87, v119
  v_mfma_f32_16x16x32_bf16 v[104:107], a[212:215], v[172:175], v[104:107]
  s_waitcnt lgkmcnt(5)
  v_cvt_pk_bf16_f32 v66, v84, v85
  v_cvt_pk_bf16_f32 v67, v86, v87
  v_mfma_f32_16x16x32_bf16 v[80:83], a[216:219], v[176:179], v[80:83]
  ds_read_b64_tr_b16 a[230:231], v255 offset:5632
  v_mul_f32 v92, v92, v124
  v_mfma_f32_16x16x32_bf16 v[88:91], a[216:219], v[180:183], v[88:91]
  buffer_load_dwordx4 v14, s[24:27], s41 offen offset:1024 sc1 lds
  v_mul_f32 v93, v93, v125
  v_mfma_f32_16x16x32_bf16 v[96:99], a[216:219], v[184:187], v[96:99]
  ds_read_b64_tr_b16 a[232:233], v255 offset:6144
  v_mul_f32 v94, v94, v126
  v_mfma_f32_16x16x32_bf16 v[104:107], a[216:219], v[188:191], v[104:107]
  s_waitcnt lgkmcnt(5)
  v_mul_f32 v95, v95, v127
  v_cvt_pk_bf16_f32 v70, v92, v93
  v_mfma_f32_16x16x32_bf16 v[80:83], a[220:223], v[204:207], v[80:83]
  ds_read_b64_tr_b16 a[234:235], v255 offset:6656
  v_cvt_pk_bf16_f32 v71, v94, v95
  v_mfma_f32_16x16x32_bf16 v[88:91], a[220:223], v[208:211], v[88:91]
  v_mul_f32 v100, v100, v132
  v_mul_f32 v101, v101, v133
  v_mfma_f32_16x16x32_bf16 v[96:99], a[220:223], v[212:215], v[96:99]
  ds_read_b64_tr_b16 a[236:237], v255 offset:7168
  v_mul_f32 v102, v102, v134
  v_mfma_f32_16x16x32_bf16 v[104:107], a[220:223], v[216:219], v[104:107]
  s_waitcnt lgkmcnt(5)
  buffer_load_dwordx4 v14, s[24:27], s41 offen offset:2048 sc1 lds
  v_mul_f32 v103, v103, v135
  v_mfma_f32_16x16x32_bf16 v[80:83], a[224:227], v[232:235], v[80:83]
  ds_read_b64_tr_b16 a[238:239], v255 offset:7680
  v_cvt_pk_bf16_f32 v74, v100, v101
  v_mfma_f32_16x16x32_bf16 v[88:91], a[224:227], v[236:239], v[88:91]
  v_cvt_pk_bf16_f32 v75, v102, v103
  v_mul_f32 v108, v108, v140
  v_mfma_f32_16x16x32_bf16 v[96:99], a[224:227], v[240:243], v[96:99]
  ds_read_b64_tr_b16 a[208:209], v255 offset:8192
  v_mul_f32 v109, v109, v141
  v_mfma_f32_16x16x32_bf16 v[104:107], a[224:227], v[244:247], v[104:107]
  s_waitcnt lgkmcnt(5)
  v_mul_f32 v110, v110, v142
  v_mfma_f32_16x16x32_bf16 v[80:83], a[228:231], a[0:3], v[80:83]
  ds_read_b64_tr_b16 a[210:211], v255 offset:8704
  v_mul_f32 v111, v111, v143
  v_mfma_f32_16x16x32_bf16 v[88:91], a[228:231], a[4:7], v[88:91]
  buffer_load_dwordx4 v14, s[24:27], s41 offen offset:3072 sc1 lds
  v_mfma_f32_16x16x32_bf16 v[96:99], a[228:231], a[8:11], v[96:99]
  s_add_u32 m0, s77, 110592
  ds_read_b64_tr_b16 a[212:213], v255 offset:9216
  v_cvt_pk_bf16_f32 v78, v108, v109
  v_mfma_f32_16x16x32_bf16 v[104:107], a[228:231], a[12:15], v[104:107]
  s_waitcnt lgkmcnt(5)
  v_cvt_pk_bf16_f32 v79, v110, v111
  v_mfma_f32_16x16x32_bf16 v[80:83], a[232:235], a[16:19], v[80:83]
  s_mov_b32 s41, s75
  ds_read_b64_tr_b16 a[214:215], v255 offset:9728
  v_mfma_f32_16x16x32_bf16 v[88:91], a[232:235], a[20:23], v[88:91]
  v_mfma_f32_16x16x32_bf16 v[96:99], a[232:235], a[24:27], v[96:99]
  ds_read_b64_tr_b16 a[216:217], v255 offset:10240
  v_mfma_f32_16x16x32_bf16 v[104:107], a[232:235], a[28:31], v[104:107]
  s_waitcnt lgkmcnt(5)
  buffer_load_dwordx4 v249, s[24:27], s41 offen sc1 lds
  v_mfma_f32_16x16x32_bf16 v[80:83], a[236:239], a[32:35], v[80:83]
  ds_read_b64_tr_b16 a[218:219], v255 offset:10752
  v_mfma_f32_16x16x32_bf16 v[88:91], a[236:239], a[36:39], v[88:91]
  buffer_load_dword v220, v254, s[20:23], s30 offen sc1
  v_mfma_f32_16x16x32_bf16 v[96:99], a[236:239], a[40:43], v[96:99]
  ds_read_b64_tr_b16 a[220:221], v255 offset:11264
  v_mfma_f32_16x16x32_bf16 v[104:107], a[236:239], a[44:47], v[104:107]
  s_waitcnt lgkmcnt(5)
  v_mfma_f32_16x16x32_bf16 v[80:83], a[208:211], a[48:51], v[80:83]
  s_add_u32 s38, s38, 4096
  ds_read_b64_tr_b16 a[222:223], v255 offset:11776
  v_mfma_f32_16x16x32_bf16 v[88:91], a[208:211], a[52:55], v[88:91]
  v_mfma_f32_16x16x32_bf16 v[96:99], a[208:211], a[56:59], v[96:99]
  ds_read_b64_tr_b16 a[224:225], v255 offset:12288
  v_mfma_f32_16x16x32_bf16 v[104:107], a[208:211], a[60:63], v[104:107]
  s_waitcnt lgkmcnt(5)
  buffer_store_dwordx4 v[64:67], v14, s[24:27], s38 offen sc1
  v_mfma_f32_16x16x32_bf16 v[80:83], a[212:215], a[64:67], v[80:83]
  ds_read_b64_tr_b16 a[226:227], v255 offset:12800
  v_mfma_f32_16x16x32_bf16 v[88:91], a[212:215], a[68:71], v[88:91]
  v_mfma_f32_16x16x32_bf16 v[96:99], a[212:215], a[72:75], v[96:99]
  ds_read_b64_tr_b16 a[228:229], v255 offset:13312
  v_mfma_f32_16x16x32_bf16 v[104:107], a[212:215], a[76:79], v[104:107]
  s_waitcnt lgkmcnt(5)
  v_mfma_f32_16x16x32_bf16 v[80:83], a[216:219], a[80:83], v[80:83]
  ds_read_b64_tr_b16 a[230:231], v255 offset:13824
  v_mfma_f32_16x16x32_bf16 v[88:91], a[216:219], a[84:87], v[88:91]
  v_mfma_f32_16x16x32_bf16 v[96:99], a[216:219], a[88:91], v[96:99]
  ds_read_b64_tr_b16 a[232:233], v255 offset:14336
  v_mfma_f32_16x16x32_bf16 v[104:107], a[216:219], a[92:95], v[104:107]
  s_waitcnt lgkmcnt(5)
  v_mfma_f32_16x16x32_bf16 v[80:83], a[220:223], a[96:99], v[80:83]
  ds_read_b64_tr_b16 a[234:235], v255 offset:14848
  v_mfma_f32_16x16x32_bf16 v[88:91], a[220:223], a[100:103], v[88:91]
  v_mfma_f32_16x16x32_bf16 v[96:99], a[220:223], a[104:107], v[96:99]
  ds_read_b64_tr_b16 a[236:237], v255 offset:15360
  v_mfma_f32_16x16x32_bf16 v[104:107], a[220:223], a[108:111], v[104:107]
  s_waitcnt lgkmcnt(5)
  buffer_store_dwordx4 v[68:71], v14, s[24:27], s38 offen offset:1024 sc1
  v_mfma_f32_16x16x32_bf16 v[80:83], a[224:227], a[112:115], v[80:83]
  ds_read_b64_tr_b16 a[238:239], v255 offset:15872
  v_mfma_f32_16x16x32_bf16 v[88:91], a[224:227], a[116:119], v[88:91]
  v_mfma_f32_16x16x32_bf16 v[96:99], a[224:227], a[120:123], v[96:99]
  ds_read_b64_tr_b16 a[208:209], v255 offset:16384
  v_mfma_f32_16x16x32_bf16 v[104:107], a[224:227], a[124:127], v[104:107]
  s_waitcnt lgkmcnt(5)
  v_mfma_f32_16x16x32_bf16 v[80:83], a[228:231], a[128:131], v[80:83]
  ds_read_b64_tr_b16 a[210:211], v255 offset:16896
  v_mfma_f32_16x16x32_bf16 v[88:91], a[228:231], a[132:135], v[88:91]
  v_mfma_f32_16x16x32_bf16 v[96:99], a[228:231], a[136:139], v[96:99]
  ds_read_b64_tr_b16 a[212:213], v255 offset:17408
  v_mfma_f32_16x16x32_bf16 v[104:107], a[228:231], a[140:143], v[104:107]
  s_waitcnt lgkmcnt(5)
  v_mfma_f32_16x16x32_bf16 v[80:83], a[232:235], a[144:147], v[80:83]
  ds_read_b64_tr_b16 a[214:215], v255 offset:17920
  v_mfma_f32_16x16x32_bf16 v[88:91], a[232:235], a[148:151], v[88:91]
  v_mfma_f32_16x16x32_bf16 v[96:99], a[232:235], a[152:155], v[96:99]
  ds_read_b64_tr_b16 a[216:217], v255 offset:18432
  v_mfma_f32_16x16x32_bf16 v[104:107], a[232:235], a[156:159], v[104:107]
  s_waitcnt lgkmcnt(5)
  buffer_store_dwordx4 v[72:75], v14, s[24:27], s38 offen offset:2048 sc1
  v_mfma_f32_16x16x32_bf16 v[80:83], a[236:239], a[160:163], v[80:83]
  ds_read_b64_tr_b16 a[218:219], v255 offset:18944
  v_mfma_f32_16x16x32_bf16 v[88:91], a[236:239], a[164:167], v[88:91]
  v_mfma_f32_16x16x32_bf16 v[96:99], a[236:239], a[168:171], v[96:99]
  ds_read_b64_tr_b16 a[220:221], v255 offset:19456
  v_mfma_f32_16x16x32_bf16 v[104:107], a[236:239], a[172:175], v[104:107]
  s_waitcnt lgkmcnt(5)
  v_mfma_f32_16x16x32_bf16 v[80:83], a[208:211], a[176:179], v[80:83]
  ds_read_b64_tr_b16 a[222:223], v255 offset:19968
  v_mfma_f32_16x16x32_bf16 v[88:91], a[208:211], a[180:183], v[88:91]
  v_mfma_f32_16x16x32_bf16 v[96:99], a[208:211], a[184:187], v[96:99]
  ds_read_b64_tr_b16 a[224:225], v255 offset:20480
  v_mfma_f32_16x16x32_bf16 v[104:107], a[208:211], a[188:191], v[104:107]
  s_waitcnt lgkmcnt(5)
  v_mfma_f32_16x16x32_bf16 v[80:83], a[212:215], a[192:195], v[80:83]
  ds_read_b64_tr_b16 a[226:227], v255 offset:20992
  v_mfma_f32_16x16x32_bf16 v[88:91], a[212:215], a[196:199], v[88:91]
  v_mfma_f32_16x16x32_bf16 v[96:99], a[212:215], a[200:203], v[96:99]
  ds_read_b64_tr_b16 a[228:229], v255 offset:21504
  v_mfma_f32_16x16x32_bf16 v[104:107], a[212:215], a[204:207], v[104:107]
  s_waitcnt lgkmcnt(5)
  buffer_store_dwordx4 v[76:79], v14, s[24:27], s38 offen offset:3072 sc1
  v_mfma_f32_16x16x32_bf16 v[112:115], a[216:219], v[144:147], 0
  ds_read_b64_tr_b16 a[230:231], v255 offset:22016
  v_mfma_f32_16x16x32_bf16 v[120:123], a[216:219], v[148:151], 0
  v_mfma_f32_16x16x32_bf16 v[128:131], a[216:219], v[152:155], 0
  ds_read_b64_tr_b16 a[232:233], v255 offset:22528
  v_mfma_f32_16x16x32_bf16 v[136:139], a[216:219], v[156:159], 0
  s_waitcnt lgkmcnt(5)
  v_mfma_f32_16x16x32_bf16 v[112:115], a[220:223], v[160:163], v[112:115]
  ds_read_b64_tr_b16 a[234:235], v255 offset:23040
  v_mul_f32 v224, v80, v192
  v_mfma_f32_16x16x32_bf16 v[120:123], a[220:223], v[164:167], v[120:123]
  v_mul_f32 v225, v81, v192
  v_mul_f32 v226, v82, v192
  v_mfma_f32_16x16x32_bf16 v[128:131], a[220:223], v[168:171], v[128:131]
  ds_read_b64_tr_b16 a[236:237], v255 offset:23552
  v_mul_f32 v227, v83, v192
  v_mfma_f32_16x16x32_bf16 v[136:139], a[220:223], v[172:175], v[136:139]
  s_waitcnt lgkmcnt(5)
  v_exp_f32 v224, v224
  v_mfma_f32_16x16x32_bf16 v[112:115], a[224:227], v[176:179], v[112:115]
  ds_read_b64_tr_b16 a[238:239], v255 offset:24064
  v_fma_f32 v224, v224, v196, v196
  v_mfma_f32_16x16x32_bf16 v[120:123], a[224:227], v[180:183], v[120:123]
  v_exp_f32 v225, v225
  v_mfma_f32_16x16x32_bf16 v[128:131], a[224:227], v[184:187], v[128:131]
  ds_read_b64_tr_b16 a[208:209], v255 offset:24576
  v_fma_f32 v225, v225, v196, v196
  v_mfma_f32_16x16x32_bf16 v[136:139], a[224:227], v[188:191], v[136:139]
  s_waitcnt lgkmcnt(5)
  v_exp_f32 v226, v226
  v_mfma_f32_16x16x32_bf16 v[112:115], a[228:231], v[204:207], v[112:115]
  s_waitcnt vmcnt(4)
  v_cmp_gt_u32 vcc, 1, v220
  s_nop 0
  s_cmp_eq_u32 vcc_lo, 0
  s_cbranch_scc0 sequential_preLN__spectral_fnet__swiglu_ffn__prompt_kernel_spin1
sequential_preLN__spectral_fnet__swiglu_ffn__prompt_kernel_go1:
  ds_read_b64_tr_b16 a[210:211], v255 offset:25088
  v_mfma_f32_16x16x32_bf16 v[120:123], a[228:231], v[208:211], v[120:123]
  v_exp_f32 v227, v227
  v_mfma_f32_16x16x32_bf16 v[128:131], a[228:231], v[212:215], v[128:131]
  ds_read_b64_tr_b16 a[212:213], v255 offset:25600
  v_fma_f32 v226, v226, v196, v196
  v_mfma_f32_16x16x32_bf16 v[136:139], a[228:231], v[216:219], v[136:139]
  s_waitcnt lgkmcnt(5)
  v_fma_f32 v227, v227, v196, v196
  v_mfma_f32_16x16x32_bf16 v[112:115], a[232:235], v[232:235], v[112:115]
  ds_read_b64_tr_b16 a[214:215], v255 offset:26112
  v_mfma_f32_16x16x32_bf16 v[120:123], a[232:235], v[236:239], v[120:123]
  v_rcp_f32 v224, v224
  v_mfma_f32_16x16x32_bf16 v[128:131], a[232:235], v[240:243], v[128:131]
  ds_read_b64_tr_b16 a[216:217], v255 offset:26624
  v_mul_f32 v80, v80, v224
  v_mfma_f32_16x16x32_bf16 v[136:139], a[232:235], v[244:247], v[136:139]
  s_waitcnt lgkmcnt(5)
  v_rcp_f32 v225, v225
  v_mfma_f32_16x16x32_bf16 v[112:115], a[236:239], a[0:3], v[112:115]
  s_add_u32 s39, s79, 0
  ds_read_b64_tr_b16 a[218:219], v255 offset:27136
  v_mul_f32 v81, v81, v225
  v_mfma_f32_16x16x32_bf16 v[120:123], a[236:239], a[4:7], v[120:123]
  v_rcp_f32 v226, v226
  v_mfma_f32_16x16x32_bf16 v[128:131], a[236:239], a[8:11], v[128:131]
  ds_read_b64_tr_b16 a[220:221], v255 offset:27648
  buffer_load_dwordx4 a[0:3], v14, s[24:27], s39 offen sc1
  v_mfma_f32_16x16x32_bf16 v[136:139], a[236:239], a[12:15], v[136:139]
  s_waitcnt lgkmcnt(5)
  v_rcp_f32 v227, v227
  v_mfma_f32_16x16x32_bf16 v[112:115], a[208:211], a[16:19], v[112:115]
  ds_read_b64_tr_b16 a[222:223], v255 offset:28160
  v_mul_f32 v82, v82, v226
  v_mfma_f32_16x16x32_bf16 v[120:123], a[208:211], a[20:23], v[120:123]
  v_mul_f32 v83, v83, v227
  v_mul_f32 v228, v88, v193
  v_mfma_f32_16x16x32_bf16 v[128:131], a[208:211], a[24:27], v[128:131]
  ds_read_b64_tr_b16 a[224:225], v255 offset:28672
  v_mul_f32 v229, v89, v193
  v_mfma_f32_16x16x32_bf16 v[136:139], a[208:211], a[28:31], v[136:139]
  s_waitcnt lgkmcnt(5)
  v_mul_f32 v230, v90, v193
  v_mul_f32 v231, v91, v193
  v_mfma_f32_16x16x32_bf16 v[112:115], a[212:215], a[32:35], v[112:115]
  ds_read_b64_tr_b16 a[226:227], v255 offset:29184
  buffer_load_dwordx4 a[4:7], v14, s[24:27], s39 offen offset:1024 sc1
  v_mfma_f32_16x16x32_bf16 v[120:123], a[212:215], a[36:39], v[120:123]
  v_exp_f32 v228, v228
  v_mfma_f32_16x16x32_bf16 v[128:131], a[212:215], a[40:43], v[128:131]
  ds_read_b64_tr_b16 a[228:229], v255 offset:29696
  v_fma_f32 v228, v228, v197, v197
  v_mfma_f32_16x16x32_bf16 v[136:139], a[212:215], a[44:47], v[136:139]
  s_waitcnt lgkmcnt(5)
  v_exp_f32 v229, v229
  v_mfma_f32_16x16x32_bf16 v[112:115], a[216:219], a[48:51], v[112:115]
  ds_read_b64_tr_b16 a[230:231], v255 offset:30208
  v_fma_f32 v229, v229, v197, v197
  v_mfma_f32_16x16x32_bf16 v[120:123], a[216:219], a[52:55], v[120:123]
  v_exp_f32 v230, v230
  v_mfma_f32_16x16x32_bf16 v[128:131], a[216:219], a[56:59], v[128:131]
  ds_read_b64_tr_b16 a[232:233], v255 offset:30720
  v_fma_f32 v230, v230, v197, v197
  v_mfma_f32_16x16x32_bf16 v[136:139], a[216:219], a[60:63], v[136:139]
  s_waitcnt lgkmcnt(5)
  v_exp_f32 v231, v231
  v_mfma_f32_16x16x32_bf16 v[112:115], a[220:223], a[64:67], v[112:115]
  ds_read_b64_tr_b16 a[234:235], v255 offset:31232
  v_fma_f32 v231, v231, v197, v197
  v_mfma_f32_16x16x32_bf16 v[120:123], a[220:223], a[68:71], v[120:123]
  buffer_load_dwordx4 a[8:11], v14, s[24:27], s39 offen offset:2048 sc1
  v_mfma_f32_16x16x32_bf16 v[128:131], a[220:223], a[72:75], v[128:131]
  ds_read_b64_tr_b16 a[236:237], v255 offset:31744
  v_mfma_f32_16x16x32_bf16 v[136:139], a[220:223], a[76:79], v[136:139]
  s_waitcnt lgkmcnt(5)
  v_rcp_f32 v228, v228
  v_mfma_f32_16x16x32_bf16 v[112:115], a[224:227], a[80:83], v[112:115]
  ds_read_b64_tr_b16 a[238:239], v255 offset:32256
  v_mul_f32 v88, v88, v228
  v_mfma_f32_16x16x32_bf16 v[120:123], a[224:227], a[84:87], v[120:123]
  v_rcp_f32 v229, v229
  v_mfma_f32_16x16x32_bf16 v[128:131], a[224:227], a[88:91], v[128:131]
  ds_read_b64_tr_b16 a[208:209], v255 offset:32768
  buffer_load_dwordx4 a[12:15], v14, s[24:27], s39 offen offset:3072 sc1
  v_mfma_f32_16x16x32_bf16 v[136:139], a[224:227], a[92:95], v[136:139]
  s_waitcnt lgkmcnt(5)
  v_rcp_f32 v230, v230
  v_mfma_f32_16x16x32_bf16 v[112:115], a[228:231], a[96:99], v[112:115]
  ds_read_b64_tr_b16 a[210:211], v255 offset:33280
  v_mul_f32 v89, v89, v229
  v_mfma_f32_16x16x32_bf16 v[120:123], a[228:231], a[100:103], v[120:123]
  v_rcp_f32 v231, v231
  v_mfma_f32_16x16x32_bf16 v[128:131], a[228:231], a[104:107], v[128:131]
  ds_read_b64_tr_b16 a[212:213], v255 offset:33792
  v_mul_f32 v90, v90, v230
  v_mfma_f32_16x16x32_bf16 v[136:139], a[228:231], a[108:111], v[136:139]
  s_waitcnt lgkmcnt(5)
  v_mul_f32 v91, v91, v231
  v_mul_f32 v224, v96, v194
  v_mfma_f32_16x16x32_bf16 v[112:115], a[232:235], a[112:115], v[112:115]
  s_add_u32 s39, s80, 0
  ds_read_b64_tr_b16 a[214:215], v255 offset:34304
  v_mul_f32 v225, v97, v194
  v_mfma_f32_16x16x32_bf16 v[120:123], a[232:235], a[116:119], v[120:123]
  v_mul_f32 v226, v98, v194
  v_mul_f32 v227, v99, v194
  v_mfma_f32_16x16x32_bf16 v[128:131], a[232:235], a[120:123], v[128:131]
  ds_read_b64_tr_b16 a[216:217], v255 offset:34816
  buffer_load_dwordx4 a[16:19], v14, s[24:27], s39 offen sc1
  v_mfma_f32_16x16x32_bf16 v[136:139], a[232:235], a[124:127], v[136:139]
  s_waitcnt lgkmcnt(5)
  v_exp_f32 v224, v224
  v_mfma_f32_16x16x32_bf16 v[112:115], a[236:239], a[128:131], v[112:115]
  ds_read_b64_tr_b16 a[218:219], v255 offset:35328
  v_fma_f32 v224, v224, v198, v198
  v_mfma_f32_16x16x32_bf16 v[120:123], a[236:239], a[132:135], v[120:123]
  v_exp_f32 v225, v225
  v_mfma_f32_16x16x32_bf16 v[128:131], a[236:239], a[136:139], v[128:131]
  ds_read_b64_tr_b16 a[220:221], v255 offset:35840
  v_fma_f32 v225, v225, v198, v198
  v_mfma_f32_16x16x32_bf16 v[136:139], a[236:239], a[140:143], v[136:139]
  s_waitcnt lgkmcnt(5)
  v_exp_f32 v226, v226
  v_mfma_f32_16x16x32_bf16 v[112:115], a[208:211], a[144:147], v[112:115]
  ds_read_b64_tr_b16 a[222:223], v255 offset:36352
  buffer_load_dwordx4 a[20:23], v14, s[24:27], s39 offen offset:1024 sc1
  v_mfma_f32_16x16x32_bf16 v[120:123], a[208:211], a[148:151], v[120:123]
  v_exp_f32 v227, v227
  v_mfma_f32_16x16x32_bf16 v[128:131], a[208:211], a[152:155], v[128:131]
  v_fma_f32 v226, v226, v198, v198
  v_fma_f32 v227, v227, v198, v198
  v_mfma_f32_16x16x32_bf16 v[136:139], a[208:211], a[156:159], v[136:139]
  s_waitcnt lgkmcnt(4)
  v_rcp_f32 v224, v224
  v_mfma_f32_16x16x32_bf16 v[112:115], a[212:215], a[160:163], v[112:115]
  v_rcp_f32 v226, v226
  v_mfma_f32_16x16x32_bf16 v[120:123], a[212:215], a[164:167], v[120:123]
  v_rcp_f32 v225, v225
  v_mfma_f32_16x16x32_bf16 v[128:131], a[212:215], a[168:171], v[128:131]
  v_mul_f32 v96, v96, v224
  v_mul_f32 v97, v97, v225
  v_mfma_f32_16x16x32_bf16 v[136:139], a[212:215], a[172:175], v[136:139]
  s_waitcnt lgkmcnt(2)
  v_rcp_f32 v227, v227
  v_mfma_f32_16x16x32_bf16 v[112:115], a[216:219], a[176:179], v[112:115]
  s_waitcnt vmcnt(6) lgkmcnt(0)
  s_barrier
  ds_read_b64_tr_b16 a[224:225], v12 offset:0
  ds_read_b64_tr_b16 a[226:227], v12 offset:18432
  v_mfma_f32_16x16x32_bf16 v[120:123], a[216:219], a[180:183], v[120:123]
  buffer_load_dwordx4 a[24:27], v14, s[24:27], s39 offen offset:2048 sc1
  v_mul_f32 v98, v98, v226
  v_mfma_f32_16x16x32_bf16 v[128:131], a[216:219], a[184:187], v[128:131]
  ds_read_b64_tr_b16 a[228:229], v13 offset:0
  ds_read_b64_tr_b16 a[232:233], v12 offset:512
  v_mfma_f32_16x16x32_bf16 v[136:139], a[216:219], a[188:191], v[136:139]
  buffer_store_dword v253, v252, s[20:23], s29 offen sc1
  v_mul_f32 v99, v99, v227
  v_mfma_f32_16x16x32_bf16 v[112:115], a[220:223], a[192:195], v[112:115]
  ds_read_b64_tr_b16 a[230:231], v13 offset:18432
  v_mul_f32 v228, v104, v195
  v_mfma_f32_16x16x32_bf16 v[120:123], a[220:223], a[196:199], v[120:123]
  ds_read_b64_tr_b16 a[234:235], v12 offset:18944
  v_mul_f32 v229, v105, v195
  v_mfma_f32_16x16x32_bf16 v[128:131], a[220:223], a[200:203], v[128:131]
  ds_read_b64_tr_b16 a[236:237], v13 offset:512
  v_mul_f32 v230, v106, v195
  v_mfma_f32_16x16x32_bf16 v[136:139], a[220:223], a[204:207], v[136:139]
  s_waitcnt lgkmcnt(5)
  buffer_load_dwordx4 a[28:31], v14, s[24:27], s39 offen offset:3072 sc1
  v_mul_f32 v231, v107, v195
  v_mfma_f32_16x16x32_bf16 v[144:147], a[224:227], v[16:19], 0
  ds_read_b64_tr_b16 a[238:239], v13 offset:18944
  v_mfma_f32_16x16x32_bf16 v[148:151], a[224:227], v[20:23], 0
  v_exp_f32 v228, v228
  v_mfma_f32_16x16x32_bf16 v[152:155], a[224:227], v[24:27], 0
  ds_read_b64_tr_b16 a[208:209], v12 offset:1024
  v_fma_f32 v228, v228, v199, v199
  v_mfma_f32_16x16x32_bf16 v[156:159], a[224:227], v[28:31], 0
  s_waitcnt lgkmcnt(4)
  v_exp_f32 v229, v229
  v_mfma_f32_16x16x32_bf16 v[160:163], a[228:231], v[16:19], 0
  s_add_u32 s39, s81, 0
  ds_read_b64_tr_b16 a[210:211], v12 offset:19456
  v_fma_f32 v229, v229, v199, v199
  v_mfma_f32_16x16x32_bf16 v[164:167], a[228:231], v[20:23], 0
  v_mov_b32 v253, 3
  v_mfma_f32_16x16x32_bf16 v[168:171], a[228:231], v[24:27], 0
  ds_read_b64_tr_b16 a[212:213], v13 offset:1024
  buffer_load_dwordx4 a[32:35], v14, s[24:27], s39 offen sc1
  v_mfma_f32_16x16x32_bf16 v[172:175], a[228:231], v[28:31], 0
  s_waitcnt lgkmcnt(5)
  v_exp_f32 v230, v230
  v_mfma_f32_16x16x32_bf16 v[176:179], a[232:235], v[16:19], 0
  ds_read_b64_tr_b16 a[214:215], v13 offset:19456
  v_fma_f32 v230, v230, v199, v199
  v_mfma_f32_16x16x32_bf16 v[180:183], a[232:235], v[20:23], 0
  v_exp_f32 v231, v231
  v_mfma_f32_16x16x32_bf16 v[184:187], a[232:235], v[24:27], 0
  ds_read_b64_tr_b16 a[216:217], v12 offset:1536
  v_fma_f32 v231, v231, v199, v199
  v_mfma_f32_16x16x32_bf16 v[188:191], a[232:235], v[28:31], 0
  s_waitcnt lgkmcnt(5)
  v_rcp_f32 v228, v228
  v_mfma_f32_16x16x32_bf16 v[204:207], a[236:239], v[16:19], 0
  ds_read_b64_tr_b16 a[218:219], v12 offset:19968
  buffer_load_dwordx4 a[36:39], v14, s[24:27], s39 offen offset:1024 sc1
  v_mfma_f32_16x16x32_bf16 v[208:211], a[236:239], v[20:23], 0
  v_rcp_f32 v229, v229
  v_mfma_f32_16x16x32_bf16 v[212:215], a[236:239], v[24:27], 0
  ds_read_b64_tr_b16 a[220:221], v13 offset:1536
  v_mul_f32 v104, v104, v228
  v_mfma_f32_16x16x32_bf16 v[216:219], a[236:239], v[28:31], 0
  s_waitcnt lgkmcnt(5)
  v_rcp_f32 v230, v230
  v_mfma_f32_16x16x32_bf16 v[144:147], a[208:211], v[32:35], v[144:147]
  ds_read_b64_tr_b16 a[222:223], v13 offset:19968
  v_mul_f32 v105, v105, v229
  v_mfma_f32_16x16x32_bf16 v[148:151], a[208:211], v[36:39], v[148:151]
  v_rcp_f32 v231, v231
  v_mfma_f32_16x16x32_bf16 v[152:155], a[208:211], v[40:43], v[152:155]
  ds_read_b64_tr_b16 a[224:225], v12 offset:2048
  v_mul_f32 v106, v106, v230
  v_mfma_f32_16x16x32_bf16 v[156:159], a[208:211], v[44:47], v[156:159]
  s_waitcnt lgkmcnt(5)
  v_mul_f32 v107, v107, v231
  v_mul_f32 v80, v80, v112
  v_mfma_f32_16x16x32_bf16 v[160:163], a[212:215], v[32:35], v[160:163]
  ds_read_b64_tr_b16 a[226:227], v12 offset:20480
  v_mul_f32 v81, v81, v113
  v_mfma_f32_16x16x32_bf16 v[164:167], a[212:215], v[36:39], v[164:167]
  buffer_load_dwordx4 a[40:43], v14, s[24:27], s39 offen offset:2048 sc1
  v_mul_f32 v82, v82, v114
  v_mfma_f32_16x16x32_bf16 v[168:171], a[212:215], v[40:43], v[168:171]
  ds_read_b64_tr_b16 a[228:229], v13 offset:2048
  v_mul_f32 v83, v83, v115
  v_mfma_f32_16x16x32_bf16 v[172:175], a[212:215], v[44:47], v[172:175]
  s_waitcnt lgkmcnt(5)
  v_cvt_pk_bf16_f32 v112, v80, v81
  v_cvt_pk_bf16_f32 v113, v82, v83
  v_mfma_f32_16x16x32_bf16 v[176:179], a[216:219], v[32:35], v[176:179]
  ds_read_b64_tr_b16 a[230:231], v13 offset:20480
  v_accvgpr_write_b32 a240, v112
  v_mfma_f32_16x16x32_bf16 v[180:183], a[216:219], v[36:39], v[180:183]
  v_accvgpr_write_b32 a241, v113
  v_mul_f32 v88, v88, v120
  v_mfma_f32_16x16x32_bf16 v[184:187], a[216:219], v[40:43], v[184:187]
  ds_read_b64_tr_b16 a[232:233], v12 offset:2560
  v_mul_f32 v89, v89, v121
  v_mfma_f32_16x16x32_bf16 v[188:191], a[216:219], v[44:47], v[188:191]
  s_waitcnt lgkmcnt(5)
  buffer_load_dwordx4 a[44:47], v14, s[24:27], s39 offen offset:3072 sc1
  v_mul_f32 v90, v90, v122
  v_mfma_f32_16x16x32_bf16 v[204:207], a[220:223], v[32:35], v[204:207]
  ds_read_b64_tr_b16 a[234:235], v12 offset:20992
  v_mul_f32 v91, v91, v123
  v_mfma_f32_16x16x32_bf16 v[208:211], a[220:223], v[36:39], v[208:211]
  v_cvt_pk_bf16_f32 v120, v88, v89
  v_cvt_pk_bf16_f32 v121, v90, v91
  v_mfma_f32_16x16x32_bf16 v[212:215], a[220:223], v[40:43], v[212:215]
  ds_read_b64_tr_b16 a[236:237], v13 offset:2560
  v_accvgpr_write_b32 a244, v120
  v_mfma_f32_16x16x32_bf16 v[216:219], a[220:223], v[44:47], v[216:219]
  s_waitcnt lgkmcnt(5)
  v_accvgpr_write_b32 a245, v121
  v_mul_f32 v96, v96, v128
  v_mfma_f32_16x16x32_bf16 v[144:147], a[224:227], v[48:51], v[144:147]
  s_add_u32 s39, s79, 4096
  ds_read_b64_tr_b16 a[238:239], v13 offset:20992
  v_mul_f32 v97, v97, v129
  v_mfma_f32_16x16x32_bf16 v[148:151], a[224:227], v[52:55], v[148:151]
  v_mul_f32 v98, v98, v130
  v_mul_f32 v99, v99, v131
  v_mfma_f32_16x16x32_bf16 v[152:155], a[224:227], v[56:59], v[152:155]
  ds_read_b64_tr_b16 a[208:209], v12 offset:3072
  v_cvt_pk_bf16_f32 v128, v96, v97
  v_mfma_f32_16x16x32_bf16 v[156:159], a[224:227], v[60:63], v[156:159]
  s_waitcnt lgkmcnt(5)
  buffer_load_dwordx4 a[48:51], v14, s[24:27], s39 offen sc1
  v_cvt_pk_bf16_f32 v129, v98, v99
  v_mfma_f32_16x16x32_bf16 v[160:163], a[228:231], v[48:51], v[160:163]
  ds_read_b64_tr_b16 a[210:211], v12 offset:21504
  v_accvgpr_write_b32 a248, v128
  v_mfma_f32_16x16x32_bf16 v[164:167], a[228:231], v[52:55], v[164:167]
  v_accvgpr_write_b32 a249, v129
  v_mul_f32 v104, v104, v136
  v_mfma_f32_16x16x32_bf16 v[168:171], a[228:231], v[56:59], v[168:171]
  ds_read_b64_tr_b16 a[212:213], v13 offset:3072
  v_mul_f32 v105, v105, v137
  v_mfma_f32_16x16x32_bf16 v[172:175], a[228:231], v[60:63], v[172:175]
  s_waitcnt lgkmcnt(5)
  v_mul_f32 v106, v106, v138
  v_mul_f32 v107, v107, v139
  v_mfma_f32_16x16x32_bf16 v[176:179], a[232:235], v[48:51], v[176:179]
  ds_read_b64_tr_b16 a[214:215], v13 offset:21504
  v_cvt_pk_bf16_f32 v136, v104, v105
  v_mfma_f32_16x16x32_bf16 v[180:183], a[232:235], v[52:55], v[180:183]
  buffer_load_dwordx4 a[52:55], v14, s[24:27], s39 offen offset:1024 sc1
  v_cvt_pk_bf16_f32 v137, v106, v107
  v_accvgpr_write_b32 a252, v136
  v_accvgpr_write_b32 a253, v137
  v_mfma_f32_16x16x32_bf16 v[184:187], a[232:235], v[56:59], v[184:187]
  s_add_u32 s38, s38, 4096
  ds_read_b64_tr_b16 a[216:217], v12 offset:3584
  v_mfma_f32_16x16x32_bf16 v[188:191], a[232:235], v[60:63], v[188:191]
  s_waitcnt lgkmcnt(5)
  v_mfma_f32_16x16x32_bf16 v[204:207], a[236:239], v[48:51], v[204:207]
  ds_read_b64_tr_b16 a[218:219], v12 offset:22016
  v_mfma_f32_16x16x32_bf16 v[208:211], a[236:239], v[52:55], v[208:211]
  buffer_store_dwordx2 a[240:241], v255, s[24:27], s38 offen sc1
  v_mfma_f32_16x16x32_bf16 v[212:215], a[236:239], v[56:59], v[212:215]
  ds_read_b64_tr_b16 a[220:221], v13 offset:3584
  v_mfma_f32_16x16x32_bf16 v[216:219], a[236:239], v[60:63], v[216:219]
  s_waitcnt lgkmcnt(5)
  v_mfma_f32_16x16x32_bf16 v[144:147], a[208:211], v[64:67], v[144:147]
  ds_read_b64_tr_b16 a[222:223], v13 offset:22016
  buffer_store_dwordx2 a[244:245], v255, s[24:27], s38 offen offset:512 sc1
  v_mfma_f32_16x16x32_bf16 v[148:151], a[208:211], v[68:71], v[148:151]
  buffer_load_dwordx4 a[56:59], v14, s[24:27], s39 offen offset:2048 sc1
  v_mfma_f32_16x16x32_bf16 v[152:155], a[208:211], v[72:75], v[152:155]
  ds_read_b64_tr_b16 a[224:225], v12 offset:4096
  v_mfma_f32_16x16x32_bf16 v[156:159], a[208:211], v[76:79], v[156:159]
  s_waitcnt lgkmcnt(5)
  v_mfma_f32_16x16x32_bf16 v[160:163], a[212:215], v[64:67], v[160:163]
  ds_read_b64_tr_b16 a[226:227], v12 offset:22528
  v_mfma_f32_16x16x32_bf16 v[164:167], a[212:215], v[68:71], v[164:167]
  buffer_store_dwordx2 a[248:249], v255, s[24:27], s38 offen offset:1024 sc1
  v_mfma_f32_16x16x32_bf16 v[168:171], a[212:215], v[72:75], v[168:171]
  ds_read_b64_tr_b16 a[228:229], v13 offset:4096
  v_mfma_f32_16x16x32_bf16 v[172:175], a[212:215], v[76:79], v[172:175]
  s_waitcnt lgkmcnt(5)
  buffer_load_dwordx4 a[60:63], v14, s[24:27], s39 offen offset:3072 sc1
  v_mfma_f32_16x16x32_bf16 v[176:179], a[216:219], v[64:67], v[176:179]
  ds_read_b64_tr_b16 a[230:231], v13 offset:22528
  v_mfma_f32_16x16x32_bf16 v[180:183], a[216:219], v[68:71], v[180:183]
  buffer_store_dwordx2 a[252:253], v255, s[24:27], s38 offen offset:1536 sc1
  v_mfma_f32_16x16x32_bf16 v[184:187], a[216:219], v[72:75], v[184:187]
  ds_read_b64_tr_b16 a[232:233], v12 offset:4608
  v_mfma_f32_16x16x32_bf16 v[188:191], a[216:219], v[76:79], v[188:191]
  s_waitcnt lgkmcnt(5)
  v_mfma_f32_16x16x32_bf16 v[204:207], a[220:223], v[64:67], v[204:207]
  s_add_u32 s39, s80, 4096
  ds_read_b64_tr_b16 a[234:235], v12 offset:23040
  v_mfma_f32_16x16x32_bf16 v[208:211], a[220:223], v[68:71], v[208:211]
  v_mfma_f32_16x16x32_bf16 v[212:215], a[220:223], v[72:75], v[212:215]
  ds_read_b64_tr_b16 a[236:237], v13 offset:4608
  v_mfma_f32_16x16x32_bf16 v[216:219], a[220:223], v[76:79], v[216:219]
  s_waitcnt lgkmcnt(5)
  buffer_load_dwordx4 a[64:67], v14, s[24:27], s39 offen sc1
  s_waitcnt vmcnt(21)
  v_mfma_f32_16x16x32_bf16 v[144:147], a[224:227], a[0:3], v[144:147]
  ds_read_b64_tr_b16 a[238:239], v13 offset:23040
  s_waitcnt vmcnt(20)
  v_mfma_f32_16x16x32_bf16 v[148:151], a[224:227], a[4:7], v[148:151]
  buffer_load_dword v220, v254, s[20:23], s30 offen sc1
  s_waitcnt vmcnt(20)
  v_mfma_f32_16x16x32_bf16 v[152:155], a[224:227], a[8:11], v[152:155]
  ds_read_b64_tr_b16 a[208:209], v12 offset:5120
  s_waitcnt vmcnt(19)
  v_mfma_f32_16x16x32_bf16 v[156:159], a[224:227], a[12:15], v[156:159]
  s_waitcnt lgkmcnt(5)
  v_mfma_f32_16x16x32_bf16 v[160:163], a[228:231], a[0:3], v[160:163]
  ds_read_b64_tr_b16 a[210:211], v12 offset:23552
  v_mfma_f32_16x16x32_bf16 v[164:167], a[228:231], a[4:7], v[164:167]
  buffer_load_dwordx4 a[68:71], v14, s[24:27], s39 offen offset:1024 sc1
  v_mfma_f32_16x16x32_bf16 v[168:171], a[228:231], a[8:11], v[168:171]
  ds_read_b64_tr_b16 a[212:213], v13 offset:5120
  v_mfma_f32_16x16x32_bf16 v[172:175], a[228:231], a[12:15], v[172:175]
  s_waitcnt lgkmcnt(5)
  v_mfma_f32_16x16x32_bf16 v[176:179], a[232:235], a[0:3], v[176:179]
  ds_read_b64_tr_b16 a[214:215], v13 offset:23552
  v_mfma_f32_16x16x32_bf16 v[180:183], a[232:235], a[4:7], v[180:183]
  v_mfma_f32_16x16x32_bf16 v[184:187], a[232:235], a[8:11], v[184:187]
  ds_read_b64_tr_b16 a[216:217], v12 offset:5632
  v_mfma_f32_16x16x32_bf16 v[188:191], a[232:235], a[12:15], v[188:191]
  s_waitcnt lgkmcnt(5)
  v_mfma_f32_16x16x32_bf16 v[204:207], a[236:239], a[0:3], v[204:207]
  ds_read_b64_tr_b16 a[218:219], v12 offset:24064
  v_mfma_f32_16x16x32_bf16 v[208:211], a[236:239], a[4:7], v[208:211]
  buffer_load_dwordx4 a[72:75], v14, s[24:27], s39 offen offset:2048 sc1
  v_mfma_f32_16x16x32_bf16 v[212:215], a[236:239], a[8:11], v[212:215]
  ds_read_b64_tr_b16 a[220:221], v13 offset:5632
  v_mfma_f32_16x16x32_bf16 v[216:219], a[236:239], a[12:15], v[216:219]
  s_waitcnt lgkmcnt(5)
  s_waitcnt vmcnt(20)
  v_mfma_f32_16x16x32_bf16 v[144:147], a[208:211], a[16:19], v[144:147]
  ds_read_b64_tr_b16 a[222:223], v13 offset:24064
  s_waitcnt vmcnt(19)
  v_mfma_f32_16x16x32_bf16 v[148:151], a[208:211], a[20:23], v[148:151]
  s_waitcnt vmcnt(18)
  v_mfma_f32_16x16x32_bf16 v[152:155], a[208:211], a[24:27], v[152:155]
  ds_read_b64_tr_b16 a[224:225], v12 offset:6144
  s_waitcnt vmcnt(16)
  v_mfma_f32_16x16x32_bf16 v[156:159], a[208:211], a[28:31], v[156:159]
  s_waitcnt lgkmcnt(5)
  buffer_load_dwordx4 a[76:79], v14, s[24:27], s39 offen offset:3072 sc1
  v_mfma_f32_16x16x32_bf16 v[160:163], a[212:215], a[16:19], v[160:163]
  ds_read_b64_tr_b16 a[226:227], v12 offset:24576
  v_mfma_f32_16x16x32_bf16 v[164:167], a[212:215], a[20:23], v[164:167]
  v_mfma_f32_16x16x32_bf16 v[168:171], a[212:215], a[24:27], v[168:171]
  ds_read_b64_tr_b16 a[228:229], v13 offset:6144
  v_mfma_f32_16x16x32_bf16 v[172:175], a[212:215], a[28:31], v[172:175]
  s_waitcnt lgkmcnt(5)
  v_mfma_f32_16x16x32_bf16 v[176:179], a[216:219], a[16:19], v[176:179]
  s_add_u32 s39, s81, 4096
  ds_read_b64_tr_b16 a[230:231], v13 offset:24576
  v_mfma_f32_16x16x32_bf16 v[180:183], a[216:219], a[20:23], v[180:183]
  v_mfma_f32_16x16x32_bf16 v[184:187], a[216:219], a[24:27], v[184:187]
  ds_read_b64_tr_b16 a[232:233], v12 offset:6656
  v_mfma_f32_16x16x32_bf16 v[188:191], a[216:219], a[28:31], v[188:191]
  s_waitcnt lgkmcnt(5)
  buffer_load_dwordx4 a[80:83], v14, s[24:27], s39 offen sc1
  v_mfma_f32_16x16x32_bf16 v[204:207], a[220:223], a[16:19], v[204:207]
  ds_read_b64_tr_b16 a[234:235], v12 offset:25088
  v_mfma_f32_16x16x32_bf16 v[208:211], a[220:223], a[20:23], v[208:211]
  v_mfma_f32_16x16x32_bf16 v[212:215], a[220:223], a[24:27], v[212:215]
  ds_read_b64_tr_b16 a[236:237], v13 offset:6656
  v_mfma_f32_16x16x32_bf16 v[216:219], a[220:223], a[28:31], v[216:219]
  s_waitcnt lgkmcnt(5)
  s_waitcnt vmcnt(17)
  v_mfma_f32_16x16x32_bf16 v[144:147], a[224:227], a[32:35], v[144:147]
  ds_read_b64_tr_b16 a[238:239], v13 offset:25088
  s_waitcnt vmcnt(16)
  v_mfma_f32_16x16x32_bf16 v[148:151], a[224:227], a[36:39], v[148:151]
  buffer_load_dwordx4 a[84:87], v14, s[24:27], s39 offen offset:1024 sc1
  s_waitcnt vmcnt(16)
  v_mfma_f32_16x16x32_bf16 v[152:155], a[224:227], a[40:43], v[152:155]
  ds_read_b64_tr_b16 a[208:209], v12 offset:7168
  s_waitcnt vmcnt(15)
  v_mfma_f32_16x16x32_bf16 v[156:159], a[224:227], a[44:47], v[156:159]
  s_waitcnt lgkmcnt(5)
  v_mfma_f32_16x16x32_bf16 v[160:163], a[228:231], a[32:35], v[160:163]
  ds_read_b64_tr_b16 a[210:211], v12 offset:25600
  v_mfma_f32_16x16x32_bf16 v[164:167], a[228:231], a[36:39], v[164:167]
  v_mfma_f32_16x16x32_bf16 v[168:171], a[228:231], a[40:43], v[168:171]
  ds_read_b64_tr_b16 a[212:213], v13 offset:7168
  v_mfma_f32_16x16x32_bf16 v[172:175], a[228:231], a[44:47], v[172:175]
  s_waitcnt lgkmcnt(5)
  v_mfma_f32_16x16x32_bf16 v[176:179], a[232:235], a[32:35], v[176:179]
  ds_read_b64_tr_b16 a[214:215], v13 offset:25600
  v_mfma_f32_16x16x32_bf16 v[180:183], a[232:235], a[36:39], v[180:183]
  buffer_load_dwordx4 a[88:91], v14, s[24:27], s39 offen offset:2048 sc1
  v_mfma_f32_16x16x32_bf16 v[184:187], a[232:235], a[40:43], v[184:187]
  ds_read_b64_tr_b16 a[216:217], v12 offset:7680
  v_mfma_f32_16x16x32_bf16 v[188:191], a[232:235], a[44:47], v[188:191]
  s_waitcnt lgkmcnt(5)
  v_mfma_f32_16x16x32_bf16 v[204:207], a[236:239], a[32:35], v[204:207]
  ds_read_b64_tr_b16 a[218:219], v12 offset:26112
  v_mfma_f32_16x16x32_bf16 v[208:211], a[236:239], a[36:39], v[208:211]
  v_mfma_f32_16x16x32_bf16 v[212:215], a[236:239], a[40:43], v[212:215]
  ds_read_b64_tr_b16 a[220:221], v13 offset:7680
  v_mfma_f32_16x16x32_bf16 v[216:219], a[236:239], a[44:47], v[216:219]
  s_waitcnt lgkmcnt(5)
  buffer_load_dwordx4 a[92:95], v14, s[24:27], s39 offen offset:3072 sc1
  s_waitcnt vmcnt(16)
  v_mfma_f32_16x16x32_bf16 v[144:147], a[208:211], a[48:51], v[144:147]
  ds_read_b64_tr_b16 a[222:223], v13 offset:26112
  s_waitcnt vmcnt(15)
  v_mfma_f32_16x16x32_bf16 v[148:151], a[208:211], a[52:55], v[148:151]
  s_waitcnt vmcnt(12)
  v_mfma_f32_16x16x32_bf16 v[152:155], a[208:211], a[56:59], v[152:155]
  ds_read_b64_tr_b16 a[224:225], v12 offset:8192
  s_waitcnt vmcnt(10)
  v_mfma_f32_16x16x32_bf16 v[156:159], a[208:211], a[60:63], v[156:159]
  s_waitcnt lgkmcnt(5)
  v_mfma_f32_16x16x32_bf16 v[160:163], a[212:215], a[48:51], v[160:163]
  s_waitcnt vmcnt(7)
  v_cmp_gt_u32 vcc, 2, v220
  s_nop 0
  s_cmp_eq_u32 vcc_lo, 0
  s_cbranch_scc0 sequential_preLN__spectral_fnet__swiglu_ffn__prompt_kernel_spin2
sequential_preLN__spectral_fnet__swiglu_ffn__prompt_kernel_go2:
  v_mfma_f32_16x16x32_bf16 v[164:167], a[212:215], a[52:55], v[164:167]
  ds_read_b64_tr_b16 a[226:227], v12 offset:26624
  v_mfma_f32_16x16x32_bf16 v[168:171], a[212:215], a[56:59], v[168:171]
  ds_read_b64_tr_b16 a[228:229], v13 offset:8192
  v_mfma_f32_16x16x32_bf16 v[172:175], a[212:215], a[60:63], v[172:175]
  s_waitcnt lgkmcnt(5)
  v_mfma_f32_16x16x32_bf16 v[176:179], a[216:219], a[48:51], v[176:179]
  s_add_u32 s39, s79, 8192
  ds_read_b64_tr_b16 a[230:231], v13 offset:26624
  v_mfma_f32_16x16x32_bf16 v[180:183], a[216:219], a[52:55], v[180:183]
  v_mfma_f32_16x16x32_bf16 v[184:187], a[216:219], a[56:59], v[184:187]
  ds_read_b64_tr_b16 a[232:233], v12 offset:8704
  v_mfma_f32_16x16x32_bf16 v[188:191], a[216:219], a[60:63], v[188:191]
  s_waitcnt lgkmcnt(5)
  buffer_load_dwordx4 a[96:99], v14, s[24:27], s39 offen sc1
  v_mfma_f32_16x16x32_bf16 v[204:207], a[220:223], a[48:51], v[204:207]
  ds_read_b64_tr_b16 a[234:235], v12 offset:27136
  v_mfma_f32_16x16x32_bf16 v[208:211], a[220:223], a[52:55], v[208:211]
  v_mfma_f32_16x16x32_bf16 v[212:215], a[220:223], a[56:59], v[212:215]
  ds_read_b64_tr_b16 a[236:237], v13 offset:8704
  v_mfma_f32_16x16x32_bf16 v[216:219], a[220:223], a[60:63], v[216:219]
  s_waitcnt lgkmcnt(5)
  v_mfma_f32_16x16x32_bf16 v[144:147], a[224:227], a[64:67], v[144:147]
  ds_read_b64_tr_b16 a[238:239], v13 offset:27136
  s_waitcnt vmcnt(7)
  v_mfma_f32_16x16x32_bf16 v[148:151], a[224:227], a[68:71], v[148:151]
  buffer_load_dwordx4 a[100:103], v14, s[24:27], s39 offen offset:1024 sc1
  s_waitcnt vmcnt(7)
  v_mfma_f32_16x16x32_bf16 v[152:155], a[224:227], a[72:75], v[152:155]
  s_waitcnt vmcnt(6)
  v_mfma_f32_16x16x32_bf16 v[156:159], a[224:227], a[76:79], v[156:159]
  s_waitcnt lgkmcnt(4)
  v_mfma_f32_16x16x32_bf16 v[160:163], a[228:231], a[64:67], v[160:163]
  v_mfma_f32_16x16x32_bf16 v[164:167], a[228:231], a[68:71], v[164:167]
  v_mfma_f32_16x16x32_bf16 v[168:171], a[228:231], a[72:75], v[168:171]
  buffer_load_dwordx4 a[104:107], v14, s[24:27], s39 offen offset:2048 sc1
  v_mfma_f32_16x16x32_bf16 v[172:175], a[228:231], a[76:79], v[172:175]
  s_waitcnt lgkmcnt(2)
  v_mfma_f32_16x16x32_bf16 v[176:179], a[232:235], a[64:67], v[176:179]
  s_waitcnt lgkmcnt(0)
  s_barrier
  ds_read_b64_tr_b16 a[208:209], v10 offset:36864
  v_mfma_f32_16x16x32_bf16 v[180:183], a[232:235], a[68:71], v[180:183]
  ds_read_b64_tr_b16 a[210:211], v10 offset:55296
  v_mfma_f32_16x16x32_bf16 v[184:187], a[232:235], a[72:75], v[184:187]
  ds_read_b64_tr_b16 a[212:213], v10 offset:37888
  ds_read_b64_tr_b16 a[216:217], v10 offset:38912
  v_mfma_f32_16x16x32_bf16 v[188:191], a[232:235], a[76:79], v[188:191]
  buffer_store_dword v253, v252, s[20:23], s29 offen sc1
  v_mfma_f32_16x16x32_bf16 v[204:207], a[236:239], a[64:67], v[204:207]
  ds_read_b64_tr_b16 a[214:215], v10 offset:56320
  ds_read_b64_tr_b16 a[218:219], v10 offset:57344
  v_mfma_f32_16x16x32_bf16 v[208:211], a[236:239], a[68:71], v[208:211]
  buffer_load_dwordx4 a[108:111], v14, s[24:27], s39 offen offset:3072 sc1
  v_mfma_f32_16x16x32_bf16 v[212:215], a[236:239], a[72:75], v[212:215]
  ds_read_b64_tr_b16 a[220:221], v10 offset:39936
  v_mfma_f32_16x16x32_bf16 v[216:219], a[236:239], a[76:79], v[216:219]
  s_waitcnt lgkmcnt(5)
  v_mfma_f32_16x16x32_bf16 v[80:83], a[208:211], v[16:19], 0
  s_add_u32 s39, s80, 8192
  ds_read_b64_tr_b16 a[222:223], v10 offset:58368
  v_mfma_f32_16x16x32_bf16 v[84:87], a[208:211], v[20:23], 0
  v_mfma_f32_16x16x32_bf16 v[88:91], a[208:211], v[24:27], 0
  ds_read_b64_tr_b16 a[224:225], v10 offset:40960
  v_mfma_f32_16x16x32_bf16 v[92:95], a[208:211], v[28:31], 0
  s_waitcnt lgkmcnt(4)
  buffer_load_dwordx4 a[112:115], v14, s[24:27], s39 offen sc1
  v_mfma_f32_16x16x32_bf16 v[80:83], a[212:215], v[32:35], v[80:83]
  ds_read_b64_tr_b16 a[226:227], v10 offset:59392
  v_mfma_f32_16x16x32_bf16 v[84:87], a[212:215], v[36:39], v[84:87]
  v_mfma_f32_16x16x32_bf16 v[88:91], a[212:215], v[40:43], v[88:91]
  ds_read_b64_tr_b16 a[228:229], v10 offset:41984
  v_mfma_f32_16x16x32_bf16 v[92:95], a[212:215], v[44:47], v[92:95]
  s_waitcnt lgkmcnt(5)
  v_mfma_f32_16x16x32_bf16 v[80:83], a[216:219], v[48:51], v[80:83]
  s_and_b32 s31, s2, 7
  ds_read_b64_tr_b16 a[230:231], v10 offset:60416
  v_mfma_f32_16x16x32_bf16 v[84:87], a[216:219], v[52:55], v[84:87]
  s_lshr_b32 s33, s31, 1
  s_and_b32 s34, s31, 1
  s_and_b32 s3, s2, 0xf8
  v_mfma_f32_16x16x32_bf16 v[88:91], a[216:219], v[56:59], v[88:91]
  s_add_u32 s44, s3, 256
  ds_read_b64_tr_b16 a[232:233], v10 offset:43008
  v_mfma_f32_16x16x32_bf16 v[92:95], a[216:219], v[60:63], v[92:95]
  s_mul_i32 s44, s44, 73728
  buffer_load_dwordx4 a[116:119], v14, s[24:27], s39 offen offset:1024 sc1
  s_waitcnt lgkmcnt(5)
  v_mfma_f32_16x16x32_bf16 v[80:83], a[220:223], v[64:67], v[80:83]
  s_mul_i32 s12, s33, 18432
  ds_read_b64_tr_b16 a[234:235], v10 offset:61440
  v_mfma_f32_16x16x32_bf16 v[84:87], a[220:223], v[68:71], v[84:87]
  s_add_u32 s44, s44, s12
  v_mfma_f32_16x16x32_bf16 v[88:91], a[220:223], v[72:75], v[88:91]
  s_lshl_b32 s12, s34, 10
  ds_read_b64_tr_b16 a[236:237], v10 offset:44032
  v_mfma_f32_16x16x32_bf16 v[92:95], a[220:223], v[76:79], v[92:95]
  s_waitcnt lgkmcnt(5)
  v_mfma_f32_16x16x32_bf16 v[80:83], a[224:227], a[0:3], v[80:83]
  s_add_u32 s44, s44, s12
  ds_read_b64_tr_b16 a[238:239], v10 offset:62464
  v_mfma_f32_16x16x32_bf16 v[84:87], a[224:227], a[4:7], v[84:87]
  buffer_load_dwordx4 a[120:123], v14, s[24:27], s39 offen offset:2048 sc1
  v_mfma_f32_16x16x32_bf16 v[88:91], a[224:227], a[8:11], v[88:91]
  s_lshl_b32 s12, s28, 11
  ds_read_b64_tr_b16 a[208:209], v10 offset:45056
  v_mfma_f32_16x16x32_bf16 v[92:95], a[224:227], a[12:15], v[92:95]
  s_add_u32 s44, s44, s12
  s_waitcnt lgkmcnt(5)
  v_mfma_f32_16x16x32_bf16 v[80:83], a[228:231], a[16:19], v[80:83]
  s_lshl_b32 s13, s3, 7
  ds_read_b64_tr_b16 a[210:211], v10 offset:63488
  v_mfma_f32_16x16x32_bf16 v[84:87], a[228:231], a[20:23], v[84:87]
  v_mfma_f32_16x16x32_bf16 v[88:91], a[228:231], a[24:27], v[88:91]
  s_add_u32 s3, s29, 32
  ds_read_b64_tr_b16 a[212:213], v11 offset:36864
  v_mfma_f32_16x16x32_bf16 v[92:95], a[228:231], a[28:31], v[92:95]
  s_waitcnt lgkmcnt(5)
  buffer_load_dwordx4 a[124:127], v14, s[24:27], s39 offen offset:3072 sc1
  v_mfma_f32_16x16x32_bf16 v[80:83], a[232:235], a[32:35], v[80:83]
  s_add_u32 s12, s28, 1
  ds_read_b64_tr_b16 a[214:215], v11 offset:55296
  v_mfma_f32_16x16x32_bf16 v[84:87], a[232:235], a[36:39], v[84:87]
  s_lshr_b32 s12, s12, 2
  v_mfma_f32_16x16x32_bf16 v[88:91], a[232:235], a[40:43], v[88:91]
  s_add_u32 s39, s81, 8192
  ds_read_b64_tr_b16 a[216:217], v11 offset:37888
  s_lshl_b32 s12, s12, 29
  v_mfma_f32_16x16x32_bf16 v[92:95], a[232:235], a[44:47], v[92:95]
  s_waitcnt lgkmcnt(5)
  v_mfma_f32_16x16x32_bf16 v[80:83], a[236:239], a[48:51], v[80:83]
  ds_read_b64_tr_b16 a[218:219], v11 offset:56320
  v_add_u32 v200, s12, v14
  v_mfma_f32_16x16x32_bf16 v[84:87], a[236:239], a[52:55], v[84:87]
  buffer_load_dwordx4 a[128:131], v14, s[24:27], s39 offen sc1
  v_mfma_f32_16x16x32_bf16 v[88:91], a[236:239], a[56:59], v[88:91]
  ds_read_b64_tr_b16 a[220:221], v11 offset:38912
  v_add_u32 v201, 6144, v200
  v_mfma_f32_16x16x32_bf16 v[92:95], a[236:239], a[60:63], v[92:95]
  s_waitcnt lgkmcnt(5)
  v_mfma_f32_16x16x32_bf16 v[80:83], a[208:211], a[64:67], v[80:83]
  ds_read_b64_tr_b16 a[222:223], v11 offset:57344
  v_add_u32 v202, 12288, v200
  v_mfma_f32_16x16x32_bf16 v[84:87], a[208:211], a[68:71], v[84:87]
  v_and_b32 v203, 7, v1
  v_mfma_f32_16x16x32_bf16 v[88:91], a[208:211], a[72:75], v[88:91]
  ds_read_b64_tr_b16 a[224:225], v11 offset:39936
  v_lshlrev_b32 v203, 2, v203
  v_mfma_f32_16x16x32_bf16 v[92:95], a[208:211], a[76:79], v[92:95]
  s_waitcnt lgkmcnt(5)
  buffer_load_dwordx4 a[132:135], v14, s[24:27], s39 offen offset:1024 sc1
  v_and_b32 v15, 31, v1
  v_mfma_f32_16x16x32_bf16 v[96:99], a[212:215], v[16:19], 0
  ds_read_b64_tr_b16 a[226:227], v11 offset:58368
  v_mfma_f32_16x16x32_bf16 v[100:103], a[212:215], v[20:23], 0
  v_mfma_f32_16x16x32_bf16 v[104:107], a[212:215], v[24:27], 0
  ds_read_b64_tr_b16 a[228:229], v11 offset:40960
  v_lshrrev_b32 v251, 5, v1
  v_mfma_f32_16x16x32_bf16 v[108:111], a[212:215], v[28:31], 0
  s_waitcnt lgkmcnt(5)
  v_lshlrev_b32 v198, 2, v15
  v_mfma_f32_16x16x32_bf16 v[96:99], a[216:219], v[32:35], v[96:99]
  s_mov_b32 s12, 73728
  ds_read_b64_tr_b16 a[230:231], v11 offset:59392
  v_mfma_f32_16x16x32_bf16 v[100:103], a[216:219], v[36:39], v[100:103]
  v_mul_lo_u32 v197, v15, s12
  v_mfma_f32_16x16x32_bf16 v[104:107], a[216:219], v[40:43], v[104:107]
  ds_read_b64_tr_b16 a[232:233], v11 offset:41984
  v_mfma_f32_16x16x32_bf16 v[108:111], a[216:219], v[44:47], v[108:111]
  s_waitcnt lgkmcnt(5)
  buffer_load_dwordx4 a[136:139], v14, s[24:27], s39 offen offset:2048 sc1
  v_mfma_f32_16x16x32_bf16 v[96:99], a[220:223], v[48:51], v[96:99]
  ds_read_b64_tr_b16 a[234:235], v11 offset:60416
  v_lshl_add_u32 v197, v251, 4, v197
  v_mfma_f32_16x16x32_bf16 v[100:103], a[220:223], v[52:55], v[100:103]
  s_lshl_b32 s12, s28, 1
  v_mfma_f32_16x16x32_bf16 v[104:107], a[220:223], v[56:59], v[104:107]
  s_add_u32 s12, s12, 0
  ds_read_b64_tr_b16 a[236:237], v11 offset:43008
  v_mfma_f32_16x16x32_bf16 v[108:111], a[220:223], v[60:63], v[108:111]
  s_xor_b32 s12, s12, s31
  s_waitcnt lgkmcnt(5)
  v_mfma_f32_16x16x32_bf16 v[96:99], a[224:227], v[64:67], v[96:99]
  ds_read_b64_tr_b16 a[238:239], v11 offset:61440
  v_mfma_f32_16x16x32_bf16 v[100:103], a[224:227], v[68:71], v[100:103]
  buffer_load_dwordx4 a[140:143], v14, s[24:27], s39 offen offset:3072 sc1
  v_mfma_f32_16x16x32_bf16 v[104:107], a[224:227], v[72:75], v[104:107]
  s_min_u32 s12, s12, 1
  ds_read_b64_tr_b16 a[208:209], v11 offset:44032
  v_mfma_f32_16x16x32_bf16 v[108:111], a[224:227], v[76:79], v[108:111]
  s_xor_b32 s12, s12, 1
  s_waitcnt lgkmcnt(5)
  v_mfma_f32_16x16x32_bf16 v[96:99], a[228:231], a[0:3], v[96:99]
  s_add_u32 s39, s79, 12288
  ds_read_b64_tr_b16 a[210:211], v11 offset:62464
  s_lshl_b32 s12, s12, 30
  v_mfma_f32_16x16x32_bf16 v[100:103], a[228:231], a[4:7], v[100:103]
  v_mfma_f32_16x16x32_bf16 v[104:107], a[228:231], a[8:11], v[104:107]
  ds_read_b64_tr_b16 a[212:213], v11 offset:45056
  v_add_u32 v4, s12, v14
  v_mfma_f32_16x16x32_bf16 v[108:111], a[228:231], a[12:15], v[108:111]
  s_waitcnt lgkmcnt(5)
  buffer_load_dwordx4 a[144:147], v14, s[24:27], s39 offen sc1
  v_mfma_f32_16x16x32_bf16 v[96:99], a[232:235], a[16:19], v[96:99]
  s_lshl_b32 s12, s28, 1
  ds_read_b64_tr_b16 a[214:215], v11 offset:63488
  v_mfma_f32_16x16x32_bf16 v[100:103], a[232:235], a[20:23], v[100:103]
  s_add_u32 s12, s12, 1
  v_mfma_f32_16x16x32_bf16 v[104:107], a[232:235], a[24:27], v[104:107]
  s_xor_b32 s12, s12, s31
  ds_read_b64_tr_b16 a[216:217], v10 offset:37376
  v_mfma_f32_16x16x32_bf16 v[108:111], a[232:235], a[28:31], v[108:111]
  s_waitcnt lgkmcnt(5)
  v_mfma_f32_16x16x32_bf16 v[96:99], a[236:239], a[32:35], v[96:99]
  s_min_u32 s12, s12, 1
  ds_read_b64_tr_b16 a[218:219], v10 offset:55808
  v_mfma_f32_16x16x32_bf16 v[100:103], a[236:239], a[36:39], v[100:103]
  buffer_load_dwordx4 a[148:151], v14, s[24:27], s39 offen offset:1024 sc1
  v_mfma_f32_16x16x32_bf16 v[104:107], a[236:239], a[40:43], v[104:107]
  s_xor_b32 s12, s12, 1
  ds_read_b64_tr_b16 a[220:221], v10 offset:38400
  v_mfma_f32_16x16x32_bf16 v[108:111], a[236:239], a[44:47], v[108:111]
  s_lshl_b32 s12, s12, 30
  s_waitcnt lgkmcnt(5)
  v_mfma_f32_16x16x32_bf16 v[96:99], a[208:211], a[48:51], v[96:99]
  ds_read_b64_tr_b16 a[222:223], v10 offset:56832
  v_add_u32 v5, s12, v14
  v_mfma_f32_16x16x32_bf16 v[100:103], a[208:211], a[52:55], v[100:103]
  v_mfma_f32_16x16x32_bf16 v[104:107], a[208:211], a[56:59], v[104:107]
  s_waitcnt lgkmcnt(4)
  ds_read_b64_tr_b16 a[224:225], v10 offset:39424
  v_add_u32 v6, 148480, v14
  v_mfma_f32_16x16x32_bf16 v[108:111], a[208:211], a[60:63], v[108:111]
  s_lshl_b32 s12, s28, 10
  buffer_load_dwordx4 a[152:155], v14, s[24:27], s39 offen offset:2048 sc1
  v_mfma_f32_16x16x32_bf16 v[96:99], a[212:215], a[64:67], v[96:99]
  ds_read_b64_tr_b16 a[226:227], v10 offset:57856
  v_mfma_f32_16x16x32_bf16 v[100:103], a[212:215], a[68:71], v[100:103]
  v_mfma_f32_16x16x32_bf16 v[104:107], a[212:215], a[72:75], v[104:107]
  ds_read_b64_tr_b16 a[228:229], v10 offset:40448
  v_add_u32 v2, s12, v6
  v_mfma_f32_16x16x32_bf16 v[108:111], a[212:215], a[76:79], v[108:111]
  s_waitcnt lgkmcnt(5)
  v_mov_b32 v250, 147456
  v_mfma_f32_16x16x32_bf16 v[112:115], a[216:219], v[16:19], 0
  s_lshl_b32 s12, 1, s31
  ds_read_b64_tr_b16 a[230:231], v10 offset:58880
  v_mfma_f32_16x16x32_bf16 v[116:119], a[216:219], v[20:23], 0
  v_mov_b32 v251, s12
  v_mfma_f32_16x16x32_bf16 v[120:123], a[216:219], v[24:27], 0
  ds_read_b64_tr_b16 a[232:233], v10 offset:41472
  v_mfma_f32_16x16x32_bf16 v[124:127], a[216:219], v[28:31], 0
  s_waitcnt lgkmcnt(5)
  buffer_load_dwordx4 a[156:159], v14, s[24:27], s39 offen offset:3072 sc1
  v_mfma_f32_16x16x32_bf16 v[112:115], a[220:223], v[32:35], v[112:115]
  ds_read_b64_tr_b16 a[234:235], v10 offset:59904
  ds_write_b32 v250, v251
  v_mfma_f32_16x16x32_bf16 v[116:119], a[220:223], v[36:39], v[116:119]
  s_lshr_b32 s47, s2, 5
  v_mfma_f32_16x16x32_bf16 v[120:123], a[220:223], v[40:43], v[120:123]
  s_add_u32 s39, s80, 12288
  ds_read_b64_tr_b16 a[236:237], v10 offset:42496
  s_lshl_b32 s47, s47, 3
  v_mfma_f32_16x16x32_bf16 v[124:127], a[220:223], v[44:47], v[124:127]
  s_waitcnt lgkmcnt(6)
  v_mfma_f32_16x16x32_bf16 v[112:115], a[224:227], v[48:51], v[112:115]
  ds_read_b64_tr_b16 a[238:239], v10 offset:60928
  v_mfma_f32_16x16x32_bf16 v[116:119], a[224:227], v[52:55], v[116:119]
  buffer_load_dwordx4 a[160:163], v14, s[24:27], s39 offen sc1
  v_mfma_f32_16x16x32_bf16 v[120:123], a[224:227], v[56:59], v[120:123]
  s_add_u32 s47, s47, s31
  ds_read_b64_tr_b16 a[208:209], v10 offset:43520
  s_lshl_b32 s12, s95, 3
  v_mfma_f32_16x16x32_bf16 v[124:127], a[224:227], v[60:63], v[124:127]
  s_waitcnt lgkmcnt(6)
  v_mfma_f32_16x16x32_bf16 v[112:115], a[228:231], v[64:67], v[112:115]
  s_add_u32 s12, s12, s28
  ds_read_b64_tr_b16 a[210:211], v10 offset:61952
  v_mfma_f32_16x16x32_bf16 v[116:119], a[228:231], v[68:71], v[116:119]
  buffer_load_dword v220, v254, s[20:23], s30 offen sc1
  v_mfma_f32_16x16x32_bf16 v[120:123], a[228:231], v[72:75], v[120:123]
  s_add_u32 s5, s12, 2
  ds_read_b64_tr_b16 a[212:213], v10 offset:44544
  v_mfma_f32_16x16x32_bf16 v[124:127], a[228:231], v[76:79], v[124:127]
  s_waitcnt lgkmcnt(6)
  buffer_load_dwordx4 a[164:167], v14, s[24:27], s39 offen offset:1024 sc1
  v_mfma_f32_16x16x32_bf16 v[112:115], a[232:235], a[0:3], v[112:115]
  s_add_u32 s6, s12, 5
  ds_read_b64_tr_b16 a[214:215], v10 offset:62976
  s_sub_u32 s4, s12, 1
  v_mfma_f32_16x16x32_bf16 v[116:119], a[232:235], a[4:7], v[116:119]
  v_mfma_f32_16x16x32_bf16 v[120:123], a[232:235], a[8:11], v[120:123]
  s_mul_i32 s7, s95, 7
  ds_read_b64_tr_b16 a[216:217], v10 offset:45568
  v_mfma_f32_16x16x32_bf16 v[124:127], a[232:235], a[12:15], v[124:127]
  s_waitcnt lgkmcnt(5)
  v_mfma_f32_16x16x32_bf16 v[112:115], a[236:239], a[16:19], v[112:115]
  s_sub_u32 s7, 33, s7
  ds_read_b64_tr_b16 a[218:219], v10 offset:64000
  v_mfma_f32_16x16x32_bf16 v[116:119], a[236:239], a[20:23], v[116:119]
  buffer_load_dwordx4 a[168:171], v14, s[24:27], s39 offen offset:2048 sc1
  v_mfma_f32_16x16x32_bf16 v[120:123], a[236:239], a[24:27], v[120:123]
  s_min_u32 s12, s28, 1
  ds_read_b64_tr_b16 a[220:221], v11 offset:37376
  v_mfma_f32_16x16x32_bf16 v[124:127], a[236:239], a[28:31], v[124:127]
  s_waitcnt lgkmcnt(5)
  v_mfma_f32_16x16x32_bf16 v[112:115], a[208:211], a[32:35], v[112:115]
  s_add_u32 m0, s32, 0
  ds_read_b64_tr_b16 a[222:223], v11 offset:55808
  s_sub_u32 s12, 1, s12
  v_mfma_f32_16x16x32_bf16 v[116:119], a[208:211], a[36:39], v[116:119]
  v_mfma_f32_16x16x32_bf16 v[120:123], a[208:211], a[40:43], v[120:123]
  s_add_u32 s41, s71, 36864
  ds_read_b64_tr_b16 a[224:225], v11 offset:38400
  s_mul_i32 s7, s7, s12
  v_mfma_f32_16x16x32_bf16 v[124:127], a[208:211], a[44:47], v[124:127]
  s_add_u32 s4, s4, s7
  buffer_load_dwordx4 a[172:175], v14, s[24:27], s39 offen offset:3072 sc1
  s_waitcnt lgkmcnt(5)
  v_mfma_f32_16x16x32_bf16 v[112:115], a[212:215], a[48:51], v[112:115]
  ds_read_b64_tr_b16 a[226:227], v11 offset:56832
  v_mfma_f32_16x16x32_bf16 v[116:119], a[212:215], a[52:55], v[116:119]
  buffer_load_dwordx4 v248, s[16:19], s41 offen lds
  v_mfma_f32_16x16x32_bf16 v[120:123], a[212:215], a[56:59], v[120:123]
  s_add_u32 m0, s32, 1024
  ds_read_b64_tr_b16 a[228:229], v11 offset:39424
  s_mul_i32 s46, s47, 36864
  v_mfma_f32_16x16x32_bf16 v[124:127], a[212:215], a[60:63], v[124:127]
  s_waitcnt lgkmcnt(5)
  v_mfma_f32_16x16x32_bf16 v[112:115], a[216:219], a[64:67], v[112:115]
  s_add_u32 s41, s69, 73728
  ds_read_b64_tr_b16 a[230:231], v11 offset:57856
  s_add_u32 s46, s46, 2424832
  s_lshl_b32 s12, s4, 10
  v_mfma_f32_16x16x32_bf16 v[116:119], a[216:219], a[68:71], v[116:119]
  s_add_u32 s39, s81, 12288
  v_mfma_f32_16x16x32_bf16 v[120:123], a[216:219], a[72:75], v[120:123]
  ds_read_b64_tr_b16 a[232:233], v11 offset:40448
  buffer_load_dwordx4 v248, s[16:19], s41 offen lds
  v_mfma_f32_16x16x32_bf16 v[124:127], a[216:219], a[76:79], v[124:127]
  s_waitcnt lgkmcnt(5)
  buffer_load_dwordx4 a[176:179], v14, s[24:27], s39 offen sc1
  v_mfma_f32_16x16x32_bf16 v[128:131], a[220:223], v[16:19], 0
  s_add_u32 m0, s32, 2048
  ds_read_b64_tr_b16 a[234:235], v11 offset:58880
  s_add_u32 s12, s12, s46
  v_mfma_f32_16x16x32_bf16 v[132:135], a[220:223], v[20:23], 0
  v_mfma_f32_16x16x32_bf16 v[136:139], a[220:223], v[24:27], 0
  s_add_u32 s41, s70, 73728
  ds_read_b64_tr_b16 a[236:237], v11 offset:41472
  buffer_load_dwordx4 v[224:227], v14, s[20:23], s12 offen sc1
  v_mfma_f32_16x16x32_bf16 v[140:143], a[220:223], v[28:31], 0
  s_lshl_b32 s12, s5, 10
  s_waitcnt lgkmcnt(5)
  v_mfma_f32_16x16x32_bf16 v[128:131], a[224:227], v[32:35], v[128:131]
  ds_read_b64_tr_b16 a[238:239], v11 offset:59904
  buffer_load_dwordx4 v248, s[16:19], s41 offen lds
  v_mfma_f32_16x16x32_bf16 v[132:135], a[224:227], v[36:39], v[132:135]
  buffer_load_dwordx4 a[180:183], v14, s[24:27], s39 offen offset:1024 sc1
  v_mfma_f32_16x16x32_bf16 v[136:139], a[224:227], v[40:43], v[136:139]
  s_add_u32 m0, s32, 3072
  ds_read_b64_tr_b16 a[208:209], v11 offset:42496
  s_add_u32 s12, s12, s46
  v_mfma_f32_16x16x32_bf16 v[140:143], a[224:227], v[44:47], v[140:143]
  s_waitcnt lgkmcnt(5)
  v_mfma_f32_16x16x32_bf16 v[128:131], a[228:231], v[48:51], v[128:131]
  s_add_u32 s41, s71, 73728
  ds_read_b64_tr_b16 a[210:211], v11 offset:60928
  buffer_load_dwordx4 v[228:231], v14, s[20:23], s12 offen sc1
  v_mfma_f32_16x16x32_bf16 v[132:135], a[228:231], v[52:55], v[132:135]
  s_lshl_b32 s12, s6, 10
  v_mfma_f32_16x16x32_bf16 v[136:139], a[228:231], v[56:59], v[136:139]
  ds_read_b64_tr_b16 a[212:213], v11 offset:43520
  buffer_load_dwordx4 v248, s[16:19], s41 offen lds
  v_mfma_f32_16x16x32_bf16 v[140:143], a[228:231], v[60:63], v[140:143]
  s_waitcnt lgkmcnt(5)
  buffer_load_dwordx4 a[184:187], v14, s[24:27], s39 offen offset:2048 sc1
  v_mfma_f32_16x16x32_bf16 v[128:131], a[232:235], v[64:67], v[128:131]
  s_add_u32 m0, s32, 4096
  ds_read_b64_tr_b16 a[214:215], v11 offset:61952
  s_add_u32 s12, s12, s46
  v_mfma_f32_16x16x32_bf16 v[132:135], a[232:235], v[68:71], v[132:135]
  v_mfma_f32_16x16x32_bf16 v[136:139], a[232:235], v[72:75], v[136:139]
  s_add_u32 s41, s69, 110592
  ds_read_b64_tr_b16 a[216:217], v11 offset:44544
  buffer_load_dwordx4 v[192:195], v14, s[20:23], s12 offen sc1
  v_mfma_f32_16x16x32_bf16 v[140:143], a[232:235], v[76:79], v[140:143]
  s_waitcnt lgkmcnt(5)
  v_mfma_f32_16x16x32_bf16 v[128:131], a[236:239], a[0:3], v[128:131]
  ds_read_b64_tr_b16 a[218:219], v11 offset:62976
  buffer_load_dwordx4 v248, s[16:19], s41 offen lds
  v_mfma_f32_16x16x32_bf16 v[132:135], a[236:239], a[4:7], v[132:135]
  s_lshl_b32 s7, s47, 7
  buffer_load_dwordx4 a[188:191], v14, s[24:27], s39 offen offset:3072 sc1
  v_mfma_f32_16x16x32_bf16 v[136:139], a[236:239], a[8:11], v[136:139]
  s_add_u32 m0, s32, 5120
  ds_read_b64_tr_b16 a[220:221], v11 offset:45568
  s_add_u32 s7, s7, 7151616
  s_mul_i32 s47, s47, 1152
  v_mfma_f32_16x16x32_bf16 v[140:143], a[236:239], a[12:15], v[140:143]
  s_waitcnt lgkmcnt(5)
  buffer_load_dword v199, v198, s[20:23], s7 offen sc1
  v_mfma_f32_16x16x32_bf16 v[128:131], a[208:211], a[16:19], v[128:131]
  s_add_u32 s41, s70, 110592
  ds_read_b64_tr_b16 a[222:223], v11 offset:64000
  v_mfma_f32_16x16x32_bf16 v[132:135], a[208:211], a[20:23], v[132:135]
  v_mfma_f32_16x16x32_bf16 v[136:139], a[208:211], a[24:27], v[136:139]
  buffer_load_dwordx4 v248, s[16:19], s41 offen lds
  v_mfma_f32_16x16x32_bf16 v[140:143], a[208:211], a[28:31], v[140:143]
  s_waitcnt lgkmcnt(4)
  v_mfma_f32_16x16x32_bf16 v[128:131], a[212:215], a[32:35], v[128:131]
  s_add_u32 m0, s32, 6144
  v_mfma_f32_16x16x32_bf16 v[132:135], a[212:215], a[36:39], v[132:135]
  s_load_dwordx2 s[14:15], s[0:1], 72
  v_mfma_f32_16x16x32_bf16 v[136:139], a[212:215], a[40:43], v[136:139]
  s_add_u32 s41, s71, 110592
  v_mfma_f32_16x16x32_bf16 v[140:143], a[212:215], a[44:47], v[140:143]
  s_waitcnt lgkmcnt(0)
  v_mfma_f32_16x16x32_bf16 v[128:131], a[216:219], a[48:51], v[128:131]
  s_barrier
  s_waitcnt vmcnt(17)
  v_cmp_gt_u32 vcc, 3, v220
  s_nop 0
  s_cmp_eq_u32 vcc_lo, 0
  s_cbranch_scc0 sequential_preLN__spectral_fnet__swiglu_ffn__prompt_kernel_spin3
sequential_preLN__spectral_fnet__swiglu_ffn__prompt_kernel_go3:
  ds_read_b64_tr_b16 a[224:225], v7 offset:0
  ds_read_b64_tr_b16 a[226:227], v7 offset:512
  v_mfma_f32_16x16x32_bf16 v[132:135], a[216:219], a[52:55], v[132:135]
  buffer_load_dwordx4 v248, s[16:19], s41 offen lds
  v_mfma_f32_16x16x32_bf16 v[136:139], a[216:219], a[56:59], v[136:139]
  s_add_u32 m0, s32, 7168
  ds_read_b64_tr_b16 a[228:229], v7 offset:1024
  v_mfma_f32_16x16x32_bf16 v[140:143], a[216:219], a[60:63], v[140:143]
  ds_read_b64_tr_b16 a[232:233], v7 offset:2048
  v_mfma_f32_16x16x32_bf16 v[128:131], a[220:223], a[64:67], v[128:131]
  s_add_u32 s41, s72, 0
  ds_read_b64_tr_b16 a[230:231], v7 offset:1536
  v_mfma_f32_16x16x32_bf16 v[132:135], a[220:223], a[68:71], v[132:135]
  s_add_u32 s39, s79, 16384
  ds_read_b64_tr_b16 a[234:235], v7 offset:2560
  v_mfma_f32_16x16x32_bf16 v[136:139], a[220:223], a[72:75], v[136:139]
  ds_read_b64_tr_b16 a[236:237], v7 offset:3072
  buffer_load_dwordx4 v248, s[16:19], s41 offen lds
  v_mfma_f32_16x16x32_bf16 v[140:143], a[220:223], a[76:79], v[140:143]
  s_waitcnt lgkmcnt(5)
  buffer_load_dwordx2 a[242:243], v255, s[24:27], s39 offen sc1
  v_mfma_f32_16x16x32_bf16 v[232:235], a[224:227], v[16:19], 0
  s_add_u32 m0, s32, 8192
  ds_read_b64_tr_b16 a[238:239], v7 offset:3584
  v_mfma_f32_16x16x32_bf16 v[236:239], a[224:227], v[20:23], 0
  v_mfma_f32_16x16x32_bf16 v[240:243], a[224:227], v[24:27], 0
  s_add_u32 s41, s73, 0
  ds_read_b64_tr_b16 a[208:209], v7 offset:4096
  v_mfma_f32_16x16x32_bf16 v[244:247], a[224:227], v[28:31], 0
  s_waitcnt lgkmcnt(4)
  buffer_load_dwordx2 a[246:247], v255, s[24:27], s39 offen offset:512 sc1
  v_mfma_f32_16x16x32_bf16 v[232:235], a[228:231], v[32:35], v[232:235]
  ds_read_b64_tr_b16 a[210:211], v7 offset:4608
  v_mfma_f32_16x16x32_bf16 v[236:239], a[228:231], v[36:39], v[236:239]
  buffer_load_dwordx4 v248, s[16:19], s41 offen lds
  v_mfma_f32_16x16x32_bf16 v[240:243], a[228:231], v[40:43], v[240:243]
  ds_read_b64_tr_b16 a[212:213], v7 offset:8192
  v_mfma_f32_16x16x32_bf16 v[244:247], a[228:231], v[44:47], v[244:247]
  s_waitcnt lgkmcnt(5)
  buffer_load_dwordx2 a[250:251], v255, s[24:27], s39 offen offset:1024 sc1
  v_mfma_f32_16x16x32_bf16 v[232:235], a[232:235], v[48:51], v[232:235]
  ds_read_b64_tr_b16 a[214:215], v7 offset:8704
  v_mfma_f32_16x16x32_bf16 v[236:239], a[232:235], v[52:55], v[236:239]
  v_mfma_f32_16x16x32_bf16 v[240:243], a[232:235], v[56:59], v[240:243]
  ds_read_b64_tr_b16 a[216:217], v7 offset:12288
  v_mfma_f32_16x16x32_bf16 v[244:247], a[232:235], v[60:63], v[244:247]
  s_waitcnt lgkmcnt(5)
  buffer_load_dwordx2 a[254:255], v255, s[24:27], s39 offen offset:1536 sc1
  v_mfma_f32_16x16x32_bf16 v[232:235], a[236:239], v[64:67], v[232:235]
  s_add_u32 s39, s80, 16384
  ds_read_b64_tr_b16 a[218:219], v7 offset:12800
  v_mfma_f32_16x16x32_bf16 v[236:239], a[236:239], v[68:71], v[236:239]
  v_mfma_f32_16x16x32_bf16 v[240:243], a[236:239], v[72:75], v[240:243]
  ds_read_b64_tr_b16 a[220:221], v7 offset:5120
  v_mfma_f32_16x16x32_bf16 v[244:247], a[236:239], v[76:79], v[244:247]
  s_waitcnt lgkmcnt(5)
  buffer_load_dwordx2 a[192:193], v255, s[24:27], s39 offen sc1
  v_mfma_f32_16x16x32_bf16 v[232:235], a[208:211], a[0:3], v[232:235]
  ds_read_b64_tr_b16 a[222:223], v7 offset:5632
  v_mfma_f32_16x16x32_bf16 v[236:239], a[208:211], a[4:7], v[236:239]
  v_mfma_f32_16x16x32_bf16 v[240:243], a[208:211], a[8:11], v[240:243]
  ds_read_b64_tr_b16 a[224:225], v7 offset:9216
  v_mfma_f32_16x16x32_bf16 v[244:247], a[208:211], a[12:15], v[244:247]
  s_waitcnt lgkmcnt(5)
  buffer_load_dwordx2 a[196:197], v255, s[24:27], s39 offen offset:512 sc1
  v_mfma_f32_16x16x32_bf16 v[232:235], a[212:215], a[16:19], v[232:235]
  ds_read_b64_tr_b16 a[226:227], v7 offset:9728
  v_mfma_f32_16x16x32_bf16 v[236:239], a[212:215], a[20:23], v[236:239]
  v_mfma_f32_16x16x32_bf16 v[240:243], a[212:215], a[24:27], v[240:243]
  ds_read_b64_tr_b16 a[228:229], v7 offset:13312
  v_mfma_f32_16x16x32_bf16 v[244:247], a[212:215], a[28:31], v[244:247]
  s_waitcnt lgkmcnt(5)
  buffer_load_dwordx2 a[200:201], v255, s[24:27], s39 offen offset:1024 sc1
  v_mfma_f32_16x16x32_bf16 v[232:235], a[216:219], a[32:35], v[232:235]
  ds_read_b64_tr_b16 a[230:231], v7 offset:13824
  v_mfma_f32_16x16x32_bf16 v[236:239], a[216:219], a[36:39], v[236:239]
  v_mfma_f32_16x16x32_bf16 v[240:243], a[216:219], a[40:43], v[240:243]
  ds_read_b64_tr_b16 a[232:233], v7 offset:6144
  v_mfma_f32_16x16x32_bf16 v[244:247], a[216:219], a[44:47], v[244:247]
  s_waitcnt lgkmcnt(5)
  buffer_load_dwordx2 a[204:205], v255, s[24:27], s39 offen offset:1536 sc1
  v_mfma_f32_16x16x32_bf16 v[232:235], a[220:223], a[48:51], v[232:235]
  s_add_u32 s39, s81, 16384
  ds_read_b64_tr_b16 a[234:235], v7 offset:6656
  v_mfma_f32_16x16x32_bf16 v[236:239], a[220:223], a[52:55], v[236:239]
  v_mfma_f32_16x16x32_bf16 v[240:243], a[220:223], a[56:59], v[240:243]
  ds_read_b64_tr_b16 a[236:237], v7 offset:10240
  v_mfma_f32_16x16x32_bf16 v[244:247], a[220:223], a[60:63], v[244:247]
  s_waitcnt lgkmcnt(5)
  buffer_load_dwordx2 a[194:195], v255, s[24:27], s39 offen sc1
  v_mfma_f32_16x16x32_bf16 v[232:235], a[224:227], a[64:67], v[232:235]
  ds_read_b64_tr_b16 a[238:239], v7 offset:10752
  v_mfma_f32_16x16x32_bf16 v[236:239], a[224:227], a[68:71], v[236:239]
  v_mfma_f32_16x16x32_bf16 v[240:243], a[224:227], a[72:75], v[240:243]
  ds_read_b64_tr_b16 a[208:209], v7 offset:14336
  v_mfma_f32_16x16x32_bf16 v[244:247], a[224:227], a[76:79], v[244:247]
  s_waitcnt lgkmcnt(5)
  buffer_load_dwordx2 a[198:199], v255, s[24:27], s39 offen offset:512 sc1
  v_mfma_f32_16x16x32_bf16 v[232:235], a[228:231], a[80:83], v[232:235]
  ds_read_b64_tr_b16 a[210:211], v7 offset:14848
  v_mfma_f32_16x16x32_bf16 v[236:239], a[228:231], a[84:87], v[236:239]
  v_mfma_f32_16x16x32_bf16 v[240:243], a[228:231], a[88:91], v[240:243]
  ds_read_b64_tr_b16 a[212:213], v7 offset:7168
  v_mfma_f32_16x16x32_bf16 v[244:247], a[228:231], a[92:95], v[244:247]
  s_waitcnt lgkmcnt(5)
  buffer_load_dwordx2 a[202:203], v255, s[24:27], s39 offen offset:1024 sc1
  v_mfma_f32_16x16x32_bf16 v[232:235], a[232:235], a[96:99], v[232:235]
  ds_read_b64_tr_b16 a[214:215], v7 offset:7680
  v_mfma_f32_16x16x32_bf16 v[236:239], a[232:235], a[100:103], v[236:239]
  v_mfma_f32_16x16x32_bf16 v[240:243], a[232:235], a[104:107], v[240:243]
  ds_read_b64_tr_b16 a[216:217], v7 offset:11264
  v_mfma_f32_16x16x32_bf16 v[244:247], a[232:235], a[108:111], v[244:247]
  s_waitcnt lgkmcnt(5)
  buffer_load_dwordx2 a[206:207], v255, s[24:27], s39 offen offset:1536 sc1
  v_mfma_f32_16x16x32_bf16 v[232:235], a[236:239], a[112:115], v[232:235]
  ds_read_b64_tr_b16 a[218:219], v7 offset:11776
  v_mfma_f32_16x16x32_bf16 v[236:239], a[236:239], a[116:119], v[236:239]
  v_mfma_f32_16x16x32_bf16 v[240:243], a[236:239], a[120:123], v[240:243]
  ds_read_b64_tr_b16 a[220:221], v7 offset:15360
  v_mfma_f32_16x16x32_bf16 v[244:247], a[236:239], a[124:127], v[244:247]
  s_waitcnt lgkmcnt(5)
  v_mfma_f32_16x16x32_bf16 v[232:235], a[208:211], a[128:131], v[232:235]
  ds_read_b64_tr_b16 a[222:223], v7 offset:15872
  v_mfma_f32_16x16x32_bf16 v[236:239], a[208:211], a[132:135], v[236:239]
  v_mfma_f32_16x16x32_bf16 v[240:243], a[208:211], a[136:139], v[240:243]
  ds_read_b64_tr_b16 a[224:225], v7 offset:16384
  v_mfma_f32_16x16x32_bf16 v[244:247], a[208:211], a[140:143], v[244:247]
  s_waitcnt lgkmcnt(5)
  v_mfma_f32_16x16x32_bf16 v[232:235], a[212:215], a[144:147], v[232:235]
  ds_read_b64_tr_b16 a[226:227], v7 offset:16896
  v_mfma_f32_16x16x32_bf16 v[236:239], a[212:215], a[148:151], v[236:239]
  v_mfma_f32_16x16x32_bf16 v[240:243], a[212:215], a[152:155], v[240:243]
  ds_read_b64_tr_b16 a[228:229], v7 offset:17408
  v_mfma_f32_16x16x32_bf16 v[244:247], a[212:215], a[156:159], v[244:247]
  s_waitcnt lgkmcnt(5)
  v_mfma_f32_16x16x32_bf16 v[232:235], a[216:219], a[160:163], v[232:235]
  ds_read_b64_tr_b16 a[230:231], v7 offset:17920
  s_waitcnt vmcnt(31)
  v_mfma_f32_16x16x32_bf16 v[236:239], a[216:219], a[164:167], v[236:239]
  s_waitcnt vmcnt(30)
  v_mfma_f32_16x16x32_bf16 v[240:243], a[216:219], a[168:171], v[240:243]
  s_waitcnt vmcnt(29)
  v_mfma_f32_16x16x32_bf16 v[244:247], a[216:219], a[172:175], v[244:247]
  s_waitcnt lgkmcnt(4)
  s_waitcnt vmcnt(26)
  v_mfma_f32_16x16x32_bf16 v[232:235], a[220:223], a[176:179], v[232:235]
  s_waitcnt vmcnt(23)
  v_mfma_f32_16x16x32_bf16 v[236:239], a[220:223], a[180:183], v[236:239]
  s_waitcnt vmcnt(20)
  v_mfma_f32_16x16x32_bf16 v[240:243], a[220:223], a[184:187], v[240:243]
  s_waitcnt vmcnt(17)
  v_mfma_f32_16x16x32_bf16 v[244:247], a[220:223], a[188:191], v[244:247]
  s_waitcnt lgkmcnt(2)
  s_waitcnt vmcnt(12)
  v_mfma_f32_16x16x32_bf16 v[232:235], a[224:227], a[240:243], v[232:235]
  s_waitcnt vmcnt(10)
  s_barrier
  ds_read_b64_tr_b16 a[232:233], v10 offset:0
  v_mfma_f32_16x16x32_bf16 v[236:239], a[224:227], a[244:247], v[236:239]
  ds_read_b64_tr_b16 a[234:235], v10 offset:18432
  s_waitcnt vmcnt(9)
  v_mfma_f32_16x16x32_bf16 v[240:243], a[224:227], a[248:251], v[240:243]
  ds_read_b64_tr_b16 a[236:237], v10 offset:1024
  s_waitcnt vmcnt(8)
  v_mfma_f32_16x16x32_bf16 v[244:247], a[224:227], a[252:255], v[244:247]
  s_waitcnt lgkmcnt(3)
  ds_read_b64_tr_b16 a[208:209], v10 offset:2048
  s_waitcnt vmcnt(3)
  v_mfma_f32_16x16x32_bf16 v[232:235], a[228:231], a[192:195], v[232:235]
  ds_read_b64_tr_b16 a[238:239], v10 offset:19456
  s_waitcnt vmcnt(2)
  v_mfma_f32_16x16x32_bf16 v[236:239], a[228:231], a[196:199], v[236:239]
  ds_read_b64_tr_b16 a[210:211], v10 offset:20480
  s_waitcnt vmcnt(1)
  v_mfma_f32_16x16x32_bf16 v[240:243], a[228:231], a[200:203], v[240:243]
  ds_read_b64_tr_b16 a[212:213], v10 offset:3072
  s_waitcnt vmcnt(0)
  v_mfma_f32_16x16x32_bf16 v[244:247], a[228:231], a[204:207], v[244:247]
  s_waitcnt lgkmcnt(5)
  v_mfma_f32_16x16x32_bf16 v[144:147], a[232:235], a[80:83], v[144:147]
  s_add_u32 m0, s32, 73728
  ds_read_b64_tr_b16 a[214:215], v10 offset:21504
  v_mfma_f32_16x16x32_bf16 v[148:151], a[232:235], a[84:87], v[148:151]
  v_mfma_f32_16x16x32_bf16 v[152:155], a[232:235], a[88:91], v[152:155]
  s_add_u32 s41, s71, 36992
  ds_read_b64_tr_b16 a[216:217], v10 offset:4096
  s_add_u32 s43, s35, 0
  v_cvt_pk_bf16_f32 v232, v232, v233
  v_mfma_f32_16x16x32_bf16 v[156:159], a[232:235], a[92:95], v[156:159]
  s_waitcnt lgkmcnt(4)
  v_cvt_pk_bf16_f32 v233, v234, v235
  v_cvt_pk_bf16_f32 v234, v236, v237
  v_mfma_f32_16x16x32_bf16 v[144:147], a[236:239], a[96:99], v[144:147]
  ds_read_b64_tr_b16 a[218:219], v10 offset:22528
  v_cvt_pk_bf16_f32 v235, v238, v239
  v_mfma_f32_16x16x32_bf16 v[148:151], a[236:239], a[100:103], v[148:151]
  buffer_load_dwordx4 v248, s[16:19], s41 offen lds
  buffer_store_dwordx4 v[232:235], v4, s[24:27], s43 offen sc1
  v_mfma_f32_16x16x32_bf16 v[152:155], a[236:239], a[104:107], v[152:155]
  s_add_u32 m0, s32, 74752
  ds_read_b64_tr_b16 a[220:221], v10 offset:5120
  v_cvt_pk_bf16_f32 v240, v240, v241
  v_mfma_f32_16x16x32_bf16 v[156:159], a[236:239], a[108:111], v[156:159]
  s_waitcnt lgkmcnt(5)
  v_cvt_pk_bf16_f32 v241, v242, v243
  v_cvt_pk_bf16_f32 v242, v244, v245
  v_mfma_f32_16x16x32_bf16 v[144:147], a[208:211], a[112:115], v[144:147]
  s_add_u32 s41, s69, 73856
  ds_read_b64_tr_b16 a[222:223], v10 offset:23552
  v_cvt_pk_bf16_f32 v243, v246, v247
  v_mfma_f32_16x16x32_bf16 v[148:151], a[208:211], a[116:119], v[148:151]
  buffer_store_dwordx4 v[240:243], v5, s[24:27], s43 offen offset:1024 sc1
  v_mfma_f32_16x16x32_bf16 v[152:155], a[208:211], a[120:123], v[152:155]
  ds_read_b64_tr_b16 a[224:225], v10 offset:6144
  v_mfma_f32_16x16x32_bf16 v[156:159], a[208:211], a[124:127], v[156:159]
  s_waitcnt lgkmcnt(5)
  buffer_load_dwordx4 v248, s[16:19], s41 offen lds
  v_mfma_f32_16x16x32_bf16 v[144:147], a[212:215], a[128:131], v[144:147]
  s_add_u32 m0, s32, 75776
  ds_read_b64_tr_b16 a[226:227], v10 offset:24576
  v_mfma_f32_16x16x32_bf16 v[148:151], a[212:215], a[132:135], v[148:151]
  v_mfma_f32_16x16x32_bf16 v[152:155], a[212:215], a[136:139], v[152:155]
  s_add_u32 s41, s70, 73856
  ds_read_b64_tr_b16 a[228:229], v10 offset:7168
  s_lshl_b32 s4, s4, 5
  v_mfma_f32_16x16x32_bf16 v[156:159], a[212:215], a[140:143], v[156:159]
  s_add_u32 s92, s4, s47
  s_lshl_b32 s5, s5, 5
  s_waitcnt lgkmcnt(5)
  v_mfma_f32_16x16x32_bf16 v[144:147], a[216:219], a[144:147], v[144:147]
  s_add_u32 s93, s5, s47
  ds_read_b64_tr_b16 a[230:231], v10 offset:25600
  s_lshl_b32 s6, s6, 5
  v_mfma_f32_16x16x32_bf16 v[148:151], a[216:219], a[148:151], v[148:151]
  s_add_u32 s94, s6, s47
  buffer_load_dwordx4 v248, s[16:19], s41 offen lds
  s_lshl_b32 s31, s31, 2
  v_mfma_f32_16x16x32_bf16 v[152:155], a[216:219], a[152:155], v[152:155]
  s_add_u32 m0, s32, 76800
  ds_read_b64_tr_b16 a[232:233], v10 offset:8192
  s_add_u32 s29, s13, s31
  v_mfma_f32_16x16x32_bf16 v[156:159], a[216:219], a[156:159], v[156:159]
  s_add_u32 s29, s29, 7159840
  s_waitcnt lgkmcnt(5)
  v_mfma_f32_16x16x32_bf16 v[144:147], a[220:223], a[160:163], v[144:147]
  s_add_u32 s41, s71, 73856
  ds_read_b64_tr_b16 a[234:235], v10 offset:26624
  v_subrev_u32 v252, 192, v0
  v_mfma_f32_16x16x32_bf16 v[148:151], a[220:223], a[164:167], v[148:151]
  v_lshrrev_b32 v251, 3, v252
  v_mfma_f32_16x16x32_bf16 v[152:155], a[220:223], a[168:171], v[152:155]
  ds_read_b64_tr_b16 a[236:237], v11 offset:0
  v_min_u32 v251, 1, v251
  v_mfma_f32_16x16x32_bf16 v[156:159], a[220:223], a[172:175], v[156:159]
  s_waitcnt lgkmcnt(5)
  buffer_load_dwordx4 v248, s[16:19], s41 offen lds
  v_mfma_f32_16x16x32_bf16 v[144:147], a[224:227], a[176:179], v[144:147]
  s_add_u32 m0, s32, 77824
  ds_read_b64_tr_b16 a[238:239], v11 offset:18432
  v_and_b32 v252, 7, v252
  v_mfma_f32_16x16x32_bf16 v[148:151], a[224:227], a[180:183], v[148:151]
  v_lshlrev_b32 v252, 7, v252
  v_mfma_f32_16x16x32_bf16 v[152:155], a[224:227], a[184:187], v[152:155]
  s_add_u32 s41, s69, 110720
  ds_read_b64_tr_b16 a[208:209], v11 offset:1024
  v_lshl_add_u32 v252, v251, 30, v252
  v_mfma_f32_16x16x32_bf16 v[156:159], a[224:227], a[188:191], v[156:159]
  s_mov_b32 s46, 0x00003f80
  s_waitcnt lgkmcnt(5)
  v_mfma_f32_16x16x32_bf16 v[144:147], a[228:231], a[240:243], v[144:147]
  s_mov_b32 s31, 0x3f800000
  ds_read_b64_tr_b16 a[210:211], v11 offset:19456
  v_mfma_f32_16x16x32_bf16 v[148:151], a[228:231], a[244:247], v[148:151]
  buffer_load_dwordx4 v248, s[16:19], s41 offen lds
  v_mfma_f32_16x16x32_bf16 v[152:155], a[228:231], a[248:251], v[152:155]
  s_add_u32 m0, s32, 78848
  ds_read_b64_tr_b16 a[212:213], v11 offset:2048
  s_mov_b32 s8, s14
  s_mov_b32 s9, s15
  v_mfma_f32_16x16x32_bf16 v[156:159], a[228:231], a[252:255], v[156:159]
  s_waitcnt lgkmcnt(5)
  v_mfma_f32_16x16x32_bf16 v[144:147], a[232:235], a[192:195], v[144:147]
  s_add_u32 s41, s70, 110720
  ds_read_b64_tr_b16 a[214:215], v11 offset:20480
  v_mfma_f32_16x16x32_bf16 v[148:151], a[232:235], a[196:199], v[148:151]
  v_mfma_f32_16x16x32_bf16 v[152:155], a[232:235], a[200:203], v[152:155]
  ds_read_b64_tr_b16 a[216:217], v11 offset:3072
  v_mfma_f32_16x16x32_bf16 v[156:159], a[232:235], a[204:207], v[156:159]
  s_waitcnt lgkmcnt(5)
  buffer_load_dwordx4 v248, s[16:19], s41 offen lds
  v_mfma_f32_16x16x32_bf16 v[160:163], a[236:239], a[80:83], v[160:163]
  s_add_u32 m0, s32, 79872
  ds_read_b64_tr_b16 a[218:219], v11 offset:21504
  s_mov_b32 s10, 2359296
  v_mfma_f32_16x16x32_bf16 v[164:167], a[236:239], a[84:87], v[164:167]
  v_mfma_f32_16x16x32_bf16 v[168:171], a[236:239], a[88:91], v[168:171]
  s_add_u32 s41, s71, 110720
  ds_read_b64_tr_b16 a[220:221], v11 offset:4096
  s_add_u32 s43, s35, 2048
  v_cvt_pk_bf16_f32 v144, v144, v145
  v_mfma_f32_16x16x32_bf16 v[172:175], a[236:239], a[92:95], v[172:175]
  s_waitcnt lgkmcnt(5)
  v_cvt_pk_bf16_f32 v145, v146, v147
  v_cvt_pk_bf16_f32 v146, v148, v149
  v_mfma_f32_16x16x32_bf16 v[160:163], a[208:211], a[96:99], v[160:163]
  ds_read_b64_tr_b16 a[222:223], v11 offset:22528
  v_cvt_pk_bf16_f32 v147, v150, v151
  v_mfma_f32_16x16x32_bf16 v[164:167], a[208:211], a[100:103], v[164:167]
  buffer_load_dwordx4 v248, s[16:19], s41 offen lds
  buffer_store_dwordx4 v[144:147], v4, s[24:27], s43 offen sc1
  v_mfma_f32_16x16x32_bf16 v[168:171], a[208:211], a[104:107], v[168:171]
  s_add_u32 m0, s32, 80896
  ds_read_b64_tr_b16 a[224:225], v11 offset:5120
  v_lshlrev_b32 v16, 16, v224
  v_mfma_f32_16x16x32_bf16 v[172:175], a[208:211], a[108:111], v[172:175]
  s_waitcnt lgkmcnt(5)
  v_cvt_pk_bf16_f32 v152, v152, v153
  v_cvt_pk_bf16_f32 v153, v154, v155
  v_mfma_f32_16x16x32_bf16 v[160:163], a[212:215], a[112:115], v[160:163]
  s_add_u32 s41, s72, 128
  ds_read_b64_tr_b16 a[226:227], v11 offset:23552
  v_cvt_pk_bf16_f32 v154, v156, v157
  v_mfma_f32_16x16x32_bf16 v[164:167], a[212:215], a[116:119], v[164:167]
  v_cvt_pk_bf16_f32 v155, v158, v159
  v_mfma_f32_16x16x32_bf16 v[168:171], a[212:215], a[120:123], v[168:171]
  ds_read_b64_tr_b16 a[228:229], v11 offset:6144
  buffer_store_dwordx4 v[152:155], v5, s[24:27], s43 offen offset:1024 sc1
  v_mfma_f32_16x16x32_bf16 v[172:175], a[212:215], a[124:127], v[172:175]
  s_waitcnt lgkmcnt(5)
  buffer_load_dwordx4 v248, s[16:19], s41 offen lds
  v_and_b32 v17, 0xffff0000, v224
  v_mfma_f32_16x16x32_bf16 v[160:163], a[216:219], a[128:131], v[160:163]
  s_add_u32 m0, s32, 81920
  ds_read_b64_tr_b16 a[230:231], v11 offset:24576
  v_lshlrev_b32 v18, 16, v225
  v_mfma_f32_16x16x32_bf16 v[164:167], a[216:219], a[132:135], v[164:167]
  v_and_b32 v19, 0xffff0000, v225
  v_mfma_f32_16x16x32_bf16 v[168:171], a[216:219], a[136:139], v[168:171]
  s_add_u32 s41, s73, 128
  ds_read_b64_tr_b16 a[232:233], v11 offset:7168
  v_lshlrev_b32 v20, 16, v226
  v_mfma_f32_16x16x32_bf16 v[172:175], a[216:219], a[140:143], v[172:175]
  s_waitcnt lgkmcnt(5)
  v_and_b32 v21, 0xffff0000, v226
  v_mfma_f32_16x16x32_bf16 v[160:163], a[220:223], a[144:147], v[160:163]
  ds_read_b64_tr_b16 a[234:235], v11 offset:25600
  v_lshlrev_b32 v22, 16, v227
  v_mfma_f32_16x16x32_bf16 v[164:167], a[220:223], a[148:151], v[164:167]
  buffer_load_dwordx4 v248, s[16:19], s41 offen lds
  v_and_b32 v23, 0xffff0000, v227
  v_mfma_f32_16x16x32_bf16 v[168:171], a[220:223], a[152:155], v[168:171]
  ds_read_b64_tr_b16 a[236:237], v11 offset:8192
  v_add_f32 v16, v16, v199
  v_mfma_f32_16x16x32_bf16 v[172:175], a[220:223], a[156:159], v[172:175]
  s_waitcnt lgkmcnt(5)
  v_add_f32 v17, v17, v199
  v_mfma_f32_16x16x32_bf16 v[160:163], a[224:227], a[160:163], v[160:163]
  ds_read_b64_tr_b16 a[238:239], v11 offset:26624
  v_add_f32 v18, v18, v199
  v_mfma_f32_16x16x32_bf16 v[164:167], a[224:227], a[164:167], v[164:167]
  v_add_f32 v19, v19, v199
  v_add_f32 v20, v20, v199
  v_mfma_f32_16x16x32_bf16 v[168:171], a[224:227], a[168:171], v[168:171]
  ds_read_b64_tr_b16 a[208:209], v10 offset:512
  v_add_f32 v21, v21, v199
  v_mfma_f32_16x16x32_bf16 v[172:175], a[224:227], a[172:175], v[172:175]
  s_waitcnt lgkmcnt(5)
  v_add_f32 v22, v22, v199
  v_mfma_f32_16x16x32_bf16 v[160:163], a[228:231], a[176:179], v[160:163]
  ds_read_b64_tr_b16 a[210:211], v10 offset:18944
  v_add_f32 v23, v23, v199
  v_mfma_f32_16x16x32_bf16 v[164:167], a[228:231], a[180:183], v[164:167]
  v_permlane16_swap_b32 v16, v20
  v_mfma_f32_16x16x32_bf16 v[168:171], a[228:231], a[184:187], v[168:171]
  ds_read_b64_tr_b16 a[212:213], v10 offset:1536
  v_permlane16_swap_b32 v17, v21
  v_mfma_f32_16x16x32_bf16 v[172:175], a[228:231], a[188:191], v[172:175]
  s_waitcnt lgkmcnt(5)
  v_permlane16_swap_b32 v18, v22
  v_mfma_f32_16x16x32_bf16 v[160:163], a[232:235], a[240:243], v[160:163]
  ds_read_b64_tr_b16 a[214:215], v10 offset:19968
  v_permlane16_swap_b32 v19, v23
  v_mfma_f32_16x16x32_bf16 v[164:167], a[232:235], a[244:247], v[164:167]
  v_lshlrev_b32 v24, 16, v228
  v_mfma_f32_16x16x32_bf16 v[168:171], a[232:235], a[248:251], v[168:171]
  ds_read_b64_tr_b16 a[216:217], v10 offset:2560
  v_and_b32 v25, 0xffff0000, v228
  v_mfma_f32_16x16x32_bf16 v[172:175], a[232:235], a[252:255], v[172:175]
  s_waitcnt lgkmcnt(5)
  v_lshlrev_b32 v26, 16, v229
  v_mfma_f32_16x16x32_bf16 v[160:163], a[236:239], a[192:195], v[160:163]
  ds_read_b64_tr_b16 a[218:219], v10 offset:20992
  v_mfma_f32_16x16x32_bf16 v[164:167], a[236:239], a[196:199], v[164:167]
  v_mfma_f32_16x16x32_bf16 v[168:171], a[236:239], a[200:203], v[168:171]
  ds_read_b64_tr_b16 a[220:221], v10 offset:3584
  v_and_b32 v27, 0xffff0000, v229
  v_mfma_f32_16x16x32_bf16 v[172:175], a[236:239], a[204:207], v[172:175]
  s_waitcnt lgkmcnt(5)
  v_mfma_f32_16x16x32_bf16 v[176:179], a[208:211], a[80:83], v[176:179]
  ds_read_b64_tr_b16 a[222:223], v10 offset:22016
  v_mfma_f32_16x16x32_bf16 v[180:183], a[208:211], a[84:87], v[180:183]
  v_mfma_f32_16x16x32_bf16 v[184:187], a[208:211], a[88:91], v[184:187]
  s_add_u32 s43, s35, 4096
  ds_read_b64_tr_b16 a[224:225], v10 offset:4608
  v_cvt_pk_bf16_f32 v160, v160, v161
  v_mfma_f32_16x16x32_bf16 v[188:191], a[208:211], a[92:95], v[188:191]
  s_waitcnt lgkmcnt(5)
  v_cvt_pk_bf16_f32 v161, v162, v163
  v_cvt_pk_bf16_f32 v162, v164, v165
  v_mfma_f32_16x16x32_bf16 v[176:179], a[212:215], a[96:99], v[176:179]
  ds_read_b64_tr_b16 a[226:227], v10 offset:23040
  v_cvt_pk_bf16_f32 v163, v166, v167
  v_mfma_f32_16x16x32_bf16 v[180:183], a[212:215], a[100:103], v[180:183]
  buffer_store_dwordx4 v[160:163], v4, s[24:27], s43 offen sc1
  v_lshlrev_b32 v28, 16, v230
  v_mfma_f32_16x16x32_bf16 v[184:187], a[212:215], a[104:107], v[184:187]
  ds_read_b64_tr_b16 a[228:229], v10 offset:5632
  v_and_b32 v29, 0xffff0000, v230
  v_mfma_f32_16x16x32_bf16 v[188:191], a[212:215], a[108:111], v[188:191]
  s_waitcnt lgkmcnt(5)
  v_cvt_pk_bf16_f32 v168, v168, v169
  v_cvt_pk_bf16_f32 v169, v170, v171
  v_mfma_f32_16x16x32_bf16 v[176:179], a[216:219], a[112:115], v[176:179]
  ds_read_b64_tr_b16 a[230:231], v10 offset:24064
  v_cvt_pk_bf16_f32 v170, v172, v173
  v_mfma_f32_16x16x32_bf16 v[180:183], a[216:219], a[116:119], v[180:183]
  v_lshlrev_b32 v30, 16, v231
  v_cvt_pk_bf16_f32 v171, v174, v175
  v_mfma_f32_16x16x32_bf16 v[184:187], a[216:219], a[120:123], v[184:187]
  ds_read_b64_tr_b16 a[232:233], v10 offset:6656
  buffer_store_dwordx4 v[168:171], v5, s[24:27], s43 offen offset:1024 sc1
  v_mfma_f32_16x16x32_bf16 v[188:191], a[216:219], a[124:127], v[188:191]
  s_waitcnt lgkmcnt(5)
  v_and_b32 v31, 0xffff0000, v231
  v_add_f32 v24, v24, v199
  v_mfma_f32_16x16x32_bf16 v[176:179], a[220:223], a[128:131], v[176:179]
  ds_read_b64_tr_b16 a[234:235], v10 offset:25088
  v_add_f32 v25, v25, v199
  v_mfma_f32_16x16x32_bf16 v[180:183], a[220:223], a[132:135], v[180:183]
  v_add_f32 v26, v26, v199
  v_mfma_f32_16x16x32_bf16 v[184:187], a[220:223], a[136:139], v[184:187]
  ds_read_b64_tr_b16 a[236:237], v10 offset:7680
  v_add_f32 v27, v27, v199
  v_mfma_f32_16x16x32_bf16 v[188:191], a[220:223], a[140:143], v[188:191]
  s_waitcnt lgkmcnt(5)
  v_add_f32 v28, v28, v199
  v_mfma_f32_16x16x32_bf16 v[176:179], a[224:227], a[144:147], v[176:179]
  ds_read_b64_tr_b16 a[238:239], v10 offset:26112
  v_add_f32 v29, v29, v199
  v_mfma_f32_16x16x32_bf16 v[180:183], a[224:227], a[148:151], v[180:183]
  v_add_f32 v30, v30, v199
  v_mfma_f32_16x16x32_bf16 v[184:187], a[224:227], a[152:155], v[184:187]
  ds_read_b64_tr_b16 a[208:209], v10 offset:8704
  v_add_f32 v31, v31, v199
  v_mfma_f32_16x16x32_bf16 v[188:191], a[224:227], a[156:159], v[188:191]
  s_waitcnt lgkmcnt(5)
  v_permlane16_swap_b32 v24, v28
  v_mfma_f32_16x16x32_bf16 v[176:179], a[228:231], a[160:163], v[176:179]
  ds_read_b64_tr_b16 a[210:211], v10 offset:27136
  v_permlane16_swap_b32 v25, v29
  v_mfma_f32_16x16x32_bf16 v[180:183], a[228:231], a[164:167], v[180:183]
  v_permlane16_swap_b32 v26, v30
  v_mfma_f32_16x16x32_bf16 v[184:187], a[228:231], a[168:171], v[184:187]
  ds_read_b64_tr_b16 a[212:213], v11 offset:512
  v_permlane16_swap_b32 v27, v31
  v_mfma_f32_16x16x32_bf16 v[188:191], a[228:231], a[172:175], v[188:191]
  s_waitcnt lgkmcnt(5)
  v_lshlrev_b32 v32, 16, v192
  v_and_b32 v33, 0xffff0000, v192
  v_mfma_f32_16x16x32_bf16 v[176:179], a[232:235], a[176:179], v[176:179]
  ds_read_b64_tr_b16 a[214:215], v11 offset:18944
  v_lshlrev_b32 v34, 16, v193
  v_mfma_f32_16x16x32_bf16 v[180:183], a[232:235], a[180:183], v[180:183]
  v_and_b32 v35, 0xffff0000, v193
  v_mfma_f32_16x16x32_bf16 v[184:187], a[232:235], a[184:187], v[184:187]
  ds_read_b64_tr_b16 a[216:217], v11 offset:1536
  v_lshlrev_b32 v36, 16, v194
  v_mfma_f32_16x16x32_bf16 v[188:191], a[232:235], a[188:191], v[188:191]
  s_waitcnt lgkmcnt(5)
  v_and_b32 v37, 0xffff0000, v194
  v_mfma_f32_16x16x32_bf16 v[176:179], a[236:239], a[240:243], v[176:179]
  ds_read_b64_tr_b16 a[218:219], v11 offset:19968
  v_lshlrev_b32 v38, 16, v195
  v_mfma_f32_16x16x32_bf16 v[180:183], a[236:239], a[244:247], v[180:183]
  v_and_b32 v39, 0xffff0000, v195
  v_mfma_f32_16x16x32_bf16 v[184:187], a[236:239], a[248:251], v[184:187]
  ds_read_b64_tr_b16 a[220:221], v11 offset:2560
  v_add_f32 v32, v32, v199
  v_mfma_f32_16x16x32_bf16 v[188:191], a[236:239], a[252:255], v[188:191]
  s_waitcnt lgkmcnt(5)
  v_add_f32 v33, v33, v199
  v_mfma_f32_16x16x32_bf16 v[176:179], a[208:211], a[192:195], v[176:179]
  ds_read_b64_tr_b16 a[222:223], v11 offset:20992
  v_mfma_f32_16x16x32_bf16 v[180:183], a[208:211], a[196:199], v[180:183]
  v_mfma_f32_16x16x32_bf16 v[184:187], a[208:211], a[200:203], v[184:187]
  ds_read_b64_tr_b16 a[224:225], v11 offset:3584
  v_add_f32 v34, v34, v199
  v_mfma_f32_16x16x32_bf16 v[188:191], a[208:211], a[204:207], v[188:191]
  s_waitcnt lgkmcnt(5)
  v_mfma_f32_16x16x32_bf16 v[204:207], a[212:215], a[80:83], v[204:207]
  ds_read_b64_tr_b16 a[226:227], v11 offset:22016
  v_mfma_f32_16x16x32_bf16 v[208:211], a[212:215], a[84:87], v[208:211]
  v_mfma_f32_16x16x32_bf16 v[212:215], a[212:215], a[88:91], v[212:215]
  s_add_u32 s43, s35, 6144
  ds_read_b64_tr_b16 a[228:229], v11 offset:4608
  v_cvt_pk_bf16_f32 v176, v176, v177
  v_mfma_f32_16x16x32_bf16 v[216:219], a[212:215], a[92:95], v[216:219]
  s_waitcnt lgkmcnt(5)
  v_cvt_pk_bf16_f32 v177, v178, v179
  v_cvt_pk_bf16_f32 v178, v180, v181
  v_mfma_f32_16x16x32_bf16 v[204:207], a[216:219], a[96:99], v[204:207]
  ds_read_b64_tr_b16 a[230:231], v11 offset:23040
  v_cvt_pk_bf16_f32 v179, v182, v183
  v_mfma_f32_16x16x32_bf16 v[208:211], a[216:219], a[100:103], v[208:211]
  buffer_store_dwordx4 v[176:179], v4, s[24:27], s43 offen sc1
  v_add_f32 v35, v35, v199
  v_mfma_f32_16x16x32_bf16 v[212:215], a[216:219], a[104:107], v[212:215]
  ds_read_b64_tr_b16 a[232:233], v11 offset:5632
  v_cvt_pk_bf16_f32 v184, v184, v185
  v_mfma_f32_16x16x32_bf16 v[216:219], a[216:219], a[108:111], v[216:219]
  s_waitcnt lgkmcnt(5)
  v_cvt_pk_bf16_f32 v185, v186, v187
  v_cvt_pk_bf16_f32 v186, v188, v189
  v_mfma_f32_16x16x32_bf16 v[204:207], a[220:223], a[112:115], v[204:207]
  ds_read_b64_tr_b16 a[234:235], v11 offset:24064
  v_add_f32 v36, v36, v199
  v_mfma_f32_16x16x32_bf16 v[208:211], a[220:223], a[116:119], v[208:211]
  v_add_f32 v37, v37, v199
  v_cvt_pk_bf16_f32 v187, v190, v191
  v_mfma_f32_16x16x32_bf16 v[212:215], a[220:223], a[120:123], v[212:215]
  ds_read_b64_tr_b16 a[236:237], v11 offset:6656
  buffer_store_dwordx4 v[184:187], v5, s[24:27], s43 offen offset:1024 sc1
  v_mfma_f32_16x16x32_bf16 v[216:219], a[220:223], a[124:127], v[216:219]
  s_waitcnt lgkmcnt(5)
  v_add_f32 v38, v38, v199
  v_add_f32 v39, v39, v199
  v_mfma_f32_16x16x32_bf16 v[204:207], a[224:227], a[128:131], v[204:207]
  ds_read_b64_tr_b16 a[238:239], v11 offset:25088
  v_permlane16_swap_b32 v32, v36
  v_mfma_f32_16x16x32_bf16 v[208:211], a[224:227], a[132:135], v[208:211]
  v_permlane16_swap_b32 v33, v37
  v_mfma_f32_16x16x32_bf16 v[212:215], a[224:227], a[136:139], v[212:215]
  ds_read_b64_tr_b16 a[208:209], v11 offset:7680
  v_permlane16_swap_b32 v34, v38
  v_mfma_f32_16x16x32_bf16 v[216:219], a[224:227], a[140:143], v[216:219]
  s_waitcnt lgkmcnt(5)
  v_permlane16_swap_b32 v35, v39
  v_mfma_f32_16x16x32_bf16 v[204:207], a[228:231], a[144:147], v[204:207]
  ds_read_b64_tr_b16 a[210:211], v11 offset:26112
  v_mfma_f32_16x16x32_bf16 v[208:211], a[228:231], a[148:151], v[208:211]
  v_mfma_f32_16x16x32_bf16 v[212:215], a[228:231], a[152:155], v[212:215]
  ds_read_b64_tr_b16 a[212:213], v11 offset:8704
  v_mfma_f32_16x16x32_bf16 v[216:219], a[228:231], a[156:159], v[216:219]
  s_waitcnt lgkmcnt(5)
  v_mfma_f32_16x16x32_bf16 v[204:207], a[232:235], a[160:163], v[204:207]
  ds_read_b64_tr_b16 a[214:215], v11 offset:27136
  v_mfma_f32_16x16x32_bf16 v[208:211], a[232:235], a[164:167], v[208:211]
  v_mfma_f32_16x16x32_bf16 v[212:215], a[232:235], a[168:171], v[212:215]
  v_mfma_f32_16x16x32_bf16 v[216:219], a[232:235], a[172:175], v[216:219]
  s_waitcnt lgkmcnt(4)
  v_mfma_f32_16x16x32_bf16 v[204:207], a[236:239], a[176:179], v[204:207]
  v_mfma_f32_16x16x32_bf16 v[208:211], a[236:239], a[180:183], v[208:211]
  v_mov_b32 v253, 1
  v_mfma_f32_16x16x32_bf16 v[212:215], a[236:239], a[184:187], v[212:215]
  v_mfma_f32_16x16x32_bf16 v[216:219], a[236:239], a[188:191], v[216:219]
  s_waitcnt lgkmcnt(2)
  v_mfma_f32_16x16x32_bf16 v[204:207], a[208:211], a[240:243], v[204:207]
  s_waitcnt vmcnt(4)
  s_barrier
  ds_read_b64_tr_b16 a[216:217], v12 offset:0
  v_mfma_f32_16x16x32_bf16 v[208:211], a[208:211], a[244:247], v[208:211]
  ds_read_b64_tr_b16 a[218:219], v12 offset:18432
  v_mfma_f32_16x16x32_bf16 v[212:215], a[208:211], a[248:251], v[212:215]
  ds_read_b64_tr_b16 a[220:221], v12 offset:1024
  v_mfma_f32_16x16x32_bf16 v[216:219], a[208:211], a[252:255], v[216:219]
  s_waitcnt lgkmcnt(3)
  ds_read_b64_tr_b16 a[224:225], v12 offset:2048
  v_mfma_f32_16x16x32_bf16 v[204:207], a[212:215], a[192:195], v[204:207]
  ds_read_b64_tr_b16 a[222:223], v12 offset:19456
  v_mfma_f32_16x16x32_bf16 v[208:211], a[212:215], a[196:199], v[208:211]
  ds_read_b64_tr_b16 a[226:227], v12 offset:20480
  v_mfma_f32_16x16x32_bf16 v[212:215], a[212:215], a[200:203], v[212:215]
  ds_read_b64_tr_b16 a[228:229], v12 offset:3072
  v_mfma_f32_16x16x32_bf16 v[216:219], a[212:215], a[204:207], v[216:219]
  s_waitcnt lgkmcnt(5)
  v_mfma_f32_16x16x32_bf16 v[80:83], a[216:219], a[80:83], v[80:83]
  ds_read_b64_tr_b16 a[230:231], v12 offset:21504
  v_mfma_f32_16x16x32_bf16 v[84:87], a[216:219], a[84:87], v[84:87]
  v_mfma_f32_16x16x32_bf16 v[88:91], a[216:219], a[88:91], v[88:91]
  s_add_u32 s43, s35, 8192
  ds_read_b64_tr_b16 a[232:233], v12 offset:4096
  v_cvt_pk_bf16_f32 v204, v204, v205
  v_mfma_f32_16x16x32_bf16 v[92:95], a[216:219], a[92:95], v[92:95]
  s_waitcnt lgkmcnt(4)
  v_cvt_pk_bf16_f32 v205, v206, v207
  v_cvt_pk_bf16_f32 v206, v208, v209
  v_mfma_f32_16x16x32_bf16 v[80:83], a[220:223], a[96:99], v[80:83]
  ds_read_b64_tr_b16 a[234:235], v12 offset:22528
  v_cvt_pk_bf16_f32 v207, v210, v211
  v_mfma_f32_16x16x32_bf16 v[84:87], a[220:223], a[100:103], v[84:87]
  buffer_store_dwordx4 v[204:207], v4, s[24:27], s43 offen sc1
  v_cvt_pk_bf16_f32 v212, v212, v213
  v_mfma_f32_16x16x32_bf16 v[88:91], a[220:223], a[104:107], v[88:91]
  ds_read_b64_tr_b16 a[236:237], v12 offset:5120
  v_cvt_pk_bf16_f32 v213, v214, v215
  v_mfma_f32_16x16x32_bf16 v[92:95], a[220:223], a[108:111], v[92:95]
  s_waitcnt lgkmcnt(5)
  v_cvt_pk_bf16_f32 v214, v216, v217
  v_mfma_f32_16x16x32_bf16 v[80:83], a[224:227], a[112:115], v[80:83]
  ds_read_b64_tr_b16 a[238:239], v12 offset:23552
  v_cvt_pk_bf16_f32 v215, v218, v219
  v_mfma_f32_16x16x32_bf16 v[84:87], a[224:227], a[116:119], v[84:87]
  buffer_store_dwordx4 v[212:215], v5, s[24:27], s43 offen offset:1024 sc1
  v_mfma_f32_16x16x32_bf16 v[88:91], a[224:227], a[120:123], v[88:91]
  ds_read_b64_tr_b16 a[208:209], v12 offset:6144
  v_mfma_f32_16x16x32_bf16 v[92:95], a[224:227], a[124:127], v[92:95]
  s_waitcnt lgkmcnt(5)
  v_mfma_f32_16x16x32_bf16 v[80:83], a[228:231], a[128:131], v[80:83]
  ds_read_b64_tr_b16 a[210:211], v12 offset:24576
  v_mfma_f32_16x16x32_bf16 v[84:87], a[228:231], a[132:135], v[84:87]
  v_mfma_f32_16x16x32_bf16 v[88:91], a[228:231], a[136:139], v[88:91]
  ds_read_b64_tr_b16 a[212:213], v12 offset:7168
  v_mfma_f32_16x16x32_bf16 v[92:95], a[228:231], a[140:143], v[92:95]
  s_waitcnt lgkmcnt(5)
  v_mfma_f32_16x16x32_bf16 v[80:83], a[232:235], a[144:147], v[80:83]
  ds_read_b64_tr_b16 a[214:215], v12 offset:25600
  v_mfma_f32_16x16x32_bf16 v[84:87], a[232:235], a[148:151], v[84:87]
  v_mfma_f32_16x16x32_bf16 v[88:91], a[232:235], a[152:155], v[88:91]
  ds_read_b64_tr_b16 a[216:217], v12 offset:8192
  v_mfma_f32_16x16x32_bf16 v[92:95], a[232:235], a[156:159], v[92:95]
  s_waitcnt lgkmcnt(5)
  v_mfma_f32_16x16x32_bf16 v[80:83], a[236:239], a[160:163], v[80:83]
  ds_read_b64_tr_b16 a[218:219], v12 offset:26624
  v_mfma_f32_16x16x32_bf16 v[84:87], a[236:239], a[164:167], v[84:87]
  v_mfma_f32_16x16x32_bf16 v[88:91], a[236:239], a[168:171], v[88:91]
  ds_read_b64_tr_b16 a[220:221], v13 offset:0
  v_mfma_f32_16x16x32_bf16 v[92:95], a[236:239], a[172:175], v[92:95]
  s_waitcnt lgkmcnt(5)
  v_mfma_f32_16x16x32_bf16 v[80:83], a[208:211], a[176:179], v[80:83]
  ds_read_b64_tr_b16 a[222:223], v13 offset:18432
  v_mfma_f32_16x16x32_bf16 v[84:87], a[208:211], a[180:183], v[84:87]
  v_mfma_f32_16x16x32_bf16 v[88:91], a[208:211], a[184:187], v[88:91]
  ds_read_b64_tr_b16 a[224:225], v13 offset:1024
  v_mfma_f32_16x16x32_bf16 v[92:95], a[208:211], a[188:191], v[92:95]
  s_waitcnt lgkmcnt(5)
  v_mfma_f32_16x16x32_bf16 v[80:83], a[212:215], a[240:243], v[80:83]
  ds_read_b64_tr_b16 a[226:227], v13 offset:19456
  v_mfma_f32_16x16x32_bf16 v[84:87], a[212:215], a[244:247], v[84:87]
  v_mfma_f32_16x16x32_bf16 v[88:91], a[212:215], a[248:251], v[88:91]
  ds_read_b64_tr_b16 a[228:229], v13 offset:2048
  v_mfma_f32_16x16x32_bf16 v[92:95], a[212:215], a[252:255], v[92:95]
  s_waitcnt lgkmcnt(5)
  v_mfma_f32_16x16x32_bf16 v[80:83], a[216:219], a[192:195], v[80:83]
  ds_read_b64_tr_b16 a[230:231], v13 offset:20480
  v_mfma_f32_16x16x32_bf16 v[84:87], a[216:219], a[196:199], v[84:87]
  v_mfma_f32_16x16x32_bf16 v[88:91], a[216:219], a[200:203], v[88:91]
  ds_read_b64_tr_b16 a[232:233], v13 offset:3072
  v_mfma_f32_16x16x32_bf16 v[92:95], a[216:219], a[204:207], v[92:95]
  s_waitcnt lgkmcnt(5)
  v_mfma_f32_16x16x32_bf16 v[96:99], a[220:223], a[80:83], v[96:99]
  ds_read_b64_tr_b16 a[234:235], v13 offset:21504
  v_mfma_f32_16x16x32_bf16 v[100:103], a[220:223], a[84:87], v[100:103]
  v_mfma_f32_16x16x32_bf16 v[104:107], a[220:223], a[88:91], v[104:107]
  s_add_u32 s43, s35, 10240
  ds_read_b64_tr_b16 a[236:237], v13 offset:4096
  v_cvt_pk_bf16_f32 v80, v80, v81
  v_mfma_f32_16x16x32_bf16 v[108:111], a[220:223], a[92:95], v[108:111]
  s_waitcnt lgkmcnt(5)
  v_cvt_pk_bf16_f32 v81, v82, v83
  v_cvt_pk_bf16_f32 v82, v84, v85
  v_mfma_f32_16x16x32_bf16 v[96:99], a[224:227], a[96:99], v[96:99]
  ds_read_b64_tr_b16 a[238:239], v13 offset:22528
  v_cvt_pk_bf16_f32 v83, v86, v87
  v_mfma_f32_16x16x32_bf16 v[100:103], a[224:227], a[100:103], v[100:103]
  buffer_store_dwordx4 v[80:83], v4, s[24:27], s43 offen sc1
  v_cvt_pk_bf16_f32 v88, v88, v89
  v_mfma_f32_16x16x32_bf16 v[104:107], a[224:227], a[104:107], v[104:107]
  ds_read_b64_tr_b16 a[208:209], v13 offset:5120
  v_cvt_pk_bf16_f32 v89, v90, v91
  v_mfma_f32_16x16x32_bf16 v[108:111], a[224:227], a[108:111], v[108:111]
  s_waitcnt lgkmcnt(5)
  v_cvt_pk_bf16_f32 v90, v92, v93
  v_mfma_f32_16x16x32_bf16 v[96:99], a[228:231], a[112:115], v[96:99]
  ds_read_b64_tr_b16 a[210:211], v13 offset:23552
  v_cvt_pk_bf16_f32 v91, v94, v95
  v_mfma_f32_16x16x32_bf16 v[100:103], a[228:231], a[116:119], v[100:103]
  buffer_store_dwordx4 v[88:91], v5, s[24:27], s43 offen offset:1024 sc1
  v_mfma_f32_16x16x32_bf16 v[104:107], a[228:231], a[120:123], v[104:107]
  ds_read_b64_tr_b16 a[212:213], v13 offset:6144
  v_mfma_f32_16x16x32_bf16 v[108:111], a[228:231], a[124:127], v[108:111]
  s_waitcnt lgkmcnt(5)
  v_mfma_f32_16x16x32_bf16 v[96:99], a[232:235], a[128:131], v[96:99]
  ds_read_b64_tr_b16 a[214:215], v13 offset:24576
  v_mfma_f32_16x16x32_bf16 v[100:103], a[232:235], a[132:135], v[100:103]
  v_mfma_f32_16x16x32_bf16 v[104:107], a[232:235], a[136:139], v[104:107]
  ds_read_b64_tr_b16 a[216:217], v13 offset:7168
  v_mfma_f32_16x16x32_bf16 v[108:111], a[232:235], a[140:143], v[108:111]
  s_waitcnt lgkmcnt(5)
  v_mfma_f32_16x16x32_bf16 v[96:99], a[236:239], a[144:147], v[96:99]
  ds_read_b64_tr_b16 a[218:219], v13 offset:25600
  v_mfma_f32_16x16x32_bf16 v[100:103], a[236:239], a[148:151], v[100:103]
  v_mfma_f32_16x16x32_bf16 v[104:107], a[236:239], a[152:155], v[104:107]
  ds_read_b64_tr_b16 a[220:221], v13 offset:8192
  v_mfma_f32_16x16x32_bf16 v[108:111], a[236:239], a[156:159], v[108:111]
  s_waitcnt lgkmcnt(5)
  v_mfma_f32_16x16x32_bf16 v[96:99], a[208:211], a[160:163], v[96:99]
  ds_read_b64_tr_b16 a[222:223], v13 offset:26624
  v_mfma_f32_16x16x32_bf16 v[100:103], a[208:211], a[164:167], v[100:103]
  v_mfma_f32_16x16x32_bf16 v[104:107], a[208:211], a[168:171], v[104:107]
  ds_read_b64_tr_b16 a[224:225], v12 offset:512
  v_mfma_f32_16x16x32_bf16 v[108:111], a[208:211], a[172:175], v[108:111]
  s_waitcnt lgkmcnt(5)
  v_mfma_f32_16x16x32_bf16 v[96:99], a[212:215], a[176:179], v[96:99]
  ds_read_b64_tr_b16 a[226:227], v12 offset:18944
  v_mfma_f32_16x16x32_bf16 v[100:103], a[212:215], a[180:183], v[100:103]
  v_mfma_f32_16x16x32_bf16 v[104:107], a[212:215], a[184:187], v[104:107]
  ds_read_b64_tr_b16 a[228:229], v12 offset:1536
  v_mfma_f32_16x16x32_bf16 v[108:111], a[212:215], a[188:191], v[108:111]
  s_waitcnt lgkmcnt(5)
  v_mfma_f32_16x16x32_bf16 v[96:99], a[216:219], a[240:243], v[96:99]
  ds_read_b64_tr_b16 a[230:231], v12 offset:19968
  v_mfma_f32_16x16x32_bf16 v[100:103], a[216:219], a[244:247], v[100:103]
  v_mfma_f32_16x16x32_bf16 v[104:107], a[216:219], a[248:251], v[104:107]
  ds_read_b64_tr_b16 a[232:233], v12 offset:2560
  v_mfma_f32_16x16x32_bf16 v[108:111], a[216:219], a[252:255], v[108:111]
  s_waitcnt lgkmcnt(5)
  v_mfma_f32_16x16x32_bf16 v[96:99], a[220:223], a[192:195], v[96:99]
  ds_read_b64_tr_b16 a[234:235], v12 offset:20992
  v_mfma_f32_16x16x32_bf16 v[100:103], a[220:223], a[196:199], v[100:103]
  v_mfma_f32_16x16x32_bf16 v[104:107], a[220:223], a[200:203], v[104:107]
  ds_read_b64_tr_b16 a[236:237], v12 offset:3584
  v_mfma_f32_16x16x32_bf16 v[108:111], a[220:223], a[204:207], v[108:111]
  s_waitcnt lgkmcnt(5)
  v_mfma_f32_16x16x32_bf16 v[112:115], a[224:227], a[80:83], v[112:115]
  ds_read_b64_tr_b16 a[238:239], v12 offset:22016
  v_mfma_f32_16x16x32_bf16 v[116:119], a[224:227], a[84:87], v[116:119]
  v_mfma_f32_16x16x32_bf16 v[120:123], a[224:227], a[88:91], v[120:123]
  s_add_u32 s43, s35, 12288
  ds_read_b64_tr_b16 a[208:209], v12 offset:4608
  v_cvt_pk_bf16_f32 v96, v96, v97
  v_mfma_f32_16x16x32_bf16 v[124:127], a[224:227], a[92:95], v[124:127]
  s_waitcnt lgkmcnt(5)
  v_cvt_pk_bf16_f32 v97, v98, v99
  v_cvt_pk_bf16_f32 v98, v100, v101
  v_mfma_f32_16x16x32_bf16 v[112:115], a[228:231], a[96:99], v[112:115]
  ds_read_b64_tr_b16 a[210:211], v12 offset:23040
  v_cvt_pk_bf16_f32 v99, v102, v103
  v_mfma_f32_16x16x32_bf16 v[116:119], a[228:231], a[100:103], v[116:119]
  buffer_store_dwordx4 v[96:99], v4, s[24:27], s43 offen sc1
  v_cvt_pk_bf16_f32 v104, v104, v105
  v_mfma_f32_16x16x32_bf16 v[120:123], a[228:231], a[104:107], v[120:123]
  ds_read_b64_tr_b16 a[212:213], v12 offset:5632
  v_cvt_pk_bf16_f32 v105, v106, v107
  v_mfma_f32_16x16x32_bf16 v[124:127], a[228:231], a[108:111], v[124:127]
  s_waitcnt lgkmcnt(5)
  v_cvt_pk_bf16_f32 v106, v108, v109
  v_mfma_f32_16x16x32_bf16 v[112:115], a[232:235], a[112:115], v[112:115]
  ds_read_b64_tr_b16 a[214:215], v12 offset:24064
  v_cvt_pk_bf16_f32 v107, v110, v111
  v_mfma_f32_16x16x32_bf16 v[116:119], a[232:235], a[116:119], v[116:119]
  buffer_store_dwordx4 v[104:107], v5, s[24:27], s43 offen offset:1024 sc1
  v_mfma_f32_16x16x32_bf16 v[120:123], a[232:235], a[120:123], v[120:123]
  ds_read_b64_tr_b16 a[216:217], v12 offset:6656
  v_mfma_f32_16x16x32_bf16 v[124:127], a[232:235], a[124:127], v[124:127]
  s_waitcnt lgkmcnt(5)
  v_mfma_f32_16x16x32_bf16 v[112:115], a[236:239], a[128:131], v[112:115]
  ds_read_b64_tr_b16 a[218:219], v12 offset:25088
  v_mfma_f32_16x16x32_bf16 v[116:119], a[236:239], a[132:135], v[116:119]
  v_mfma_f32_16x16x32_bf16 v[120:123], a[236:239], a[136:139], v[120:123]
  ds_read_b64_tr_b16 a[220:221], v12 offset:7680
  v_mfma_f32_16x16x32_bf16 v[124:127], a[236:239], a[140:143], v[124:127]
  s_waitcnt lgkmcnt(5)
  v_mfma_f32_16x16x32_bf16 v[112:115], a[208:211], a[144:147], v[112:115]
  ds_read_b64_tr_b16 a[222:223], v12 offset:26112
  v_mfma_f32_16x16x32_bf16 v[116:119], a[208:211], a[148:151], v[116:119]
  v_mfma_f32_16x16x32_bf16 v[120:123], a[208:211], a[152:155], v[120:123]
  ds_read_b64_tr_b16 a[224:225], v12 offset:8704
  v_mfma_f32_16x16x32_bf16 v[124:127], a[208:211], a[156:159], v[124:127]
  s_waitcnt lgkmcnt(5)
  v_mfma_f32_16x16x32_bf16 v[112:115], a[212:215], a[160:163], v[112:115]
  ds_read_b64_tr_b16 a[226:227], v12 offset:27136
  v_mfma_f32_16x16x32_bf16 v[116:119], a[212:215], a[164:167], v[116:119]
  v_mfma_f32_16x16x32_bf16 v[120:123], a[212:215], a[168:171], v[120:123]
  ds_read_b64_tr_b16 a[228:229], v13 offset:512
  v_mfma_f32_16x16x32_bf16 v[124:127], a[212:215], a[172:175], v[124:127]
  s_waitcnt lgkmcnt(5)
  v_mfma_f32_16x16x32_bf16 v[112:115], a[216:219], a[176:179], v[112:115]
  ds_read_b64_tr_b16 a[230:231], v13 offset:18944
  v_mfma_f32_16x16x32_bf16 v[116:119], a[216:219], a[180:183], v[116:119]
  v_mfma_f32_16x16x32_bf16 v[120:123], a[216:219], a[184:187], v[120:123]
  ds_read_b64_tr_b16 a[232:233], v13 offset:1536
  v_mfma_f32_16x16x32_bf16 v[124:127], a[216:219], a[188:191], v[124:127]
  s_waitcnt lgkmcnt(5)
  v_mfma_f32_16x16x32_bf16 v[112:115], a[220:223], a[240:243], v[112:115]
  ds_read_b64_tr_b16 a[234:235], v13 offset:19968
  v_mfma_f32_16x16x32_bf16 v[116:119], a[220:223], a[244:247], v[116:119]
  v_mfma_f32_16x16x32_bf16 v[120:123], a[220:223], a[248:251], v[120:123]
  ds_read_b64_tr_b16 a[236:237], v13 offset:2560
  v_mfma_f32_16x16x32_bf16 v[124:127], a[220:223], a[252:255], v[124:127]
  s_waitcnt lgkmcnt(5)
  v_mfma_f32_16x16x32_bf16 v[112:115], a[224:227], a[192:195], v[112:115]
  ds_read_b64_tr_b16 a[238:239], v13 offset:20992
  v_mfma_f32_16x16x32_bf16 v[116:119], a[224:227], a[196:199], v[116:119]
  v_mfma_f32_16x16x32_bf16 v[120:123], a[224:227], a[200:203], v[120:123]
  ds_read_b64_tr_b16 a[208:209], v13 offset:3584
  v_mfma_f32_16x16x32_bf16 v[124:127], a[224:227], a[204:207], v[124:127]
  s_waitcnt lgkmcnt(5)
  v_mfma_f32_16x16x32_bf16 v[128:131], a[228:231], a[80:83], v[128:131]
  ds_read_b64_tr_b16 a[210:211], v13 offset:22016
  v_mfma_f32_16x16x32_bf16 v[132:135], a[228:231], a[84:87], v[132:135]
  buffer_load_dword v220, v203, s[20:23], s3 offen sc1
  v_mfma_f32_16x16x32_bf16 v[136:139], a[228:231], a[88:91], v[136:139]
  s_add_u32 s43, s35, 14336
  ds_read_b64_tr_b16 a[212:213], v13 offset:4608
  v_cvt_pk_bf16_f32 v112, v112, v113
  v_mfma_f32_16x16x32_bf16 v[140:143], a[228:231], a[92:95], v[140:143]
  s_waitcnt lgkmcnt(5)
  v_cvt_pk_bf16_f32 v113, v114, v115
  v_cvt_pk_bf16_f32 v114, v116, v117
  v_mfma_f32_16x16x32_bf16 v[128:131], a[232:235], a[96:99], v[128:131]
  ds_read_b64_tr_b16 a[214:215], v13 offset:23040
  v_cvt_pk_bf16_f32 v115, v118, v119
  v_mfma_f32_16x16x32_bf16 v[132:135], a[232:235], a[100:103], v[132:135]
  buffer_store_dwordx4 v[112:115], v4, s[24:27], s43 offen sc1
  v_cvt_pk_bf16_f32 v120, v120, v121
  v_mfma_f32_16x16x32_bf16 v[136:139], a[232:235], a[104:107], v[136:139]
  ds_read_b64_tr_b16 a[216:217], v13 offset:5632
  v_cvt_pk_bf16_f32 v121, v122, v123
  v_mfma_f32_16x16x32_bf16 v[140:143], a[232:235], a[108:111], v[140:143]
  s_waitcnt lgkmcnt(5)
  v_cvt_pk_bf16_f32 v122, v124, v125
  v_mfma_f32_16x16x32_bf16 v[128:131], a[236:239], a[112:115], v[128:131]
  ds_read_b64_tr_b16 a[218:219], v13 offset:24064
  v_cvt_pk_bf16_f32 v123, v126, v127
  v_mfma_f32_16x16x32_bf16 v[132:135], a[236:239], a[116:119], v[132:135]
  buffer_store_dwordx4 v[120:123], v5, s[24:27], s43 offen offset:1024 sc1
  v_mfma_f32_16x16x32_bf16 v[136:139], a[236:239], a[120:123], v[136:139]
  ds_read_b64_tr_b16 a[220:221], v13 offset:6656
  v_mfma_f32_16x16x32_bf16 v[140:143], a[236:239], a[124:127], v[140:143]
  s_waitcnt lgkmcnt(5)
  v_mfma_f32_16x16x32_bf16 v[128:131], a[208:211], a[128:131], v[128:131]
  ds_read_b64_tr_b16 a[222:223], v13 offset:25088
  v_mfma_f32_16x16x32_bf16 v[132:135], a[208:211], a[132:135], v[132:135]
  v_mfma_f32_16x16x32_bf16 v[136:139], a[208:211], a[136:139], v[136:139]
  ds_read_b64_tr_b16 a[224:225], v13 offset:7680
  v_mfma_f32_16x16x32_bf16 v[140:143], a[208:211], a[140:143], v[140:143]
  s_waitcnt lgkmcnt(5)
  v_mfma_f32_16x16x32_bf16 v[128:131], a[212:215], a[144:147], v[128:131]
  ds_read_b64_tr_b16 a[226:227], v13 offset:26112
  v_mfma_f32_16x16x32_bf16 v[132:135], a[212:215], a[148:151], v[132:135]
  v_mfma_f32_16x16x32_bf16 v[136:139], a[212:215], a[152:155], v[136:139]
  ds_read_b64_tr_b16 a[228:229], v13 offset:8704
  v_mfma_f32_16x16x32_bf16 v[140:143], a[212:215], a[156:159], v[140:143]
  s_waitcnt lgkmcnt(5)
  v_mfma_f32_16x16x32_bf16 v[128:131], a[216:219], a[160:163], v[128:131]
  ds_read_b64_tr_b16 a[230:231], v13 offset:27136
  v_mfma_f32_16x16x32_bf16 v[132:135], a[216:219], a[164:167], v[132:135]
  v_mfma_f32_16x16x32_bf16 v[136:139], a[216:219], a[168:171], v[136:139]
  v_mfma_f32_16x16x32_bf16 v[140:143], a[216:219], a[172:175], v[140:143]
  s_waitcnt lgkmcnt(4)
  v_mov_b32 v253, 3
  v_mfma_f32_16x16x32_bf16 v[128:131], a[220:223], a[176:179], v[128:131]
  v_mfma_f32_16x16x32_bf16 v[132:135], a[220:223], a[180:183], v[132:135]
  v_mfma_f32_16x16x32_bf16 v[136:139], a[220:223], a[184:187], v[136:139]
  v_mfma_f32_16x16x32_bf16 v[140:143], a[220:223], a[188:191], v[140:143]
  s_waitcnt lgkmcnt(2)
  v_mfma_f32_16x16x32_bf16 v[128:131], a[224:227], a[240:243], v[128:131]
  v_mfma_f32_16x16x32_bf16 v[132:135], a[224:227], a[244:247], v[132:135]
  v_mfma_f32_16x16x32_bf16 v[136:139], a[224:227], a[248:251], v[136:139]
  v_mfma_f32_16x16x32_bf16 v[140:143], a[224:227], a[252:255], v[140:143]
  s_waitcnt lgkmcnt(0)
  v_mfma_f32_16x16x32_bf16 v[128:131], a[228:231], a[192:195], v[128:131]
  v_mfma_f32_16x16x32_bf16 v[132:135], a[228:231], a[196:199], v[132:135]
  v_mfma_f32_16x16x32_bf16 v[136:139], a[228:231], a[200:203], v[136:139]
  v_mfma_f32_16x16x32_bf16 v[140:143], a[228:231], a[204:207], v[140:143]
  s_add_u32 s43, s35, 16384
  s_nop 3
  v_cvt_pk_bf16_f32 v128, v128, v129
  v_cvt_pk_bf16_f32 v129, v130, v131
  v_cvt_pk_bf16_f32 v130, v132, v133
  v_cvt_pk_bf16_f32 v131, v134, v135
  buffer_store_dwordx4 v[128:131], v4, s[24:27], s43 offen sc1
  v_cvt_pk_bf16_f32 v136, v136, v137
  v_cvt_pk_bf16_f32 v137, v138, v139
  v_cvt_pk_bf16_f32 v138, v140, v141
  v_cvt_pk_bf16_f32 v139, v142, v143
  buffer_store_dwordx4 v[136:139], v5, s[24:27], s43 offen offset:1024 sc1
  s_waitcnt vmcnt(4)
  v_cmp_lt_u32 s[16:17], 0, v220
  v_cmp_lt_u32 s[32:33], 2, v220
  s_bfe_u32 s12, s2, 0x20001
  s_cmp_lg_u32 s12, s28
  s_cbranch_scc1 sequential_preLN__spectral_fnet__swiglu_ffn__prompt_kernel_oe
  s_bitcmp1_b32 s2, 0
  s_cbranch_scc1 sequential_preLN__spectral_fnet__swiglu_ffn__prompt_kernel_o1
  ds_write_b128 v6, v[232:235] offset:0
  ds_write_b128 v6, v[144:147] offset:1024
  ds_write_b128 v6, v[160:163] offset:2048
  ds_write_b128 v6, v[176:179] offset:3072
  ds_write_b128 v6, v[204:207] offset:4096
  ds_write_b128 v6, v[80:83] offset:5120
  ds_write_b128 v6, v[96:99] offset:6144
  ds_write_b128 v6, v[112:115] offset:7168
  ds_write_b128 v6, v[128:131] offset:8192
  s_branch sequential_preLN__spectral_fnet__swiglu_ffn__prompt_kernel_oe
sequential_preLN__spectral_fnet__swiglu_ffn__prompt_kernel_o1:
  ds_write_b128 v6, v[240:243] offset:0
  ds_write_b128 v6, v[152:155] offset:1024
  ds_write_b128 v6, v[168:171] offset:2048
  ds_write_b128 v6, v[184:187] offset:3072
  ds_write_b128 v6, v[212:215] offset:4096
  ds_write_b128 v6, v[88:91] offset:5120
  ds_write_b128 v6, v[104:107] offset:6144
  ds_write_b128 v6, v[120:123] offset:7168
  ds_write_b128 v6, v[136:139] offset:8192
sequential_preLN__spectral_fnet__swiglu_ffn__prompt_kernel_oe:
  s_waitcnt lgkmcnt(0)
  s_cmp_eq_u32 s28, 3
  s_cbranch_scc1 sequential_preLN__spectral_fnet__swiglu_ffn__prompt_kernel_poll
  s_and_b32 s37, s16, 0xff
  s_bitcmp1_b32 s16, 0
  s_cbranch_scc0 sequential_preLN__spectral_fnet__swiglu_ffn__prompt_kernel_a0
  s_add_u32 s12, s44, 0
  buffer_load_dwordx4 v[144:147], v200, s[24:27], s12 offen sc1
sequential_preLN__spectral_fnet__swiglu_ffn__prompt_kernel_a0:
  s_bitcmp1_b32 s16, 1
  s_cbranch_scc0 sequential_preLN__spectral_fnet__swiglu_ffn__prompt_kernel_a1
  s_add_u32 s12, s44, 73728
  buffer_load_dwordx4 v[148:151], v200, s[24:27], s12 offen sc1
sequential_preLN__spectral_fnet__swiglu_ffn__prompt_kernel_a1:
  s_bitcmp1_b32 s16, 2
  s_cbranch_scc0 sequential_preLN__spectral_fnet__swiglu_ffn__prompt_kernel_a2
  s_add_u32 s12, s44, 147456
  buffer_load_dwordx4 v[152:155], v200, s[24:27], s12 offen sc1
sequential_preLN__spectral_fnet__swiglu_ffn__prompt_kernel_a2:
  s_bitcmp1_b32 s16, 3
  s_cbranch_scc0 sequential_preLN__spectral_fnet__swiglu_ffn__prompt_kernel_a3
  s_add_u32 s12, s44, 221184
  buffer_load_dwordx4 v[156:159], v200, s[24:27], s12 offen sc1
sequential_preLN__spectral_fnet__swiglu_ffn__prompt_kernel_a3:
  s_bitcmp1_b32 s16, 4
  s_cbranch_scc0 sequential_preLN__spectral_fnet__swiglu_ffn__prompt_kernel_a4
  s_add_u32 s12, s44, 294912
  buffer_load_dwordx4 v[160:163], v200, s[24:27], s12 offen sc1
sequential_preLN__spectral_fnet__swiglu_ffn__prompt_kernel_a4:
  s_bitcmp1_b32 s16, 5
  s_cbranch_scc0 sequential_preLN__spectral_fnet__swiglu_ffn__prompt_kernel_a5
  s_add_u32 s12, s44, 368640
  buffer_load_dwordx4 v[164:167], v200, s[24:27], s12 offen sc1
sequential_preLN__spectral_fnet__swiglu_ffn__prompt_kernel_a5:
  s_bitcmp1_b32 s16, 6
  s_cbranch_scc0 sequential_preLN__spectral_fnet__swiglu_ffn__prompt_kernel_a6
  s_add_u32 s12, s44, 442368
  buffer_load_dwordx4 v[168:171], v200, s[24:27], s12 offen sc1
sequential_preLN__spectral_fnet__swiglu_ffn__prompt_kernel_a6:
  s_bitcmp1_b32 s16, 7
  s_cbranch_scc0 sequential_preLN__spectral_fnet__swiglu_ffn__prompt_kernel_a7
  s_add_u32 s12, s44, 516096
  buffer_load_dwordx4 v[172:175], v200, s[24:27], s12 offen sc1
sequential_preLN__spectral_fnet__swiglu_ffn__prompt_kernel_a7:
  s_bcnt1_i32_b32 s37, s37
  s_cmp_ge_u32 s37, 7
  s_cbranch_scc1 sequential_preLN__spectral_fnet__swiglu_ffn__prompt_kernel_w7
  s_cmp_ge_u32 s37, 5
  s_cbranch_scc1 sequential_preLN__spectral_fnet__swiglu_ffn__prompt_kernel_w5
  s_cmp_ge_u32 s37, 3
  s_cbranch_scc1 sequential_preLN__spectral_fnet__swiglu_ffn__prompt_kernel_w3
  s_cmp_ge_u32 s37, 1
  s_cbranch_scc1 sequential_preLN__spectral_fnet__swiglu_ffn__prompt_kernel_w1
  s_waitcnt vmcnt(0)
sequential_preLN__spectral_fnet__swiglu_ffn__prompt_kernel_w1:
  s_waitcnt vmcnt(1)
sequential_preLN__spectral_fnet__swiglu_ffn__prompt_kernel_w3:
  s_waitcnt vmcnt(3)
sequential_preLN__spectral_fnet__swiglu_ffn__prompt_kernel_w5:
  s_waitcnt vmcnt(5)
sequential_preLN__spectral_fnet__swiglu_ffn__prompt_kernel_w7:
  s_waitcnt vmcnt(7)
  s_waitcnt lgkmcnt(0)
  s_barrier
  ds_read_b128 v[40:43], v2 offset:0
  ds_read_b128 v[44:47], v2 offset:3072
  ds_read_b128 v[48:51], v2 offset:6144
  s_and_b32 s36, s2, 7
  s_lshl_b32 s36, 1, s36
  s_mov_b32 s37, s36
  s_mov_b32 s41, s36
  s_and_b32 s40, s32, 0xff
  s_mov_b32 s99, 1
  s_branch sequential_preLN__spectral_fnet__swiglu_ffn__prompt_kernel_ti
sequential_preLN__spectral_fnet__swiglu_ffn__prompt_kernel_tl:
  ds_read_b32 v220, v250
  s_waitcnt lgkmcnt(0)
  v_readfirstlane_b32 s33, v220
  s_nop 0
  s_andn2_b32 s40, s33, s36
  s_cbranch_scc0 sequential_preLN__spectral_fnet__swiglu_ffn__prompt_kernel_tc
sequential_preLN__spectral_fnet__swiglu_ffn__prompt_kernel_ti:
  s_and_b32 s13, s40, 0xf
  s_cbranch_scc0 sequential_preLN__spectral_fnet__swiglu_ffn__prompt_kernel_b0_4
  s_and_b32 s13, s40, 0x3
  s_cbranch_scc0 sequential_preLN__spectral_fnet__swiglu_ffn__prompt_kernel_b0_2
  s_bitcmp1_b32 s40, 0
  s_cbranch_scc0 sequential_preLN__spectral_fnet__swiglu_ffn__prompt_kernel_b0_1
  s_add_u32 s12, s44, 0
  buffer_load_dwordx4 v[96:99], v202, s[24:27], s12 offen sc1
  buffer_load_dwordx4 v[176:179], v201, s[24:27], s12 offen sc1
  s_bitcmp1_b32 s16, 0
  s_cbranch_scc1 sequential_preLN__spectral_fnet__swiglu_ffn__prompt_kernel_b0_1
  buffer_load_dwordx4 v[144:147], v200, s[24:27], s12 offen sc1
sequential_preLN__spectral_fnet__swiglu_ffn__prompt_kernel_b0_1:
  s_bitcmp1_b32 s40, 1
  s_cbranch_scc0 sequential_preLN__spectral_fnet__swiglu_ffn__prompt_kernel_b1_1
  s_add_u32 s12, s44, 73728
  buffer_load_dwordx4 v[100:103], v202, s[24:27], s12 offen sc1
  buffer_load_dwordx4 v[180:183], v201, s[24:27], s12 offen sc1
  s_bitcmp1_b32 s16, 1
  s_cbranch_scc1 sequential_preLN__spectral_fnet__swiglu_ffn__prompt_kernel_b1_1
  buffer_load_dwordx4 v[148:151], v200, s[24:27], s12 offen sc1
sequential_preLN__spectral_fnet__swiglu_ffn__prompt_kernel_b1_1:
sequential_preLN__spectral_fnet__swiglu_ffn__prompt_kernel_b0_2:
  s_and_b32 s13, s40, 0xc
  s_cbranch_scc0 sequential_preLN__spectral_fnet__swiglu_ffn__prompt_kernel_b2_2
  s_bitcmp1_b32 s40, 2
  s_cbranch_scc0 sequential_preLN__spectral_fnet__swiglu_ffn__prompt_kernel_b2_1
  s_add_u32 s12, s44, 147456
  buffer_load_dwordx4 v[104:107], v202, s[24:27], s12 offen sc1
  buffer_load_dwordx4 v[184:187], v201, s[24:27], s12 offen sc1
  s_bitcmp1_b32 s16, 2
  s_cbranch_scc1 sequential_preLN__spectral_fnet__swiglu_ffn__prompt_kernel_b2_1
  buffer_load_dwordx4 v[152:155], v200, s[24:27], s12 offen sc1
sequential_preLN__spectral_fnet__swiglu_ffn__prompt_kernel_b2_1:
  s_bitcmp1_b32 s40, 3
  s_cbranch_scc0 sequential_preLN__spectral_fnet__swiglu_ffn__prompt_kernel_b3_1
  s_add_u32 s12, s44, 221184
  buffer_load_dwordx4 v[108:111], v202, s[24:27], s12 offen sc1
  buffer_load_dwordx4 v[188:191], v201, s[24:27], s12 offen sc1
  s_bitcmp1_b32 s16, 3
  s_cbranch_scc1 sequential_preLN__spectral_fnet__swiglu_ffn__prompt_kernel_b3_1
  buffer_load_dwordx4 v[156:159], v200, s[24:27], s12 offen sc1
sequential_preLN__spectral_fnet__swiglu_ffn__prompt_kernel_b3_1:
sequential_preLN__spectral_fnet__swiglu_ffn__prompt_kernel_b2_2:
sequential_preLN__spectral_fnet__swiglu_ffn__prompt_kernel_b0_4:
  s_and_b32 s13, s40, 0xf0
  s_cbranch_scc0 sequential_preLN__spectral_fnet__swiglu_ffn__prompt_kernel_b4_4
  s_and_b32 s13, s40, 0x30
  s_cbranch_scc0 sequential_preLN__spectral_fnet__swiglu_ffn__prompt_kernel_b4_2
  s_bitcmp1_b32 s40, 4
  s_cbranch_scc0 sequential_preLN__spectral_fnet__swiglu_ffn__prompt_kernel_b4_1
  s_add_u32 s12, s44, 294912
  buffer_load_dwordx4 v[112:115], v202, s[24:27], s12 offen sc1
  buffer_load_dwordx4 v[80:83], v201, s[24:27], s12 offen sc1
  s_bitcmp1_b32 s16, 4
  s_cbranch_scc1 sequential_preLN__spectral_fnet__swiglu_ffn__prompt_kernel_b4_1
  buffer_load_dwordx4 v[160:163], v200, s[24:27], s12 offen sc1
sequential_preLN__spectral_fnet__swiglu_ffn__prompt_kernel_b4_1:
  s_bitcmp1_b32 s40, 5
  s_cbranch_scc0 sequential_preLN__spectral_fnet__swiglu_ffn__prompt_kernel_b5_1
  s_add_u32 s12, s44, 368640
  buffer_load_dwordx4 v[116:119], v202, s[24:27], s12 offen sc1
  buffer_load_dwordx4 v[84:87], v201, s[24:27], s12 offen sc1
  s_bitcmp1_b32 s16, 5
  s_cbranch_scc1 sequential_preLN__spectral_fnet__swiglu_ffn__prompt_kernel_b5_1
  buffer_load_dwordx4 v[164:167], v200, s[24:27], s12 offen sc1
sequential_preLN__spectral_fnet__swiglu_ffn__prompt_kernel_b5_1:
sequential_preLN__spectral_fnet__swiglu_ffn__prompt_kernel_b4_2:
  s_and_b32 s13, s40, 0xc0
  s_cbranch_scc0 sequential_preLN__spectral_fnet__swiglu_ffn__prompt_kernel_b6_2
  s_bitcmp1_b32 s40, 6
  s_cbranch_scc0 sequential_preLN__spectral_fnet__swiglu_ffn__prompt_kernel_b6_1
  s_add_u32 s12, s44, 442368
  buffer_load_dwordx4 v[120:123], v202, s[24:27], s12 offen sc1
  buffer_load_dwordx4 v[88:91], v201, s[24:27], s12 offen sc1
  s_bitcmp1_b32 s16, 6
  s_cbranch_scc1 sequential_preLN__spectral_fnet__swiglu_ffn__prompt_kernel_b6_1
  buffer_load_dwordx4 v[168:171], v200, s[24:27], s12 offen sc1
sequential_preLN__spectral_fnet__swiglu_ffn__prompt_kernel_b6_1:
  s_bitcmp1_b32 s40, 7
  s_cbranch_scc0 sequential_preLN__spectral_fnet__swiglu_ffn__prompt_kernel_b7_1
  s_add_u32 s12, s44, 516096
  buffer_load_dwordx4 v[124:127], v202, s[24:27], s12 offen sc1
  buffer_load_dwordx4 v[92:95], v201, s[24:27], s12 offen sc1
  s_bitcmp1_b32 s16, 7
  s_cbranch_scc1 sequential_preLN__spectral_fnet__swiglu_ffn__prompt_kernel_b7_1
  buffer_load_dwordx4 v[172:175], v200, s[24:27], s12 offen sc1
sequential_preLN__spectral_fnet__swiglu_ffn__prompt_kernel_b7_1:
sequential_preLN__spectral_fnet__swiglu_ffn__prompt_kernel_b6_2:
sequential_preLN__spectral_fnet__swiglu_ffn__prompt_kernel_b4_4:
  s_or_b32 s36, s36, s40
  s_cmp_eq_u32 s99, 0
  s_cbranch_scc1 sequential_preLN__spectral_fnet__swiglu_ffn__prompt_kernel_tc
  s_mov_b32 s99, 0
  s_waitcnt lgkmcnt(0)
  v_dot2c_f32_bf16 v16, s46, v40
  v_dot2c_f32_bf16 v17, s31, v40
  v_dot2c_f32_bf16 v18, s46, v41
  v_dot2c_f32_bf16 v19, s31, v41
  v_dot2c_f32_bf16 v20, s46, v42
  v_dot2c_f32_bf16 v21, s31, v42
  v_dot2c_f32_bf16 v22, s46, v43
  v_dot2c_f32_bf16 v23, s31, v43
  v_dot2c_f32_bf16 v24, s46, v44
  v_dot2c_f32_bf16 v25, s31, v44
  v_dot2c_f32_bf16 v26, s46, v45
  v_dot2c_f32_bf16 v27, s31, v45
  v_dot2c_f32_bf16 v28, s46, v46
  v_dot2c_f32_bf16 v29, s31, v46
  v_dot2c_f32_bf16 v30, s46, v47
  v_dot2c_f32_bf16 v31, s31, v47
  v_dot2c_f32_bf16 v32, s46, v48
  v_dot2c_f32_bf16 v33, s31, v48
  v_dot2c_f32_bf16 v34, s46, v49
  v_dot2c_f32_bf16 v35, s31, v49
  v_dot2c_f32_bf16 v36, s46, v50
  v_dot2c_f32_bf16 v37, s31, v50
  v_dot2c_f32_bf16 v38, s46, v51
  v_dot2c_f32_bf16 v39, s31, v51
sequential_preLN__spectral_fnet__swiglu_ffn__prompt_kernel_tc:
  s_andn2_b32 s40, s37, s41
  s_cbranch_scc1 sequential_preLN__spectral_fnet__swiglu_ffn__prompt_kernel_ac
  s_cmp_eq_u32 s36, s37
  s_cbranch_scc1 sequential_preLN__spectral_fnet__swiglu_ffn__prompt_kernel_tl
  s_waitcnt vmcnt(0)
  s_mov_b32 s37, s36
  s_cmp_lg_u32 s36, 0xff
  s_cbranch_scc1 sequential_preLN__spectral_fnet__swiglu_ffn__prompt_kernel_tl
  s_andn2_b32 s40, s37, s41
sequential_preLN__spectral_fnet__swiglu_ffn__prompt_kernel_ac:
  s_and_b32 s13, s40, 0xf
  s_cbranch_scc0 sequential_preLN__spectral_fnet__swiglu_ffn__prompt_kernel_c0_4
  s_and_b32 s13, s40, 0x3
  s_cbranch_scc0 sequential_preLN__spectral_fnet__swiglu_ffn__prompt_kernel_c0_2
  s_bitcmp1_b32 s40, 0
  s_cbranch_scc0 sequential_preLN__spectral_fnet__swiglu_ffn__prompt_kernel_c0_1
  v_dot2c_f32_bf16 v16, s46, v144
  v_dot2c_f32_bf16 v17, s31, v144
  v_dot2c_f32_bf16 v18, s46, v145
  v_dot2c_f32_bf16 v19, s31, v145
  v_dot2c_f32_bf16 v20, s46, v146
  v_dot2c_f32_bf16 v21, s31, v146
  v_dot2c_f32_bf16 v22, s46, v147
  v_dot2c_f32_bf16 v23, s31, v147
  v_dot2c_f32_bf16 v24, s46, v176
  v_dot2c_f32_bf16 v25, s31, v176
  v_dot2c_f32_bf16 v26, s46, v177
  v_dot2c_f32_bf16 v27, s31, v177
  v_dot2c_f32_bf16 v28, s46, v178
  v_dot2c_f32_bf16 v29, s31, v178
  v_dot2c_f32_bf16 v30, s46, v179
  v_dot2c_f32_bf16 v31, s31, v179
  v_dot2c_f32_bf16 v32, s46, v96
  v_dot2c_f32_bf16 v33, s31, v96
  v_dot2c_f32_bf16 v34, s46, v97
  v_dot2c_f32_bf16 v35, s31, v97
  v_dot2c_f32_bf16 v36, s46, v98
  v_dot2c_f32_bf16 v37, s31, v98
  v_dot2c_f32_bf16 v38, s46, v99
  v_dot2c_f32_bf16 v39, s31, v99
sequential_preLN__spectral_fnet__swiglu_ffn__prompt_kernel_c0_1:
  s_bitcmp1_b32 s40, 1
  s_cbranch_scc0 sequential_preLN__spectral_fnet__swiglu_ffn__prompt_kernel_c1_1
  v_dot2c_f32_bf16 v16, s46, v148
  v_dot2c_f32_bf16 v17, s31, v148
  v_dot2c_f32_bf16 v18, s46, v149
  v_dot2c_f32_bf16 v19, s31, v149
  v_dot2c_f32_bf16 v20, s46, v150
  v_dot2c_f32_bf16 v21, s31, v150
  v_dot2c_f32_bf16 v22, s46, v151
  v_dot2c_f32_bf16 v23, s31, v151
  v_dot2c_f32_bf16 v24, s46, v180
  v_dot2c_f32_bf16 v25, s31, v180
  v_dot2c_f32_bf16 v26, s46, v181
  v_dot2c_f32_bf16 v27, s31, v181
  v_dot2c_f32_bf16 v28, s46, v182
  v_dot2c_f32_bf16 v29, s31, v182
  v_dot2c_f32_bf16 v30, s46, v183
  v_dot2c_f32_bf16 v31, s31, v183
  v_dot2c_f32_bf16 v32, s46, v100
  v_dot2c_f32_bf16 v33, s31, v100
  v_dot2c_f32_bf16 v34, s46, v101
  v_dot2c_f32_bf16 v35, s31, v101
  v_dot2c_f32_bf16 v36, s46, v102
  v_dot2c_f32_bf16 v37, s31, v102
  v_dot2c_f32_bf16 v38, s46, v103
  v_dot2c_f32_bf16 v39, s31, v103
sequential_preLN__spectral_fnet__swiglu_ffn__prompt_kernel_c1_1:
sequential_preLN__spectral_fnet__swiglu_ffn__prompt_kernel_c0_2:
  s_and_b32 s13, s40, 0xc
  s_cbranch_scc0 sequential_preLN__spectral_fnet__swiglu_ffn__prompt_kernel_c2_2
  s_bitcmp1_b32 s40, 2
  s_cbranch_scc0 sequential_preLN__spectral_fnet__swiglu_ffn__prompt_kernel_c2_1
  v_dot2c_f32_bf16 v16, s46, v152
  v_dot2c_f32_bf16 v17, s31, v152
  v_dot2c_f32_bf16 v18, s46, v153
  v_dot2c_f32_bf16 v19, s31, v153
  v_dot2c_f32_bf16 v20, s46, v154
  v_dot2c_f32_bf16 v21, s31, v154
  v_dot2c_f32_bf16 v22, s46, v155
  v_dot2c_f32_bf16 v23, s31, v155
  v_dot2c_f32_bf16 v24, s46, v184
  v_dot2c_f32_bf16 v25, s31, v184
  v_dot2c_f32_bf16 v26, s46, v185
  v_dot2c_f32_bf16 v27, s31, v185
  v_dot2c_f32_bf16 v28, s46, v186
  v_dot2c_f32_bf16 v29, s31, v186
  v_dot2c_f32_bf16 v30, s46, v187
  v_dot2c_f32_bf16 v31, s31, v187
  v_dot2c_f32_bf16 v32, s46, v104
  v_dot2c_f32_bf16 v33, s31, v104
  v_dot2c_f32_bf16 v34, s46, v105
  v_dot2c_f32_bf16 v35, s31, v105
  v_dot2c_f32_bf16 v36, s46, v106
  v_dot2c_f32_bf16 v37, s31, v106
  v_dot2c_f32_bf16 v38, s46, v107
  v_dot2c_f32_bf16 v39, s31, v107
sequential_preLN__spectral_fnet__swiglu_ffn__prompt_kernel_c2_1:
  s_bitcmp1_b32 s40, 3
  s_cbranch_scc0 sequential_preLN__spectral_fnet__swiglu_ffn__prompt_kernel_c3_1
  v_dot2c_f32_bf16 v16, s46, v156
  v_dot2c_f32_bf16 v17, s31, v156
  v_dot2c_f32_bf16 v18, s46, v157
  v_dot2c_f32_bf16 v19, s31, v157
  v_dot2c_f32_bf16 v20, s46, v158
  v_dot2c_f32_bf16 v21, s31, v158
  v_dot2c_f32_bf16 v22, s46, v159
  v_dot2c_f32_bf16 v23, s31, v159
  v_dot2c_f32_bf16 v24, s46, v188
  v_dot2c_f32_bf16 v25, s31, v188
  v_dot2c_f32_bf16 v26, s46, v189
  v_dot2c_f32_bf16 v27, s31, v189
  v_dot2c_f32_bf16 v28, s46, v190
  v_dot2c_f32_bf16 v29, s31, v190
  v_dot2c_f32_bf16 v30, s46, v191
  v_dot2c_f32_bf16 v31, s31, v191
  v_dot2c_f32_bf16 v32, s46, v108
  v_dot2c_f32_bf16 v33, s31, v108
  v_dot2c_f32_bf16 v34, s46, v109
  v_dot2c_f32_bf16 v35, s31, v109
  v_dot2c_f32_bf16 v36, s46, v110
  v_dot2c_f32_bf16 v37, s31, v110
  v_dot2c_f32_bf16 v38, s46, v111
  v_dot2c_f32_bf16 v39, s31, v111
sequential_preLN__spectral_fnet__swiglu_ffn__prompt_kernel_c3_1:
sequential_preLN__spectral_fnet__swiglu_ffn__prompt_kernel_c2_2:
sequential_preLN__spectral_fnet__swiglu_ffn__prompt_kernel_c0_4:
  s_and_b32 s13, s40, 0xf0
  s_cbranch_scc0 sequential_preLN__spectral_fnet__swiglu_ffn__prompt_kernel_c4_4
  s_and_b32 s13, s40, 0x30
  s_cbranch_scc0 sequential_preLN__spectral_fnet__swiglu_ffn__prompt_kernel_c4_2
  s_bitcmp1_b32 s40, 4
  s_cbranch_scc0 sequential_preLN__spectral_fnet__swiglu_ffn__prompt_kernel_c4_1
  v_dot2c_f32_bf16 v16, s46, v160
  v_dot2c_f32_bf16 v17, s31, v160
  v_dot2c_f32_bf16 v18, s46, v161
  v_dot2c_f32_bf16 v19, s31, v161
  v_dot2c_f32_bf16 v20, s46, v162
  v_dot2c_f32_bf16 v21, s31, v162
  v_dot2c_f32_bf16 v22, s46, v163
  v_dot2c_f32_bf16 v23, s31, v163
  v_dot2c_f32_bf16 v24, s46, v80
  v_dot2c_f32_bf16 v25, s31, v80
  v_dot2c_f32_bf16 v26, s46, v81
  v_dot2c_f32_bf16 v27, s31, v81
  v_dot2c_f32_bf16 v28, s46, v82
  v_dot2c_f32_bf16 v29, s31, v82
  v_dot2c_f32_bf16 v30, s46, v83
  v_dot2c_f32_bf16 v31, s31, v83
  v_dot2c_f32_bf16 v32, s46, v112
  v_dot2c_f32_bf16 v33, s31, v112
  v_dot2c_f32_bf16 v34, s46, v113
  v_dot2c_f32_bf16 v35, s31, v113
  v_dot2c_f32_bf16 v36, s46, v114
  v_dot2c_f32_bf16 v37, s31, v114
  v_dot2c_f32_bf16 v38, s46, v115
  v_dot2c_f32_bf16 v39, s31, v115
sequential_preLN__spectral_fnet__swiglu_ffn__prompt_kernel_c4_1:
  s_bitcmp1_b32 s40, 5
  s_cbranch_scc0 sequential_preLN__spectral_fnet__swiglu_ffn__prompt_kernel_c5_1
  v_dot2c_f32_bf16 v16, s46, v164
  v_dot2c_f32_bf16 v17, s31, v164
  v_dot2c_f32_bf16 v18, s46, v165
  v_dot2c_f32_bf16 v19, s31, v165
  v_dot2c_f32_bf16 v20, s46, v166
  v_dot2c_f32_bf16 v21, s31, v166
  v_dot2c_f32_bf16 v22, s46, v167
  v_dot2c_f32_bf16 v23, s31, v167
  v_dot2c_f32_bf16 v24, s46, v84
  v_dot2c_f32_bf16 v25, s31, v84
  v_dot2c_f32_bf16 v26, s46, v85
  v_dot2c_f32_bf16 v27, s31, v85
  v_dot2c_f32_bf16 v28, s46, v86
  v_dot2c_f32_bf16 v29, s31, v86
  v_dot2c_f32_bf16 v30, s46, v87
  v_dot2c_f32_bf16 v31, s31, v87
  v_dot2c_f32_bf16 v32, s46, v116
  v_dot2c_f32_bf16 v33, s31, v116
  v_dot2c_f32_bf16 v34, s46, v117
  v_dot2c_f32_bf16 v35, s31, v117
  v_dot2c_f32_bf16 v36, s46, v118
  v_dot2c_f32_bf16 v37, s31, v118
  v_dot2c_f32_bf16 v38, s46, v119
  v_dot2c_f32_bf16 v39, s31, v119
sequential_preLN__spectral_fnet__swiglu_ffn__prompt_kernel_c5_1:
sequential_preLN__spectral_fnet__swiglu_ffn__prompt_kernel_c4_2:
  s_and_b32 s13, s40, 0xc0
  s_cbranch_scc0 sequential_preLN__spectral_fnet__swiglu_ffn__prompt_kernel_c6_2
  s_bitcmp1_b32 s40, 6
  s_cbranch_scc0 sequential_preLN__spectral_fnet__swiglu_ffn__prompt_kernel_c6_1
  v_dot2c_f32_bf16 v16, s46, v168
  v_dot2c_f32_bf16 v17, s31, v168
  v_dot2c_f32_bf16 v18, s46, v169
  v_dot2c_f32_bf16 v19, s31, v169
  v_dot2c_f32_bf16 v20, s46, v170
  v_dot2c_f32_bf16 v21, s31, v170
  v_dot2c_f32_bf16 v22, s46, v171
  v_dot2c_f32_bf16 v23, s31, v171
  v_dot2c_f32_bf16 v24, s46, v88
  v_dot2c_f32_bf16 v25, s31, v88
  v_dot2c_f32_bf16 v26, s46, v89
  v_dot2c_f32_bf16 v27, s31, v89
  v_dot2c_f32_bf16 v28, s46, v90
  v_dot2c_f32_bf16 v29, s31, v90
  v_dot2c_f32_bf16 v30, s46, v91
  v_dot2c_f32_bf16 v31, s31, v91
  v_dot2c_f32_bf16 v32, s46, v120
  v_dot2c_f32_bf16 v33, s31, v120
  v_dot2c_f32_bf16 v34, s46, v121
  v_dot2c_f32_bf16 v35, s31, v121
  v_dot2c_f32_bf16 v36, s46, v122
  v_dot2c_f32_bf16 v37, s31, v122
  v_dot2c_f32_bf16 v38, s46, v123
  v_dot2c_f32_bf16 v39, s31, v123
sequential_preLN__spectral_fnet__swiglu_ffn__prompt_kernel_c6_1:
  s_bitcmp1_b32 s40, 7
  s_cbranch_scc0 sequential_preLN__spectral_fnet__swiglu_ffn__prompt_kernel_c7_1
  v_dot2c_f32_bf16 v16, s46, v172
  v_dot2c_f32_bf16 v17, s31, v172
  v_dot2c_f32_bf16 v18, s46, v173
  v_dot2c_f32_bf16 v19, s31, v173
  v_dot2c_f32_bf16 v20, s46, v174
  v_dot2c_f32_bf16 v21, s31, v174
  v_dot2c_f32_bf16 v22, s46, v175
  v_dot2c_f32_bf16 v23, s31, v175
  v_dot2c_f32_bf16 v24, s46, v92
  v_dot2c_f32_bf16 v25, s31, v92
  v_dot2c_f32_bf16 v26, s46, v93
  v_dot2c_f32_bf16 v27, s31, v93
  v_dot2c_f32_bf16 v28, s46, v94
  v_dot2c_f32_bf16 v29, s31, v94
  v_dot2c_f32_bf16 v30, s46, v95
  v_dot2c_f32_bf16 v31, s31, v95
  v_dot2c_f32_bf16 v32, s46, v124
  v_dot2c_f32_bf16 v33, s31, v124
  v_dot2c_f32_bf16 v34, s46, v125
  v_dot2c_f32_bf16 v35, s31, v125
  v_dot2c_f32_bf16 v36, s46, v126
  v_dot2c_f32_bf16 v37, s31, v126
  v_dot2c_f32_bf16 v38, s46, v127
  v_dot2c_f32_bf16 v39, s31, v127
sequential_preLN__spectral_fnet__swiglu_ffn__prompt_kernel_c7_1:
sequential_preLN__spectral_fnet__swiglu_ffn__prompt_kernel_c6_2:
sequential_preLN__spectral_fnet__swiglu_ffn__prompt_kernel_c4_4:
  s_or_b32 s41, s41, s40
  s_cmp_lg_u32 s41, 0xff
  s_cbranch_scc1 sequential_preLN__spectral_fnet__swiglu_ffn__prompt_kernel_tl
  s_nop 2
  v_permlane16_swap_b32 v16, v20
  v_permlane16_swap_b32 v17, v21
  v_permlane16_swap_b32 v18, v22
  v_permlane16_swap_b32 v19, v23
  v_cvt_pk_bf16_f32 v204, v16, v17
  v_cvt_pk_bf16_f32 v205, v18, v19
  v_cvt_pk_bf16_f32 v206, v20, v21
  v_cvt_pk_bf16_f32 v207, v22, v23
  buffer_store_dwordx4 v[204:207], v197, s[8:11], s92 offen
  v_permlane16_swap_b32 v24, v28
  v_permlane16_swap_b32 v25, v29
  v_permlane16_swap_b32 v26, v30
  v_permlane16_swap_b32 v27, v31
  v_cvt_pk_bf16_f32 v208, v24, v25
  v_cvt_pk_bf16_f32 v209, v26, v27
  v_cvt_pk_bf16_f32 v210, v28, v29
  v_cvt_pk_bf16_f32 v211, v30, v31
  buffer_store_dwordx4 v[208:211], v197, s[8:11], s93 offen
  v_permlane16_swap_b32 v32, v36
  v_permlane16_swap_b32 v33, v37
  v_permlane16_swap_b32 v34, v38
  v_permlane16_swap_b32 v35, v39
  v_cvt_pk_bf16_f32 v212, v32, v33
  v_cvt_pk_bf16_f32 v213, v34, v35
  v_cvt_pk_bf16_f32 v214, v36, v37
  v_cvt_pk_bf16_f32 v215, v38, v39
  buffer_store_dwordx4 v[212:215], v197, s[8:11], s94 offen
  s_endpgm
sequential_preLN__spectral_fnet__swiglu_ffn__prompt_kernel_mu:
  v_lshlrev_b32 v12, 7, v3
  v_lshl_add_u32 v12, v4, 4, v12
  s_lshl_b32 s55, s54, 12
  s_add_u32 s62, s55, 7151616
  s_add_u32 s55, s55, 7143424
  s_lshl_b32 s57, s28, 24
  s_add_u32 s62, s62, s57
  buffer_load_dwordx4 v[88:91], v12, s[20:23], s55 offen sc1
  buffer_load_dwordx4 v[92:95], v12, s[20:23], s55 offen offset:32 sc1
  buffer_load_dwordx4 v[96:99], v12, s[20:23], s55 offen offset:64 sc1
  buffer_load_dwordx4 v[100:103], v12, s[20:23], s55 offen offset:96 sc1
  s_waitcnt vmcnt(3)
  v_sub_f32 v232, v232, v88
  v_sub_f32 v233, v233, v89
  v_sub_f32 v234, v234, v90
  v_sub_f32 v235, v235, v91
  s_waitcnt vmcnt(2)
  v_sub_f32 v236, v236, v92
  v_sub_f32 v237, v237, v93
  v_sub_f32 v238, v238, v94
  v_sub_f32 v239, v239, v95
  s_waitcnt vmcnt(1)
  v_sub_f32 v240, v240, v96
  v_sub_f32 v241, v241, v97
  v_sub_f32 v242, v242, v98
  v_sub_f32 v243, v243, v99
  s_waitcnt vmcnt(0)
  v_sub_f32 v244, v244, v100
  v_sub_f32 v245, v245, v101
  v_sub_f32 v246, v246, v102
  v_sub_f32 v247, v247, v103
  buffer_store_dwordx4 v[232:235], v12, s[20:23], s62 offen sc1
  buffer_store_dwordx4 v[236:239], v12, s[20:23], s62 offen offset:32 sc1
  buffer_store_dwordx4 v[240:243], v12, s[20:23], s62 offen offset:64 sc1
  buffer_store_dwordx4 v[244:247], v12, s[20:23], s62 offen offset:96 sc1
  s_waitcnt vmcnt(0)
  s_branch sequential_preLN__spectral_fnet__swiglu_ffn__prompt_kernel_nofft
sequential_preLN__spectral_fnet__swiglu_ffn__prompt_kernel_nofft:
  s_add_u32 m0, s32, 0
  s_add_u32 s41, s46, 0
  buffer_load_dwordx4 v200, s[8:11], s41 offen lds
  buffer_load_dwordx4 v201, s[8:11], s41 offen offset:1024 lds
  buffer_load_dwordx4 v202, s[8:11], s41 offen offset:2048 lds
  buffer_load_dwordx4 v203, s[8:11], s41 offen offset:3072 lds
  s_add_u32 m0, s32, 4096
  s_add_u32 s41, s46, 1179648
  buffer_load_dwordx4 v200, s[8:11], s41 offen lds
  buffer_load_dwordx4 v201, s[8:11], s41 offen offset:1024 lds
  buffer_load_dwordx4 v202, s[8:11], s41 offen offset:2048 lds
  buffer_load_dwordx4 v203, s[8:11], s41 offen offset:3072 lds
  s_add_u32 m0, s32, 8192
  s_add_u32 s41, s46, 2359296
  buffer_load_dwordx4 v200, s[8:11], s41 offen lds
  s_add_u32 m0, s32, 36864
  s_add_u32 s41, s46, 0
  buffer_load_dwordx4 v200, s[12:15], s41 offen lds
  buffer_load_dwordx4 v201, s[12:15], s41 offen offset:1024 lds
  buffer_load_dwordx4 v202, s[12:15], s41 offen offset:2048 lds
  buffer_load_dwordx4 v203, s[12:15], s41 offen offset:3072 lds
  s_add_u32 m0, s32, 40960
  s_add_u32 s41, s46, 1179648
  buffer_load_dwordx4 v200, s[12:15], s41 offen lds
  buffer_load_dwordx4 v201, s[12:15], s41 offen offset:1024 lds
  buffer_load_dwordx4 v202, s[12:15], s41 offen offset:2048 lds
  buffer_load_dwordx4 v203, s[12:15], s41 offen offset:3072 lds
  s_add_u32 m0, s32, 45056
  s_add_u32 s41, s46, 2359296
  buffer_load_dwordx4 v200, s[12:15], s41 offen lds
  s_branch sequential_preLN__spectral_fnet__swiglu_ffn__prompt_kernel_join
sequential_preLN__spectral_fnet__swiglu_ffn__prompt_kernel_spin0:
  s_mov_b32 s42, 0x80000
sequential_preLN__spectral_fnet__swiglu_ffn__prompt_kernel_spin0l:
  s_sleep 2
  buffer_load_dword v220, v221, s[20:23], s43 offen offset:1152 sc1
  buffer_load_dword v8, v9, s[20:23], s99 offen sc1
  s_waitcnt vmcnt(0)
  v_min_u32 v220, v220, v8
  v_cmp_gt_u32 vcc, 1, v220
  s_sub_u32 s42, s42, 1
  s_cbranch_scc1 sequential_preLN__spectral_fnet__swiglu_ffn__prompt_kernel_go0
  s_cmp_eq_u32 vcc_lo, 0
  s_cbranch_scc0 sequential_preLN__spectral_fnet__swiglu_ffn__prompt_kernel_spin0l
  s_branch sequential_preLN__spectral_fnet__swiglu_ffn__prompt_kernel_go0
sequential_preLN__spectral_fnet__swiglu_ffn__prompt_kernel_spin1:
  s_mov_b32 s42, 0x80000
sequential_preLN__spectral_fnet__swiglu_ffn__prompt_kernel_spin1l:
  s_sleep 2
  buffer_load_dword v220, v254, s[20:23], s30 offen sc1

  s_waitcnt vmcnt(0)

  v_cmp_gt_u32 vcc, 1, v220
  s_sub_u32 s42, s42, 1
  s_cbranch_scc1 sequential_preLN__spectral_fnet__swiglu_ffn__prompt_kernel_go1
  s_cmp_eq_u32 vcc_lo, 0
  s_cbranch_scc0 sequential_preLN__spectral_fnet__swiglu_ffn__prompt_kernel_spin1l
  s_branch sequential_preLN__spectral_fnet__swiglu_ffn__prompt_kernel_go1
sequential_preLN__spectral_fnet__swiglu_ffn__prompt_kernel_spin2:
  s_mov_b32 s42, 0x80000
sequential_preLN__spectral_fnet__swiglu_ffn__prompt_kernel_spin2l:
  s_sleep 2
  buffer_load_dword v220, v254, s[20:23], s30 offen sc1

  s_waitcnt vmcnt(0)

  v_cmp_gt_u32 vcc, 2, v220
  s_sub_u32 s42, s42, 1
  s_cbranch_scc1 sequential_preLN__spectral_fnet__swiglu_ffn__prompt_kernel_go2
  s_cmp_eq_u32 vcc_lo, 0
  s_cbranch_scc0 sequential_preLN__spectral_fnet__swiglu_ffn__prompt_kernel_spin2l
  s_branch sequential_preLN__spectral_fnet__swiglu_ffn__prompt_kernel_go2
sequential_preLN__spectral_fnet__swiglu_ffn__prompt_kernel_spin3:
  s_mov_b32 s42, 0x80000
sequential_preLN__spectral_fnet__swiglu_ffn__prompt_kernel_spin3l:
  s_sleep 2
  buffer_load_dword v220, v254, s[20:23], s30 offen sc1

  s_waitcnt vmcnt(0)

  v_cmp_gt_u32 vcc, 3, v220
  s_sub_u32 s42, s42, 1
  s_cbranch_scc1 sequential_preLN__spectral_fnet__swiglu_ffn__prompt_kernel_go3
  s_cmp_eq_u32 vcc_lo, 0
  s_cbranch_scc0 sequential_preLN__spectral_fnet__swiglu_ffn__prompt_kernel_spin3l
  s_branch sequential_preLN__spectral_fnet__swiglu_ffn__prompt_kernel_go3
sequential_preLN__spectral_fnet__swiglu_ffn__prompt_kernel_spinq:
  s_mov_b32 s98, 0x80000
sequential_preLN__spectral_fnet__swiglu_ffn__prompt_kernel_spinql:
  s_sleep 4
  buffer_load_dword v226, v224, s[20:23], s43 offen sc1
  buffer_load_dword v227, v225, s[20:23], s43 offen offset:1024 sc1
  s_waitcnt vmcnt(0)
  v_min_u32 v226, v226, v227
  v_cmp_gt_u32 vcc, 2, v226
  s_sub_u32 s98, s98, 1
  s_cbranch_scc1 sequential_preLN__spectral_fnet__swiglu_ffn__prompt_kernel_goq
  s_cmp_eq_u64 vcc, 0
  s_cbranch_scc0 sequential_preLN__spectral_fnet__swiglu_ffn__prompt_kernel_spinql
  s_branch sequential_preLN__spectral_fnet__swiglu_ffn__prompt_kernel_goq
sequential_preLN__spectral_fnet__swiglu_ffn__prompt_kernel_poll:
  s_waitcnt vmcnt(0) lgkmcnt(0)
  s_barrier
  buffer_store_dword v253, v252, s[20:23], s29 offen sc1
  s_mov_b32 s42, 0x80000
  s_and_b32 s33, s2, 7
  s_lshl_b32 s33, 1, s33
sequential_preLN__spectral_fnet__swiglu_ffn__prompt_kernel_poll1:
  buffer_load_dword v220, v203, s[20:23], s3 offen sc1
  s_waitcnt vmcnt(0)
  v_cmp_lt_u32 vcc, 2, v220
  s_sub_u32 s42, s42, 1
  s_cselect_b32 s40, 0xff, 0
  s_or_b32 s33, s33, s40
  s_and_b32 s40, vcc_lo, 0xff
  s_or_b32 s33, s33, s40
  v_mov_b32 v221, s33
  ds_write_b32 v250, v221
  s_cmp_eq_u32 s33, 0xff
  s_cbranch_scc0 sequential_preLN__spectral_fnet__swiglu_ffn__prompt_kernel_poll1
sequential_preLN__spectral_fnet__swiglu_ffn__prompt_kernel_end:
  s_endpgm

.section .rodata,"a"
.p2align 6
.amdhsa_kernel sequential_preLN__spectral_fnet__swiglu_ffn__prompt_kernel
  .amdhsa_next_free_vgpr 512
  .amdhsa_next_free_sgpr 102
  .amdhsa_accum_offset 256
  .amdhsa_group_segment_fixed_size 0
  .amdhsa_kernarg_size 96
  .amdhsa_user_sgpr_count 2
  .amdhsa_user_sgpr_kernarg_segment_ptr 1
  .amdhsa_system_sgpr_workgroup_id_x 1
  .amdhsa_float_denorm_mode_32 3
.end_amdhsa_kernel
```
